```python
import torch

def _softmax(x, axis=-1):
    return torch.softmax(x, dim=axis)
def _gelu(x):
    return torch.nn.functional.gelu(x, approximate="tanh")
def _silu(x):
    return torch.nn.functional.silu(x)
def _sigmoid(x):
    return torch.sigmoid(x)
def _layernorm(x, axis=-1, eps=1e-5):
    m = x.mean(dim=axis, keepdim=True)
    v = x.var(dim=axis, keepdim=True, unbiased=False)
    return (x - m) / torch.sqrt(v + eps)
def _scatter_add(tgt, idx, src, axis=0):
    return tgt.clone().index_add_(axis, idx, src)
def _segment_sum(src, seg, n):
    out = torch.zeros((n,) + src.shape[1:], dtype=src.dtype)
    return out.index_add_(0, seg, src)
def _pad(x, pw):
    flat = tuple(v for pair in reversed(pw) for v in pair)
    return torch.nn.functional.pad(x, flat)

kernel_name = 'parallel_sum__sliding_local_dilated__geglu_ffn__prompt'

def setup_inputs():

    _w = (lambda a: (lambda t: t.to(torch.bfloat16) if t.is_floating_point() else t)(torch.as_tensor(a)))
    def _A_setup():
        B, S, D = 1, 2048, 512
        return {
            "x": _w((lambda *s: torch.randn(*s, dtype=torch.bfloat16) * 0.05)(B, S, D)),
            "wqkv": _w((lambda *s: torch.randn(*s, dtype=torch.bfloat16) * 0.05)(D, 3 * D)),
            "wo": _w((lambda *s: torch.randn(*s, dtype=torch.bfloat16) * 0.05)(D, D)),
        }
    _A_in = _A_setup()

    def _B_setup():
        B, S, D, F = 1, 2048, 512, 1376
        return {
            "x": _w((lambda *s: torch.randn(*s, dtype=torch.bfloat16) * 0.05)(B, S, D)),
            "w_gate": _w((lambda *s: torch.randn(*s, dtype=torch.bfloat16) * 0.05)(D, F)),
            "w_up": _w((lambda *s: torch.randn(*s, dtype=torch.bfloat16) * 0.05)(D, F)),
            "w_down": _w((lambda *s: torch.randn(*s, dtype=torch.bfloat16) * 0.05)(F, D)),
        }
    _B_in = _B_setup()

    return {
        "A_x": _A_in["x"],
        "A_wqkv": _A_in["wqkv"],
        "A_wo": _A_in["wo"],
        "B_x": _B_in["x"],
        "B_w_gate": _B_in["w_gate"],
        "B_w_up": _B_in["w_up"],
        "B_w_down": _B_in["w_down"],
    }

def reference(A_x, A_wqkv, A_wo, B_x, B_w_gate, B_w_up, B_w_down):
    def _A_ref(x, wqkv, wo):
        B, S, D = x.shape
        H = 32; Dh = D // H
        W, dil = 8, 2
        qkv = (lambda x, *d: x.permute(*d))((x @ wqkv).reshape(B, S, 3, H, Dh), 2, 0, 3, 1, 4)
        q, k, v = qkv[0], qkv[1], qkv[2]
        scale = Dh ** -0.5
        pos = torch.arange(S)
        off = torch.arange(W) * dil
        idx = pos[:, None] - off[None, :]
        mask = idx >= 0
        idx_c = torch.where(mask, idx, 0).reshape(-1)
        kg = k[:, :, idx_c, :].reshape(B, H, S, W, Dh)
        vg = v[:, :, idx_c, :].reshape(B, H, S, W, Dh)
        logits = torch.einsum("bhsd,bhswd->bhsw", q, kg) * scale
        logits = torch.where(mask[None, None, :, :], logits, -1e9)
        attn = _softmax(logits, axis=-1)
        o = torch.einsum("bhsw,bhswd->bhsd", attn, vg)
        return (lambda x, *d: x.permute(*d))(o, 0, 2, 1, 3).reshape(B, S, D) @ wo

    def _B_ref(x, w_gate, w_up, w_down):
        return (_gelu(x @ w_gate) * (x @ w_up)) @ w_down

    x = A_x
    xn = _layernorm(x, axis=-1)
    return x + _A_ref(xn, A_wqkv, A_wo) + _B_ref(xn, B_w_gate, B_w_up, B_w_down)
```

```asm
; @launch grid=(256,1,1) block=(512,1,1) lds=161920
.amdgcn_target "amdgcn-amd-amdhsa--gfx950"
.text
.globl parallel_sum__sliding_local_dilated__geglu_ffn__prompt_kernel
.p2align 8
.type parallel_sum__sliding_local_dilated__geglu_ffn__prompt_kernel,@function
parallel_sum__sliding_local_dilated__geglu_ffn__prompt_kernel:
  s_load_dwordx16 s[36:51], s[0:1], 0
  s_load_dwordx4 s[52:55], s[0:1], 64
  s_cmp_ge_u32 s2, 256
  s_cbranch_scc1 L_end
  s_getpc_b64 s[84:85]
L_pfpc:
  s_lshl_b32 s60, s2, 2
  s_add_u32 s60, s60, L_table-L_pfpc
  s_load_dword s59, s[84:85], s60
  v_lshrrev_b32 v11, 6, v0
  v_and_b32 v1, 63, v0
  v_readfirstlane_b32 s79, v11
  s_and_b32 s56, s79, 3
  s_cmp_ge_u32 s79, 4
  s_cbranch_scc1 L_loader
  s_lshr_b32 s60, s2, 3
  s_lshl_b32 s60, s60, 2
  s_add_u32 s60, s60, s56
  s_lshl_b32 s60, s60, 9
  v_lshl_add_u32 v11, v1, 3, s60
  v_min_u32 v11, L_code_end-L_pfpc-8, v11
  v_and_b32 v11, -4, v11
  global_load_dwordx2 v[100:101], v11, s[84:85]
  s_waitcnt lgkmcnt(0)
  s_mov_b32 s4, s36
  s_mov_b32 s5, s37
  s_mov_b32 s6, 0x200000
  s_mov_b32 s7, 0x20000
  s_lshl_b32 s60, s2, 2
  s_add_u32 s60, s60, s56
  s_lshl_b32 s60, s60, 11
  v_lshlrev_b32 v14, 4, v1
  buffer_load_dwordx4 v[40:43], v14, s[4:7], s60 offen
  buffer_load_dwordx4 v[44:47], v14, s[4:7], s60 offen offset:1024
  s_branch L_compute
L_loader:
  v_lshrrev_b32 v11, 3, v1
  v_lshrrev_b32 v13, 4, v1
  v_and_b32 v12, 7, v1
  v_xor_b32 v14, v12, v13
  v_lshlrev_b32 v14, 4, v14
  v_lshl_add_u32 v10, v11, 10, v14
  v_lshrrev_b32 v14, 2, v11
  v_and_b32 v11, 3, v11
  v_lshl_add_u32 v11, v14, 3, v11
  v_mul_u32_u24 v11, 3072, v11
  v_lshlrev_b32 v13, 1, v13
  v_xor_b32 v12, v12, v13
  v_lshl_add_u32 v9, v12, 4, v11
  v_add_u32 v11, 0, v1
  v_mul_u32_u24 v12, 0x5556, v11
  v_lshrrev_b32 v12, 18, v12
  v_mul_u32_u24 v13, 12, v12
  v_sub_u32 v13, v11, v13
  v_bfe_u32 v14, v12, 2, 1
  v_lshlrev_b32 v15, 1, v14
  v_xor_b32 v13, v13, v15
  v_bfe_u32 v15, v12, 3, 1
  v_and_b32 v12, 3, v12
  v_lshl_add_u32 v12, v14, 3, v12
  v_lshl_add_u32 v12, v15, 2, v12
  v_mul_u32_u24 v12, 2752, v12
  v_lshl_add_u32 v12, v13, 4, v12
  v_subrev_u32 v4, 0, v12
  v_cmp_lt_u32 s[16:17], 3, v13
  v_add_u32 v11, 64, v1
  v_mul_u32_u24 v12, 0x5556, v11
  v_lshrrev_b32 v12, 18, v12
  v_mul_u32_u24 v13, 12, v12
  v_sub_u32 v13, v11, v13
  v_bfe_u32 v14, v12, 2, 1
  v_lshlrev_b32 v15, 1, v14
  v_xor_b32 v13, v13, v15
  v_bfe_u32 v15, v12, 3, 1
  v_and_b32 v12, 3, v12
  v_lshl_add_u32 v12, v14, 3, v12
  v_lshl_add_u32 v12, v15, 2, v12
  v_mul_u32_u24 v12, 2752, v12
  v_lshl_add_u32 v12, v13, 4, v12
  v_subrev_u32 v5, 1024, v12
  v_cmp_lt_u32 s[18:19], 3, v13
  v_add_u32 v11, 128, v1
  v_mul_u32_u24 v12, 0x5556, v11
  v_lshrrev_b32 v12, 18, v12
  v_mul_u32_u24 v13, 12, v12
  v_sub_u32 v13, v11, v13
  v_bfe_u32 v14, v12, 2, 1
  v_lshlrev_b32 v15, 1, v14
  v_xor_b32 v13, v13, v15
  v_bfe_u32 v15, v12, 3, 1
  v_and_b32 v12, 3, v12
  v_lshl_add_u32 v12, v14, 3, v12
  v_lshl_add_u32 v12, v15, 2, v12
  v_mul_u32_u24 v12, 2752, v12
  v_lshl_add_u32 v12, v13, 4, v12
  v_subrev_u32 v6, 2048, v12
  v_cmp_lt_u32 s[20:21], 3, v13
  s_waitcnt lgkmcnt(0)
  s_and_b32 s57, s59, 15
  s_bfe_u32 s58, s59, 0x50008
  s_bitcmp1_b32 s59, 7
  s_cbranch_scc1 L_lidle
  s_cmp_lt_u32 s58, 8
  s_cbranch_scc1 L_latt0
  s_sub_u32 s24, s36, 4096
  s_subb_u32 s25, s37, 0
  s_mov_b32 s26, 0x201000
  s_mov_b32 s27, 0x20000
  s_mul_i32 s60, s56, 6
  s_bitcmp1_b32 s58, 0
  s_cselect_b32 s61, 3, 0
  s_cselect_b32 s62, 0, 3
  s_add_u32 s61, s61, s60
  s_add_u32 s62, s62, s60
  s_lshl_b32 s73, s61, 10
  s_lshl_b32 s77, s62, 10
  s_and_b32 s63, s61, 1
  s_lshl_b32 s63, s63, 6
  v_xor_b32 v2, s63, v10
  v_xor_b32 v3, 64, v2
  s_and_b32 s63, s62, 1
  s_lshl_b32 s63, s63, 6
  v_xor_b32 v7, s63, v10
  v_xor_b32 v8, 64, v7
  s_mul_i32 s63, s57, 192
  s_lshl_b32 s61, s61, 3
  s_lshl_b32 s62, s62, 3
  s_add_u32 s61, s61, s63
  s_add_u32 s62, s62, s63
  s_lshl_b32 s64, s61, 10
  s_add_u32 s64, s64, 4096
  s_add_u32 s65, s64, 7168
  s_add_u32 s66, s65, 7168
  s_lshl_b32 s67, s62, 10
  s_add_u32 s67, s67, 4096
  s_add_u32 s68, s67, 7168
  s_add_u32 s69, s68, 7168
  s_add_u32 m0, s73, 0
  s_nop 0
  buffer_load_dwordx4 v2, s[24:27], s64 offen offset:0 lds
  buffer_load_dwordx4 v3, s[24:27], s65 offen offset:1024 lds
  buffer_load_dwordx4 v2, s[24:27], s66 offen offset:2048 lds
  s_bitcmp1_b32 s57, 0
  s_cselect_b32 s8, s46, s44
  s_cselect_b32 s9, s47, s45
  s_cselect_b32 s12, s44, s46
  s_cselect_b32 s13, s45, s47
  s_mov_b32 s10, 0x158000
  s_mov_b32 s11, 0x20000
  s_mov_b32 s14, 0x158000
  s_mov_b32 s15, 0x20000
  s_cselect_b32 s60, 0x3000, 0
  s_mul_i32 s61, s56, 3072
  s_add_u32 s61, s61, 24576
  s_add_u32 s74, s61, s60
  s_xor_b32 s60, s60, 0x3000
  s_add_u32 s78, s61, s60
  s_sub_u32 s60, s58, 8
  s_mul_i32 s60, s60, 192
  s_mul_i32 s61, s56, 44032
  s_add_u32 s71, s60, s61
  s_cmp_eq_u32 s58, 22
  v_mov_b32 v11, 0x7f000000
  s_cselect_b64 s[16:17], s[16:17], 0
  s_cselect_b64 s[18:19], s[18:19], 0
  s_cselect_b64 s[20:21], s[20:21], 0
  v_cndmask_b32 v4, v4, v11, s[16:17]
  v_cndmask_b32 v5, v5, v11, s[18:19]
  v_cndmask_b32 v6, v6, v11, s[20:21]
  s_add_u32 m0, s74, 0
  s_nop 0
  buffer_load_dwordx4 v4, s[8:11], s71 offen offset:0 lds
  buffer_load_dwordx4 v5, s[8:11], s71 offen offset:1024 lds
  buffer_load_dwordx4 v6, s[8:11], s71 offen offset:2048 lds
  s_add_u32 m0, s77, 0
  s_nop 0
  buffer_load_dwordx4 v7, s[24:27], s67 offen offset:0 lds
  buffer_load_dwordx4 v8, s[24:27], s68 offen offset:1024 lds
  buffer_load_dwordx4 v7, s[24:27], s69 offen offset:2048 lds
  s_add_u32 m0, s78, 0
  s_nop 0
  buffer_load_dwordx4 v4, s[12:15], s71 offen offset:0 lds
  buffer_load_dwordx4 v5, s[12:15], s71 offen offset:1024 lds
  buffer_load_dwordx4 v6, s[12:15], s71 offen offset:2048 lds
  s_add_u32 s71, s71, 176128
  v_add_u32 v2, 128, v2
  v_add_u32 v3, 128, v3
  v_add_u32 v7, 128, v7
  v_add_u32 v8, 128, v8
  s_add_u32 m0, s73, 51200
  s_nop 0
  buffer_load_dwordx4 v2, s[24:27], s64 offen offset:0 lds
  buffer_load_dwordx4 v3, s[24:27], s65 offen offset:1024 lds
  buffer_load_dwordx4 v2, s[24:27], s66 offen offset:2048 lds
  s_add_u32 m0, s74, 51200
  s_nop 0
  buffer_load_dwordx4 v4, s[8:11], s71 offen offset:0 lds
  buffer_load_dwordx4 v5, s[8:11], s71 offen offset:1024 lds
  buffer_load_dwordx4 v6, s[8:11], s71 offen offset:2048 lds
  s_add_u32 m0, s77, 51200
  s_nop 0
  buffer_load_dwordx4 v7, s[24:27], s67 offen offset:0 lds
  buffer_load_dwordx4 v8, s[24:27], s68 offen offset:1024 lds
  s_mov_b32 s4, s36
  s_mov_b32 s5, s37
  s_mov_b32 s6, 0x200000
  s_mov_b32 s7, 0x20000
  s_add_u32 s28, s54, 0x100000
  s_addc_u32 s29, s55, 0
  s_mov_b32 s30, 0x200000
  s_mov_b32 s31, 0x20000
  s_mov_b32 s32, s52
  s_mov_b32 s33, s53
  s_mov_b32 s34, 0x100
  s_mov_b32 s35, 0x20000
  s_waitcnt vmcnt(8)
  s_nop 0
  s_branch L_lffn
L_latt0:
  s_sub_u32 s24, s36, 4096
  s_subb_u32 s25, s37, 0
  s_mov_b32 s26, 0x201000
  s_mov_b32 s27, 0x20000
  s_mul_i32 s60, s56, 7
  s_min_u32 s60, s60, 19
  s_bitcmp1_b32 s58, 0
  s_cselect_b32 s61, 4, 0
  s_cselect_b32 s62, 0, 3
  s_add_u32 s61, s61, s60
  s_add_u32 s62, s62, s60
  s_lshl_b32 s73, s61, 10
  s_lshl_b32 s77, s62, 10
  s_and_b32 s63, s61, 1
  s_lshl_b32 s63, s63, 6
  v_xor_b32 v2, s63, v10
  v_xor_b32 v3, 64, v2
  s_and_b32 s63, s62, 1
  s_lshl_b32 s63, s63, 6
  v_xor_b32 v7, s63, v10
  v_xor_b32 v8, 64, v7
  s_mul_i32 s63, s57, 192
  s_sub_u32 s63, s63, 16
  s_lshl_b32 s61, s61, 3
  s_lshl_b32 s62, s62, 3
  s_add_u32 s61, s61, s63
  s_add_u32 s62, s62, s63
  s_add_u32 s60, s61, 0
  s_max_i32 s60, s60, 0
  s_lshl_b32 s60, s60, 10
  s_add_u32 s64, s60, 4096
  s_add_u32 s60, s61, 8
  s_max_i32 s60, s60, 0
  s_lshl_b32 s60, s60, 10
  s_add_u32 s65, s60, 3072
  s_lshl_b32 s66, s61, 10
  s_add_u32 s66, s66, 18432
  s_add_u32 s60, s62, 0
  s_max_i32 s60, s60, 0
  s_lshl_b32 s60, s60, 10
  s_add_u32 s67, s60, 4096
  s_add_u32 s60, s62, 8
  s_max_i32 s60, s60, 0
  s_lshl_b32 s60, s60, 10
  s_add_u32 s68, s60, 3072
  s_lshl_b32 s69, s62, 10
  s_add_u32 s69, s69, 18432
  s_add_u32 s70, s69, 7168
  s_add_u32 m0, s73, 0
  s_nop 0
  buffer_load_dwordx4 v2, s[24:27], s64 offen offset:0 lds
  buffer_load_dwordx4 v3, s[24:27], s65 offen offset:1024 lds
  buffer_load_dwordx4 v2, s[24:27], s66 offen offset:2048 lds
  s_bitcmp1_b32 s57, 0
  s_cselect_b32 s62, 12288, 0
  s_cselect_b32 s60, 0xc00, 0
  v_add_u32 v4, s62, v9
  s_mov_b32 s8, s38
  s_mov_b32 s9, s39
  s_mov_b32 s10, 0x180000
  s_mov_b32 s11, 0x20000
  s_mul_i32 s61, s56, 6144
  s_add_u32 s61, s61, 26624
  s_add_u32 s74, s61, s60
  s_xor_b32 s60, s60, 0xc00
  s_add_u32 s78, s61, s60
  s_xor_b32 s62, s62, 12288
  v_add_u32 v5, s62, v9
  s_lshl_b32 s60, s58, 7
  s_mul_i32 s61, s56, 49152
  s_add_u32 s71, s60, s61
  s_add_u32 m0, s74, 0
  s_nop 0
  buffer_load_dwordx4 v4, s[8:11], s71 offen offset:0 lds
  buffer_load_dwordx4 v4, s[8:11], s71 offen offset:1024 lds
  buffer_load_dwordx4 v4, s[8:11], s71 offen offset:2048 lds
  s_add_u32 m0, s77, 0
  s_nop 0
  buffer_load_dwordx4 v7, s[24:27], s67 offen offset:0 lds
  buffer_load_dwordx4 v8, s[24:27], s68 offen offset:1024 lds
  buffer_load_dwordx4 v7, s[24:27], s69 offen offset:2048 lds
  buffer_load_dwordx4 v8, s[24:27], s70 offen offset:3072 lds
  s_add_u32 m0, s78, 0
  s_nop 0
  buffer_load_dwordx4 v5, s[8:11], s71 offen offset:0 lds
  buffer_load_dwordx4 v5, s[8:11], s71 offen offset:1024 lds
  buffer_load_dwordx4 v5, s[8:11], s71 offen offset:2048 lds
  s_add_u32 s71, s71, 196608
  v_add_u32 v2, 128, v2
  v_add_u32 v3, 128, v3
  v_add_u32 v7, 128, v7
  v_add_u32 v8, 128, v8
  s_add_u32 m0, s73, 51200
  s_nop 0
  buffer_load_dwordx4 v2, s[24:27], s64 offen offset:0 lds
  buffer_load_dwordx4 v3, s[24:27], s65 offen offset:1024 lds
  buffer_load_dwordx4 v2, s[24:27], s66 offen offset:2048 lds
  s_add_u32 m0, s74, 51200
  s_nop 0
  buffer_load_dwordx4 v4, s[8:11], s71 offen offset:0 lds
  buffer_load_dwordx4 v4, s[8:11], s71 offen offset:1024 lds
  buffer_load_dwordx4 v4, s[8:11], s71 offen offset:2048 lds
  s_add_u32 m0, s77, 51200
  s_nop 0
  buffer_load_dwordx4 v7, s[24:27], s67 offen offset:0 lds
  buffer_load_dwordx4 v8, s[24:27], s68 offen offset:1024 lds
  s_mov_b32 s4, s36
  s_mov_b32 s5, s37
  s_mov_b32 s6, 0x200000
  s_mov_b32 s7, 0x20000
  s_add_u32 s28, s54, 0x100000
  s_addc_u32 s29, s55, 0
  s_mov_b32 s30, 0x200000
  s_mov_b32 s31, 0x20000
  s_mov_b32 s32, s52
  s_mov_b32 s33, s53
  s_mov_b32 s34, 0x100
  s_mov_b32 s35, 0x20000
  s_waitcnt vmcnt(8)
  s_nop 0
  s_branch L_latt
L_lffn:
  s_barrier
  s_add_u32 m0, s77, 51200
  s_nop 0
  buffer_load_dwordx4 v7, s[24:27], s69 offen offset:2048 lds
  s_add_u32 m0, s78, 51200
  s_nop 0
  buffer_load_dwordx4 v4, s[12:15], s71 offen offset:0 lds
  buffer_load_dwordx4 v5, s[12:15], s71 offen offset:1024 lds
  buffer_load_dwordx4 v6, s[12:15], s71 offen offset:2048 lds
  s_add_u32 s71, s71, 176128
  v_add_u32 v2, 128, v2
  v_add_u32 v3, 128, v3
  v_add_u32 v7, 128, v7
  v_add_u32 v8, 128, v8
  s_add_u32 m0, s73, 102400
  s_nop 0
  buffer_load_dwordx4 v2, s[24:27], s64 offen offset:0 lds
  buffer_load_dwordx4 v3, s[24:27], s65 offen offset:1024 lds
  buffer_load_dwordx4 v2, s[24:27], s66 offen offset:2048 lds
  s_add_u32 m0, s74, 102400
  s_nop 0
  buffer_load_dwordx4 v4, s[8:11], s71 offen offset:0 lds
  buffer_load_dwordx4 v5, s[8:11], s71 offen offset:1024 lds
  buffer_load_dwordx4 v6, s[8:11], s71 offen offset:2048 lds
  s_add_u32 m0, s77, 102400
  s_nop 0
  buffer_load_dwordx4 v7, s[24:27], s67 offen offset:0 lds
  buffer_load_dwordx4 v8, s[24:27], s68 offen offset:1024 lds
  s_cmp_eq_u32 s56, 0
  s_cselect_b32 s72, 0, 0x7f000000
  v_mov_b32 v26, 0
  buffer_load_dword v27, v26, s[32:35], s72 offen sc1
  s_waitcnt vmcnt(9)
  s_nop 0
  s_barrier
  s_add_u32 m0, s77, 102400
  s_nop 0
  buffer_load_dwordx4 v7, s[24:27], s69 offen offset:2048 lds
  s_add_u32 m0, s78, 102400
  s_nop 0
  buffer_load_dwordx4 v4, s[12:15], s71 offen offset:0 lds
  buffer_load_dwordx4 v5, s[12:15], s71 offen offset:1024 lds
  buffer_load_dwordx4 v6, s[12:15], s71 offen offset:2048 lds
  s_add_u32 s71, s71, 176128
  v_add_u32 v2, 128, v2
  v_add_u32 v3, 128, v3
  v_add_u32 v7, 128, v7
  v_add_u32 v8, 128, v8
  s_add_u32 m0, s73, 0
  s_nop 0
  buffer_load_dwordx4 v2, s[24:27], s64 offen offset:0 lds
  buffer_load_dwordx4 v3, s[24:27], s65 offen offset:1024 lds
  buffer_load_dwordx4 v2, s[24:27], s66 offen offset:2048 lds
  s_add_u32 m0, s74, 0
  s_nop 0
  buffer_load_dwordx4 v4, s[8:11], s71 offen offset:0 lds
  buffer_load_dwordx4 v5, s[8:11], s71 offen offset:1024 lds
  buffer_load_dwordx4 v6, s[8:11], s71 offen offset:2048 lds
  s_add_u32 m0, s77, 0
  s_nop 0
  buffer_load_dwordx4 v7, s[24:27], s67 offen offset:0 lds
  buffer_load_dwordx4 v8, s[24:27], s68 offen offset:1024 lds
  s_waitcnt vmcnt(8)
  s_nop 0
  s_cmp_lg_u32 s56, 0
  s_cbranch_scc1 L_tokffn
  v_readfirstlane_b32 s3, v27
  s_mov_b32 s61, 0
  s_nop 1
  s_cmp_lg_u32 s3, 0
  s_cbranch_scc1 L_tgotffn
L_tspinffn:
  s_sleep 2
  buffer_load_dword v27, v26, s[32:35], 0 offen sc1
  s_add_u32 s61, s61, 1
  s_waitcnt vmcnt(0)
  v_readfirstlane_b32 s3, v27
  s_cmp_ge_u32 s61, 40000
  s_cbranch_scc1 L_tgotffn
  s_cmp_eq_u32 s3, 0
  s_cbranch_scc1 L_tspinffn
L_tgotffn:
  v_mov_b32 v26, 155664
  v_mov_b32 v27, s3
  ds_write_b32 v26, v27
  s_waitcnt lgkmcnt(0)
L_tokffn:
  s_barrier
  s_add_u32 m0, s77, 0
  s_nop 0
  buffer_load_dwordx4 v7, s[24:27], s69 offen offset:2048 lds
  s_add_u32 m0, s78, 0
  s_nop 0
  buffer_load_dwordx4 v4, s[12:15], s71 offen offset:0 lds
  buffer_load_dwordx4 v5, s[12:15], s71 offen offset:1024 lds
  buffer_load_dwordx4 v6, s[12:15], s71 offen offset:2048 lds
  s_add_u32 s71, s71, 176128
  v_add_u32 v2, 128, v2
  v_add_u32 v3, 128, v3
  v_add_u32 v7, 128, v7
  v_add_u32 v8, 128, v8
  s_add_u32 m0, s73, 51200
  s_nop 0
  buffer_load_dwordx4 v2, s[24:27], s64 offen offset:0 lds
  buffer_load_dwordx4 v3, s[24:27], s65 offen offset:1024 lds
  buffer_load_dwordx4 v2, s[24:27], s66 offen offset:2048 lds
  s_add_u32 m0, s74, 51200
  s_nop 0
  buffer_load_dwordx4 v4, s[8:11], s71 offen offset:0 lds
  buffer_load_dwordx4 v5, s[8:11], s71 offen offset:1024 lds
  buffer_load_dwordx4 v6, s[8:11], s71 offen offset:2048 lds
  s_add_u32 m0, s77, 51200
  s_nop 0
  buffer_load_dwordx4 v7, s[24:27], s67 offen offset:0 lds
  buffer_load_dwordx4 v8, s[24:27], s68 offen offset:1024 lds
  s_cmp_lg_u32 s56, 0
  s_cbranch_scc1 L_pubffn
  v_lshlrev_b32 v26, 2, v1
  v_add_u32 v26, 155680, v26
  s_mov_b64 exec, 0xff
  ds_read_b32 v28, v26
  v_mov_b32 v29, s3
  v_lshlrev_b32 v26, 3, v1
  s_lshl_b32 s60, s2, 6
  s_waitcnt lgkmcnt(0)
  buffer_store_dwordx2 v[28:29], v26, s[28:31], s60 offen sc0 sc1
  s_mov_b64 exec, -1
L_pubffn:
  s_waitcnt vmcnt(8)
  s_nop 0
  s_barrier
  s_add_u32 m0, s77, 51200
  s_nop 0
  buffer_load_dwordx4 v7, s[24:27], s69 offen offset:2048 lds
  s_add_u32 m0, s78, 51200
  s_nop 0
  buffer_load_dwordx4 v4, s[12:15], s71 offen offset:0 lds
  buffer_load_dwordx4 v5, s[12:15], s71 offen offset:1024 lds
  buffer_load_dwordx4 v6, s[12:15], s71 offen offset:2048 lds
  s_add_u32 s71, s71, 176128
  v_add_u32 v2, 128, v2
  v_add_u32 v3, 128, v3
  v_add_u32 v7, 128, v7
  v_add_u32 v8, 128, v8
  s_add_u32 m0, s73, 102400
  s_nop 0
  buffer_load_dwordx4 v2, s[24:27], s64 offen offset:0 lds
  buffer_load_dwordx4 v3, s[24:27], s65 offen offset:1024 lds
  buffer_load_dwordx4 v2, s[24:27], s66 offen offset:2048 lds
  s_add_u32 m0, s74, 102400
  s_nop 0
  buffer_load_dwordx4 v4, s[8:11], s71 offen offset:0 lds
  buffer_load_dwordx4 v5, s[8:11], s71 offen offset:1024 lds
  buffer_load_dwordx4 v6, s[8:11], s71 offen offset:2048 lds
  s_add_u32 m0, s77, 102400
  s_nop 0
  buffer_load_dwordx4 v7, s[24:27], s67 offen offset:0 lds
  buffer_load_dwordx4 v8, s[24:27], s68 offen offset:1024 lds
  s_waitcnt vmcnt(8)
  s_nop 0
  s_barrier
  s_add_u32 m0, s77, 102400
  s_nop 0
  buffer_load_dwordx4 v7, s[24:27], s69 offen offset:2048 lds
  s_add_u32 m0, s78, 102400
  s_nop 0
  buffer_load_dwordx4 v4, s[12:15], s71 offen offset:0 lds
  buffer_load_dwordx4 v5, s[12:15], s71 offen offset:1024 lds
  buffer_load_dwordx4 v6, s[12:15], s71 offen offset:2048 lds
  s_add_u32 s71, s71, 176128
  v_add_u32 v2, 128, v2
  v_add_u32 v3, 128, v3
  v_add_u32 v7, 128, v7
  v_add_u32 v8, 128, v8
  s_add_u32 m0, s73, 0
  s_nop 0
  buffer_load_dwordx4 v2, s[24:27], s64 offen offset:0 lds
  buffer_load_dwordx4 v3, s[24:27], s65 offen offset:1024 lds
  buffer_load_dwordx4 v2, s[24:27], s66 offen offset:2048 lds
  s_add_u32 m0, s74, 0
  s_nop 0
  buffer_load_dwordx4 v4, s[8:11], s71 offen offset:0 lds
  buffer_load_dwordx4 v5, s[8:11], s71 offen offset:1024 lds
  buffer_load_dwordx4 v6, s[8:11], s71 offen offset:2048 lds
  s_add_u32 m0, s77, 0
  s_nop 0
  buffer_load_dwordx4 v7, s[24:27], s67 offen offset:0 lds
  buffer_load_dwordx4 v8, s[24:27], s68 offen offset:1024 lds
  s_waitcnt vmcnt(8)
  s_nop 0
  s_barrier
  s_add_u32 m0, s77, 0
  s_nop 0
  buffer_load_dwordx4 v7, s[24:27], s69 offen offset:2048 lds
  s_add_u32 m0, s78, 0
  s_nop 0
  buffer_load_dwordx4 v4, s[12:15], s71 offen offset:0 lds
  buffer_load_dwordx4 v5, s[12:15], s71 offen offset:1024 lds
  buffer_load_dwordx4 v6, s[12:15], s71 offen offset:2048 lds
  s_add_u32 s71, s71, 176128
  v_add_u32 v2, 128, v2
  v_add_u32 v3, 128, v3
  v_add_u32 v7, 128, v7
  v_add_u32 v8, 128, v8
  s_add_u32 m0, s73, 51200
  s_nop 0
  buffer_load_dwordx4 v2, s[24:27], s64 offen offset:0 lds
  buffer_load_dwordx4 v3, s[24:27], s65 offen offset:1024 lds
  buffer_load_dwordx4 v2, s[24:27], s66 offen offset:2048 lds
  s_add_u32 m0, s74, 51200
  s_nop 0
  buffer_load_dwordx4 v4, s[8:11], s71 offen offset:0 lds
  buffer_load_dwordx4 v5, s[8:11], s71 offen offset:1024 lds
  buffer_load_dwordx4 v6, s[8:11], s71 offen offset:2048 lds
  s_add_u32 m0, s77, 51200
  s_nop 0
  buffer_load_dwordx4 v7, s[24:27], s67 offen offset:0 lds
  buffer_load_dwordx4 v8, s[24:27], s68 offen offset:1024 lds
  s_cmp_lg_u32 s56, 0
  s_cbranch_scc1 L_sfffn
  s_mul_i32 s60, s57, 192
  s_sub_u32 s60, s60, 16
  v_lshl_add_u32 v26, v1, 2, s60
  v_max_i32 v26, 0, v26
  v_min_u32 v26, 0x7fc, v26
  v_lshlrev_b32 v26, 3, v26
  buffer_load_dwordx4 v[28:31], v26, s[28:31], 0 offen sc1
  buffer_load_dwordx4 v[32:35], v26, s[28:31], 0 offen offset:16 sc1
L_sfffn:
  s_waitcnt vmcnt(8)
  s_nop 0
  s_barrier
  s_add_u32 m0, s77, 51200
  s_nop 0
  buffer_load_dwordx4 v7, s[24:27], s69 offen offset:2048 lds
  s_add_u32 m0, s78, 51200
  s_nop 0
  buffer_load_dwordx4 v4, s[12:15], s71 offen offset:0 lds
  buffer_load_dwordx4 v5, s[12:15], s71 offen offset:1024 lds
  buffer_load_dwordx4 v6, s[12:15], s71 offen offset:2048 lds
  s_lshr_b32 s60, s2, 3
  s_mul_i32 s60, s60, 59
  v_add_u32 v60, s60, v1
  v_cmp_gt_u32 vcc, 59, v1
  v_mov_b32 v61, 0x7f000000
  v_subrev_u32 v62, 512, v60
  v_lshlrev_b32 v60, 10, v60
  v_lshlrev_b32 v62, 10, v62
  v_cndmask_b32 v60, v61, v60, vcc
  v_cndmask_b32 v62, v61, v62, vcc
  v_min_u32 v62, v61, v62
  s_and_b32 s61, s2, 1
  s_lshl_b32 s61, s61, 2
  s_add_u32 s61, s61, s56
  s_lshl_b32 s61, s61, 7
  s_mov_b32 s20, s40
  s_mov_b32 s21, s41
  s_mov_b32 s22, 0x80000
  s_mov_b32 s23, 0x20000
  buffer_load_dword v49, v60, s[20:23], s61 offen
  s_mov_b32 s20, s48
  s_mov_b32 s21, s49
  s_mov_b32 s22, 0x158000
  s_mov_b32 s23, 0x20000
  buffer_load_dword v49, v62, s[20:23], s61 offen
  s_waitcnt vmcnt(2)
  s_nop 0
  s_cmp_lg_u32 s56, 0
  s_cbranch_scc1 L_scffn
  s_mov_b32 s61, 0
L_sspinffn:
  v_xor_b32 v36, s3, v29
  v_xor_b32 v37, s3, v31
  v_xor_b32 v38, s3, v33
  v_xor_b32 v39, s3, v35
  v_or_b32 v36, v36, v37
  v_or3_b32 v36, v36, v38, v39
  v_cmp_ne_u32 vcc, 0, v36
  s_add_u32 s61, s61, 1
  s_cmp_ge_u32 s61, 40000
  s_cbranch_scc1 L_sokffn
  s_nop 1
  s_cbranch_vccz L_sokffn
  s_sleep 2
  buffer_load_dwordx4 v[28:31], v26, s[28:31], 0 offen sc1
  buffer_load_dwordx4 v[32:35], v26, s[28:31], 0 offen offset:16 sc1
  s_waitcnt vmcnt(0)
  s_branch L_sspinffn
L_sokffn:
  v_and_b32 v40, 0xffff0000, v28
  v_lshlrev_b32 v36, 16, v28
  v_and_b32 v41, 0xffff0000, v30
  v_lshlrev_b32 v37, 16, v30
  v_and_b32 v42, 0xffff0000, v32
  v_lshlrev_b32 v38, 16, v32
  v_and_b32 v43, 0xffff0000, v34
  v_lshlrev_b32 v39, 16, v34
  v_rcp_f32 v40, v40
  v_xor_b32 v36, 0x80000000, v36
  v_rcp_f32 v41, v41
  v_xor_b32 v37, 0x80000000, v37
  v_rcp_f32 v42, v42
  v_xor_b32 v38, 0x80000000, v38
  v_rcp_f32 v43, v43
  v_xor_b32 v39, 0x80000000, v39
  v_lshlrev_b32 v26, 4, v1
  v_add_u32 v26, 153600, v26
  ds_write_b128 v26, v[36:39]
  ds_write_b128 v26, v[40:43] offset:1024
  v_mov_b32 v52, v36
  v_mov_b32 v53, v40
  v_mov_b32 v54, v37
  v_mov_b32 v55, v41
  v_mov_b32 v56, v38
  v_mov_b32 v57, v42
  v_mov_b32 v58, v39
  v_mov_b32 v59, v43
  v_lshlrev_b32 v26, 5, v1
  v_add_u32 v26, 159872, v26
  ds_write_b128 v26, v[52:55]
  ds_write_b128 v26, v[56:59] offset:16
  s_waitcnt lgkmcnt(0)
L_scffn:
  s_barrier
  s_and_b32 s60, s2, 6
  s_lshl_b32 s60, s60, 2
  s_lshr_b32 s61, s2, 5
  s_add_u32 s57, s60, s61
  s_and_b32 s60, s2, 1
  s_lshl_b32 s60, s60, 2
  s_bfe_u32 s61, s2, 0x20003
  s_add_u32 s58, s60, s61
  s_and_b32 s75, s58, 1
  s_mul_i32 s76, s56, 15
  s_lshl_b32 s77, s58, 7
  s_lshl_b32 s78, s75, 1
  s_add_u32 s61, s76, s78
  s_cmp_lt_u32 s61, 16
  s_cselect_b32 s20, s40, s48
  s_cselect_b32 s21, s41, s49
  s_mov_b32 s60, 0x80000
  s_cselect_b32 s22, s60, 0x158000
  s_mov_b32 s23, 0x20000
  s_cselect_b32 s60, 0, 16
  s_sub_u32 s61, s61, s60
  s_lshl_b32 s61, s61, 15
  s_add_u32 s64, s61, s77
  s_add_u32 s61, s76, 2
  s_sub_u32 s61, s61, s78
  s_cmp_lt_u32 s61, 16
  s_cselect_b32 s12, s40, s48
  s_cselect_b32 s13, s41, s49
  s_mov_b32 s60, 0x80000
  s_cselect_b32 s14, s60, 0x158000
  s_mov_b32 s15, 0x20000
  s_cselect_b32 s60, 0, 16
  s_sub_u32 s61, s61, s60
  s_lshl_b32 s61, s61, 15
  s_add_u32 s65, s61, s77
  s_add_u32 s61, s76, 1
  s_cmp_lt_u32 s61, 16
  s_cselect_b32 s24, s40, s48
  s_cselect_b32 s25, s41, s49
  s_mov_b32 s60, 0x80000
  s_cselect_b32 s26, s60, 0x158000
  s_mov_b32 s27, 0x20000
  s_cselect_b32 s60, 0, 16
  s_sub_u32 s61, s61, s60
  s_lshl_b32 s61, s61, 15
  s_add_u32 s72, s61, s77
  s_sub_u32 s72, s72, 0x8000
  s_lshl_b32 s60, s75, 16
  s_sub_u32 s73, s72, s60
  s_add_u32 s72, s72, s60
  s_sub_u32 s84, s72, s60
  s_mul_i32 s66, s56, 12288
  v_lshrrev_b32 v11, 3, v1
  v_lshrrev_b32 v12, 2, v11
  v_and_b32 v11, 3, v11
  v_lshl_add_u32 v11, v12, 3, v11
  v_lshrrev_b32 v12, 4, v1
  v_lshlrev_b32 v13, 1, v12
  v_and_b32 v14, 7, v1
  v_xor_b32 v14, v14, v13
  v_lshlrev_b32 v14, 4, v14
  v_lshl_add_u32 v2, v11, 10, v14
  s_add_u32 m0, s66, 102400
  s_add_u32 s60, s64, 0
  buffer_load_dwordx4 v2, s[20:23], s60 offen offset:0 lds
  s_add_u32 s60, s64, 3072
  buffer_load_dwordx4 v2, s[20:23], s60 offen offset:1024 lds
  s_add_u32 s60, s64, 14336
  buffer_load_dwordx4 v2, s[20:23], s60 offen offset:2048 lds
  s_add_u32 s60, s64, 17408
  buffer_load_dwordx4 v2, s[20:23], s60 offen offset:3072 lds
  s_add_u32 m0, s66, 106496
  s_add_u32 s60, s72, 32768
  buffer_load_dwordx4 v2, s[24:27], s60 offen offset:0 lds
  s_add_u32 s60, s72, 35840
  buffer_load_dwordx4 v2, s[24:27], s60 offen offset:1024 lds
  s_add_u32 s60, s72, 47104
  buffer_load_dwordx4 v2, s[24:27], s60 offen offset:2048 lds
  s_add_u32 s60, s72, 50176
  buffer_load_dwordx4 v2, s[24:27], s60 offen offset:3072 lds
  s_add_u32 m0, s66, 110592
  s_add_u32 s60, s65, 0
  buffer_load_dwordx4 v2, s[12:15], s60 offen offset:0 lds
  s_add_u32 s60, s65, 3072
  buffer_load_dwordx4 v2, s[12:15], s60 offen offset:1024 lds
  s_add_u32 s60, s65, 14336
  buffer_load_dwordx4 v2, s[12:15], s60 offen offset:2048 lds
  s_add_u32 s60, s65, 17408
  buffer_load_dwordx4 v2, s[12:15], s60 offen offset:3072 lds
  s_branch L_lw2
L_latt:
  s_barrier
  s_add_u32 m0, s77, 51200
  s_nop 0
  buffer_load_dwordx4 v7, s[24:27], s69 offen offset:2048 lds
  buffer_load_dwordx4 v8, s[24:27], s70 offen offset:3072 lds
  s_add_u32 m0, s78, 51200
  s_nop 0
  buffer_load_dwordx4 v5, s[8:11], s71 offen offset:0 lds
  buffer_load_dwordx4 v5, s[8:11], s71 offen offset:1024 lds
  buffer_load_dwordx4 v5, s[8:11], s71 offen offset:2048 lds
  s_add_u32 s71, s71, 196608
  v_add_u32 v2, 128, v2
  v_add_u32 v3, 128, v3
  v_add_u32 v7, 128, v7
  v_add_u32 v8, 128, v8
  s_add_u32 m0, s73, 102400
  s_nop 0
  buffer_load_dwordx4 v2, s[24:27], s64 offen offset:0 lds
  buffer_load_dwordx4 v3, s[24:27], s65 offen offset:1024 lds
  buffer_load_dwordx4 v2, s[24:27], s66 offen offset:2048 lds
  s_add_u32 m0, s74, 102400
  s_nop 0
  buffer_load_dwordx4 v4, s[8:11], s71 offen offset:0 lds
  buffer_load_dwordx4 v4, s[8:11], s71 offen offset:1024 lds
  buffer_load_dwordx4 v4, s[8:11], s71 offen offset:2048 lds
  s_add_u32 m0, s77, 102400
  s_nop 0
  buffer_load_dwordx4 v7, s[24:27], s67 offen offset:0 lds
  buffer_load_dwordx4 v8, s[24:27], s68 offen offset:1024 lds
  s_cmp_eq_u32 s56, 0
  s_cselect_b32 s72, 0, 0x7f000000
  v_mov_b32 v26, 0
  buffer_load_dword v27, v26, s[32:35], s72 offen sc1
  s_waitcnt vmcnt(9)
  s_nop 0
  s_barrier
  s_add_u32 m0, s77, 102400
  s_nop 0
  buffer_load_dwordx4 v7, s[24:27], s69 offen offset:2048 lds
  buffer_load_dwordx4 v8, s[24:27], s70 offen offset:3072 lds
  s_add_u32 m0, s78, 102400
  s_nop 0
  buffer_load_dwordx4 v5, s[8:11], s71 offen offset:0 lds
  buffer_load_dwordx4 v5, s[8:11], s71 offen offset:1024 lds
  buffer_load_dwordx4 v5, s[8:11], s71 offen offset:2048 lds
  s_add_u32 s71, s71, 196608
  v_add_u32 v2, 128, v2
  v_add_u32 v3, 128, v3
  v_add_u32 v7, 128, v7
  v_add_u32 v8, 128, v8
  s_add_u32 m0, s73, 0
  s_nop 0
  buffer_load_dwordx4 v2, s[24:27], s64 offen offset:0 lds
  buffer_load_dwordx4 v3, s[24:27], s65 offen offset:1024 lds
  buffer_load_dwordx4 v2, s[24:27], s66 offen offset:2048 lds
  s_add_u32 m0, s74, 0
  s_nop 0
  buffer_load_dwordx4 v4, s[8:11], s71 offen offset:0 lds
  buffer_load_dwordx4 v4, s[8:11], s71 offen offset:1024 lds
  buffer_load_dwordx4 v4, s[8:11], s71 offen offset:2048 lds
  s_add_u32 m0, s77, 0
  s_nop 0
  buffer_load_dwordx4 v7, s[24:27], s67 offen offset:0 lds
  buffer_load_dwordx4 v8, s[24:27], s68 offen offset:1024 lds
  s_waitcnt vmcnt(8)
  s_nop 0
  s_cmp_lg_u32 s56, 0
  s_cbranch_scc1 L_tokatt
  v_readfirstlane_b32 s3, v27
  s_mov_b32 s61, 0
  s_nop 1
  s_cmp_lg_u32 s3, 0
  s_cbranch_scc1 L_tgotatt
L_tspinatt:
  s_sleep 2
  buffer_load_dword v27, v26, s[32:35], 0 offen sc1
  s_add_u32 s61, s61, 1
  s_waitcnt vmcnt(0)
  v_readfirstlane_b32 s3, v27
  s_cmp_ge_u32 s61, 40000
  s_cbranch_scc1 L_tgotatt
  s_cmp_eq_u32 s3, 0
  s_cbranch_scc1 L_tspinatt
L_tgotatt:
  v_mov_b32 v26, 155664
  v_mov_b32 v27, s3
  ds_write_b32 v26, v27
  s_waitcnt lgkmcnt(0)
L_tokatt:
  s_barrier
  s_add_u32 m0, s77, 0
  s_nop 0
  buffer_load_dwordx4 v7, s[24:27], s69 offen offset:2048 lds
  buffer_load_dwordx4 v8, s[24:27], s70 offen offset:3072 lds
  s_add_u32 m0, s78, 0
  s_nop 0
  buffer_load_dwordx4 v5, s[8:11], s71 offen offset:0 lds
  buffer_load_dwordx4 v5, s[8:11], s71 offen offset:1024 lds
  buffer_load_dwordx4 v5, s[8:11], s71 offen offset:2048 lds
  s_add_u32 s71, s71, 196608
  v_add_u32 v2, 128, v2
  v_add_u32 v3, 128, v3
  v_add_u32 v7, 128, v7
  v_add_u32 v8, 128, v8
  s_add_u32 m0, s73, 51200
  s_nop 0
  buffer_load_dwordx4 v2, s[24:27], s64 offen offset:0 lds
  buffer_load_dwordx4 v3, s[24:27], s65 offen offset:1024 lds
  buffer_load_dwordx4 v2, s[24:27], s66 offen offset:2048 lds
  s_add_u32 m0, s74, 51200
  s_nop 0
  buffer_load_dwordx4 v4, s[8:11], s71 offen offset:0 lds
  buffer_load_dwordx4 v4, s[8:11], s71 offen offset:1024 lds
  buffer_load_dwordx4 v4, s[8:11], s71 offen offset:2048 lds
  s_add_u32 m0, s77, 51200
  s_nop 0
  buffer_load_dwordx4 v7, s[24:27], s67 offen offset:0 lds
  buffer_load_dwordx4 v8, s[24:27], s68 offen offset:1024 lds
  s_cmp_lg_u32 s56, 0
  s_cbranch_scc1 L_pubatt
  v_lshlrev_b32 v26, 2, v1
  v_add_u32 v26, 155680, v26
  s_mov_b64 exec, 0xff
  ds_read_b32 v28, v26
  v_mov_b32 v29, s3
  v_lshlrev_b32 v26, 3, v1
  s_lshl_b32 s60, s2, 6
  s_waitcnt lgkmcnt(0)
  buffer_store_dwordx2 v[28:29], v26, s[28:31], s60 offen sc0 sc1
  s_mov_b64 exec, -1
L_pubatt:
  s_waitcnt vmcnt(8)
  s_nop 0
  s_barrier
  s_add_u32 m0, s77, 51200
  s_nop 0
  buffer_load_dwordx4 v7, s[24:27], s69 offen offset:2048 lds
  buffer_load_dwordx4 v8, s[24:27], s70 offen offset:3072 lds
  s_add_u32 m0, s78, 51200
  s_nop 0
  buffer_load_dwordx4 v5, s[8:11], s71 offen offset:0 lds
  buffer_load_dwordx4 v5, s[8:11], s71 offen offset:1024 lds
  buffer_load_dwordx4 v5, s[8:11], s71 offen offset:2048 lds
  s_add_u32 s71, s71, 196608
  v_add_u32 v2, 128, v2
  v_add_u32 v3, 128, v3
  v_add_u32 v7, 128, v7
  v_add_u32 v8, 128, v8
  s_add_u32 m0, s73, 102400
  s_nop 0
  buffer_load_dwordx4 v2, s[24:27], s64 offen offset:0 lds
  buffer_load_dwordx4 v3, s[24:27], s65 offen offset:1024 lds
  buffer_load_dwordx4 v2, s[24:27], s66 offen offset:2048 lds
  s_add_u32 m0, s74, 102400
  s_nop 0
  buffer_load_dwordx4 v4, s[8:11], s71 offen offset:0 lds
  buffer_load_dwordx4 v4, s[8:11], s71 offen offset:1024 lds
  buffer_load_dwordx4 v4, s[8:11], s71 offen offset:2048 lds
  s_add_u32 m0, s77, 102400
  s_nop 0
  buffer_load_dwordx4 v7, s[24:27], s67 offen offset:0 lds
  buffer_load_dwordx4 v8, s[24:27], s68 offen offset:1024 lds
  s_waitcnt vmcnt(8)
  s_nop 0
  s_barrier
  s_add_u32 m0, s77, 102400
  s_nop 0
  buffer_load_dwordx4 v7, s[24:27], s69 offen offset:2048 lds
  buffer_load_dwordx4 v8, s[24:27], s70 offen offset:3072 lds
  s_add_u32 m0, s78, 102400
  s_nop 0
  buffer_load_dwordx4 v5, s[8:11], s71 offen offset:0 lds
  buffer_load_dwordx4 v5, s[8:11], s71 offen offset:1024 lds
  buffer_load_dwordx4 v5, s[8:11], s71 offen offset:2048 lds
  s_add_u32 s71, s71, 196608
  v_add_u32 v2, 128, v2
  v_add_u32 v3, 128, v3
  v_add_u32 v7, 128, v7
  v_add_u32 v8, 128, v8
  s_add_u32 m0, s73, 0
  s_nop 0
  buffer_load_dwordx4 v2, s[24:27], s64 offen offset:0 lds
  buffer_load_dwordx4 v3, s[24:27], s65 offen offset:1024 lds
  buffer_load_dwordx4 v2, s[24:27], s66 offen offset:2048 lds
  s_add_u32 m0, s74, 0
  s_nop 0
  buffer_load_dwordx4 v4, s[8:11], s71 offen offset:0 lds
  buffer_load_dwordx4 v4, s[8:11], s71 offen offset:1024 lds
  buffer_load_dwordx4 v4, s[8:11], s71 offen offset:2048 lds
  s_add_u32 m0, s77, 0
  s_nop 0
  buffer_load_dwordx4 v7, s[24:27], s67 offen offset:0 lds
  buffer_load_dwordx4 v8, s[24:27], s68 offen offset:1024 lds
  s_waitcnt vmcnt(8)
  s_nop 0
  s_barrier
  s_add_u32 m0, s77, 0
  s_nop 0
  buffer_load_dwordx4 v7, s[24:27], s69 offen offset:2048 lds
  buffer_load_dwordx4 v8, s[24:27], s70 offen offset:3072 lds
  s_add_u32 m0, s78, 0
  s_nop 0
  buffer_load_dwordx4 v5, s[8:11], s71 offen offset:0 lds
  buffer_load_dwordx4 v5, s[8:11], s71 offen offset:1024 lds
  buffer_load_dwordx4 v5, s[8:11], s71 offen offset:2048 lds
  s_add_u32 s71, s71, 196608
  v_add_u32 v2, 128, v2
  v_add_u32 v3, 128, v3
  v_add_u32 v7, 128, v7
  v_add_u32 v8, 128, v8
  s_add_u32 m0, s73, 51200
  s_nop 0
  buffer_load_dwordx4 v2, s[24:27], s64 offen offset:0 lds
  buffer_load_dwordx4 v3, s[24:27], s65 offen offset:1024 lds
  buffer_load_dwordx4 v2, s[24:27], s66 offen offset:2048 lds
  s_add_u32 m0, s74, 51200
  s_nop 0
  buffer_load_dwordx4 v4, s[8:11], s71 offen offset:0 lds
  buffer_load_dwordx4 v4, s[8:11], s71 offen offset:1024 lds
  buffer_load_dwordx4 v4, s[8:11], s71 offen offset:2048 lds
  s_add_u32 m0, s77, 51200
  s_nop 0
  buffer_load_dwordx4 v7, s[24:27], s67 offen offset:0 lds
  buffer_load_dwordx4 v8, s[24:27], s68 offen offset:1024 lds
  s_cmp_lg_u32 s56, 0
  s_cbranch_scc1 L_sfatt
  s_mul_i32 s60, s57, 192
  s_sub_u32 s60, s60, 16
  v_lshl_add_u32 v26, v1, 2, s60
  v_max_i32 v26, 0, v26
  v_min_u32 v26, 0x7fc, v26
  v_lshlrev_b32 v26, 3, v26
  buffer_load_dwordx4 v[28:31], v26, s[28:31], 0 offen sc1
  buffer_load_dwordx4 v[32:35], v26, s[28:31], 0 offen offset:16 sc1
L_sfatt:
  s_waitcnt vmcnt(8)
  s_nop 0
  s_barrier
  s_add_u32 m0, s77, 51200
  s_nop 0
  buffer_load_dwordx4 v7, s[24:27], s69 offen offset:2048 lds
  buffer_load_dwordx4 v8, s[24:27], s70 offen offset:3072 lds
  s_add_u32 m0, s78, 51200
  s_nop 0
  buffer_load_dwordx4 v5, s[8:11], s71 offen offset:0 lds
  buffer_load_dwordx4 v5, s[8:11], s71 offen offset:1024 lds
  buffer_load_dwordx4 v5, s[8:11], s71 offen offset:2048 lds
  s_lshr_b32 s60, s2, 3
  s_mul_i32 s60, s60, 59
  v_add_u32 v60, s60, v1
  v_cmp_gt_u32 vcc, 59, v1
  v_mov_b32 v61, 0x7f000000
  v_subrev_u32 v62, 512, v60
  v_lshlrev_b32 v60, 10, v60
  v_lshlrev_b32 v62, 10, v62
  v_cndmask_b32 v60, v61, v60, vcc
  v_cndmask_b32 v62, v61, v62, vcc
  v_min_u32 v62, v61, v62
  s_and_b32 s61, s2, 1
  s_lshl_b32 s61, s61, 2
  s_add_u32 s61, s61, s56
  s_lshl_b32 s61, s61, 7
  s_mov_b32 s20, s40
  s_mov_b32 s21, s41
  s_mov_b32 s22, 0x80000
  s_mov_b32 s23, 0x20000
  buffer_load_dword v49, v60, s[20:23], s61 offen
  s_mov_b32 s20, s48
  s_mov_b32 s21, s49
  s_mov_b32 s22, 0x158000
  s_mov_b32 s23, 0x20000
  buffer_load_dword v49, v62, s[20:23], s61 offen
  s_waitcnt vmcnt(2)
  s_nop 0
  s_cmp_lg_u32 s56, 0
  s_cbranch_scc1 L_scatt
  s_mov_b32 s61, 0
L_sspinatt:
  v_xor_b32 v36, s3, v29
  v_xor_b32 v37, s3, v31
  v_xor_b32 v38, s3, v33
  v_xor_b32 v39, s3, v35
  v_or_b32 v36, v36, v37
  v_or3_b32 v36, v36, v38, v39
  v_cmp_ne_u32 vcc, 0, v36
  s_add_u32 s61, s61, 1
  s_cmp_ge_u32 s61, 40000
  s_cbranch_scc1 L_sokatt
  s_nop 1
  s_cbranch_vccz L_sokatt
  s_sleep 2
  buffer_load_dwordx4 v[28:31], v26, s[28:31], 0 offen sc1
  buffer_load_dwordx4 v[32:35], v26, s[28:31], 0 offen offset:16 sc1
  s_waitcnt vmcnt(0)
  s_branch L_sspinatt
L_sokatt:
  v_and_b32 v40, 0xffff0000, v28
  v_lshlrev_b32 v36, 16, v28
  v_and_b32 v41, 0xffff0000, v30
  v_lshlrev_b32 v37, 16, v30
  v_and_b32 v42, 0xffff0000, v32
  v_lshlrev_b32 v38, 16, v32
  v_and_b32 v43, 0xffff0000, v34
  v_lshlrev_b32 v39, 16, v34
  v_rcp_f32 v40, v40
  v_xor_b32 v36, 0x80000000, v36
  v_rcp_f32 v41, v41
  v_xor_b32 v37, 0x80000000, v37
  v_rcp_f32 v42, v42
  v_xor_b32 v38, 0x80000000, v38
  v_rcp_f32 v43, v43
  v_xor_b32 v39, 0x80000000, v39
  v_lshlrev_b32 v26, 4, v1
  v_add_u32 v26, 153600, v26
  ds_write_b128 v26, v[36:39]
  ds_write_b128 v26, v[40:43] offset:1024
  v_mov_b32 v52, v36
  v_mov_b32 v53, v40
  v_mov_b32 v54, v37
  v_mov_b32 v55, v41
  v_mov_b32 v56, v38
  v_mov_b32 v57, v42
  v_mov_b32 v58, v39
  v_mov_b32 v59, v43
  v_lshlrev_b32 v26, 5, v1
  v_add_u32 v26, 159872, v26
  ds_write_b128 v26, v[52:55]
  ds_write_b128 v26, v[56:59] offset:16
  s_waitcnt lgkmcnt(0)
L_scatt:
  s_barrier
  s_and_b32 s60, s2, 6
  s_lshl_b32 s60, s60, 2
  s_lshr_b32 s61, s2, 5
  s_add_u32 s57, s60, s61
  s_and_b32 s60, s2, 1
  s_lshl_b32 s60, s60, 2
  s_bfe_u32 s61, s2, 0x20003
  s_add_u32 s58, s60, s61
  s_and_b32 s75, s58, 1
  s_mul_i32 s76, s56, 15
  s_lshl_b32 s77, s58, 7
  s_lshl_b32 s78, s75, 1
  s_add_u32 s61, s76, s78
  s_cmp_lt_u32 s61, 16
  s_cselect_b32 s20, s40, s48
  s_cselect_b32 s21, s41, s49
  s_mov_b32 s60, 0x80000
  s_cselect_b32 s22, s60, 0x158000
  s_mov_b32 s23, 0x20000
  s_cselect_b32 s60, 0, 16
  s_sub_u32 s61, s61, s60
  s_lshl_b32 s61, s61, 15
  s_add_u32 s64, s61, s77
  s_add_u32 s61, s76, 2
  s_sub_u32 s61, s61, s78
  s_cmp_lt_u32 s61, 16
  s_cselect_b32 s12, s40, s48
  s_cselect_b32 s13, s41, s49
  s_mov_b32 s60, 0x80000
  s_cselect_b32 s14, s60, 0x158000
  s_mov_b32 s15, 0x20000
  s_cselect_b32 s60, 0, 16
  s_sub_u32 s61, s61, s60
  s_lshl_b32 s61, s61, 15
  s_add_u32 s65, s61, s77
  s_add_u32 s61, s76, 1
  s_cmp_lt_u32 s61, 16
  s_cselect_b32 s24, s40, s48
  s_cselect_b32 s25, s41, s49
  s_mov_b32 s60, 0x80000
  s_cselect_b32 s26, s60, 0x158000
  s_mov_b32 s27, 0x20000
  s_cselect_b32 s60, 0, 16
  s_sub_u32 s61, s61, s60
  s_lshl_b32 s61, s61, 15
  s_add_u32 s72, s61, s77
  s_sub_u32 s72, s72, 0x8000
  s_lshl_b32 s60, s75, 16
  s_sub_u32 s73, s72, s60
  s_add_u32 s72, s72, s60
  s_sub_u32 s84, s72, s60
  s_mul_i32 s66, s56, 12288
  v_lshrrev_b32 v11, 3, v1
  v_lshrrev_b32 v12, 2, v11
  v_and_b32 v11, 3, v11
  v_lshl_add_u32 v11, v12, 3, v11
  v_lshrrev_b32 v12, 4, v1
  v_lshlrev_b32 v13, 1, v12
  v_and_b32 v14, 7, v1
  v_xor_b32 v14, v14, v13
  v_lshlrev_b32 v14, 4, v14
  v_lshl_add_u32 v2, v11, 10, v14
  s_add_u32 m0, s66, 102400
  s_add_u32 s60, s64, 0
  buffer_load_dwordx4 v2, s[20:23], s60 offen offset:0 lds
  s_add_u32 s60, s64, 3072
  buffer_load_dwordx4 v2, s[20:23], s60 offen offset:1024 lds
  s_add_u32 s60, s64, 14336
  buffer_load_dwordx4 v2, s[20:23], s60 offen offset:2048 lds
  s_add_u32 s60, s64, 17408
  buffer_load_dwordx4 v2, s[20:23], s60 offen offset:3072 lds
  s_add_u32 m0, s66, 106496
  s_add_u32 s60, s72, 32768
  buffer_load_dwordx4 v2, s[24:27], s60 offen offset:0 lds
  s_add_u32 s60, s72, 35840
  buffer_load_dwordx4 v2, s[24:27], s60 offen offset:1024 lds
  s_add_u32 s60, s72, 47104
  buffer_load_dwordx4 v2, s[24:27], s60 offen offset:2048 lds
  s_add_u32 s60, s72, 50176
  buffer_load_dwordx4 v2, s[24:27], s60 offen offset:3072 lds
  s_add_u32 m0, s66, 110592
  s_add_u32 s60, s65, 0
  buffer_load_dwordx4 v2, s[12:15], s60 offen offset:0 lds
  s_add_u32 s60, s65, 3072
  buffer_load_dwordx4 v2, s[12:15], s60 offen offset:1024 lds
  s_add_u32 s60, s65, 14336
  buffer_load_dwordx4 v2, s[12:15], s60 offen offset:2048 lds
  s_add_u32 s60, s65, 17408
  buffer_load_dwordx4 v2, s[12:15], s60 offen offset:3072 lds
L_lw2:
  s_barrier
L_lw2b:
  s_add_u32 m0, s66, 0
  s_add_u32 s60, s73, 98304
  buffer_load_dwordx4 v2, s[24:27], s60 offen offset:0 lds
  s_add_u32 s60, s73, 101376
  buffer_load_dwordx4 v2, s[24:27], s60 offen offset:1024 lds
  s_add_u32 s60, s73, 112640
  buffer_load_dwordx4 v2, s[24:27], s60 offen offset:2048 lds
  s_add_u32 s60, s73, 115712
  buffer_load_dwordx4 v2, s[24:27], s60 offen offset:3072 lds
  s_add_u32 m0, s66, 4096
  s_add_u32 s60, s72, 131072
  buffer_load_dwordx4 v2, s[24:27], s60 offen offset:0 lds
  s_add_u32 s60, s72, 134144
  buffer_load_dwordx4 v2, s[24:27], s60 offen offset:1024 lds
  s_add_u32 s60, s72, 145408
  buffer_load_dwordx4 v2, s[24:27], s60 offen offset:2048 lds
  s_add_u32 s60, s72, 148480
  buffer_load_dwordx4 v2, s[24:27], s60 offen offset:3072 lds
  s_add_u32 m0, s66, 8192
  s_add_u32 s60, s72, 163840
  buffer_load_dwordx4 v2, s[24:27], s60 offen offset:0 lds
  s_add_u32 s60, s72, 166912
  buffer_load_dwordx4 v2, s[24:27], s60 offen offset:1024 lds
  s_add_u32 s60, s72, 178176
  buffer_load_dwordx4 v2, s[24:27], s60 offen offset:2048 lds
  s_add_u32 s60, s72, 181248
  buffer_load_dwordx4 v2, s[24:27], s60 offen offset:3072 lds
  s_add_u32 m0, s66, 51200
  s_add_u32 s60, s73, 196608
  buffer_load_dwordx4 v2, s[24:27], s60 offen offset:0 lds
  s_add_u32 s60, s73, 199680
  buffer_load_dwordx4 v2, s[24:27], s60 offen offset:1024 lds
  s_add_u32 s60, s73, 210944
  buffer_load_dwordx4 v2, s[24:27], s60 offen offset:2048 lds
  s_add_u32 s60, s73, 214016
  buffer_load_dwordx4 v2, s[24:27], s60 offen offset:3072 lds
  s_add_u32 m0, s66, 55296
  s_add_u32 s60, s73, 229376
  buffer_load_dwordx4 v2, s[24:27], s60 offen offset:0 lds
  s_add_u32 s60, s73, 232448
  buffer_load_dwordx4 v2, s[24:27], s60 offen offset:1024 lds
  s_add_u32 s60, s73, 243712
  buffer_load_dwordx4 v2, s[24:27], s60 offen offset:2048 lds
  s_add_u32 s60, s73, 246784
  buffer_load_dwordx4 v2, s[24:27], s60 offen offset:3072 lds
  s_add_u32 m0, s66, 59392
  s_add_u32 s60, s72, 262144
  buffer_load_dwordx4 v2, s[24:27], s60 offen offset:0 lds
  s_add_u32 s60, s72, 265216
  buffer_load_dwordx4 v2, s[24:27], s60 offen offset:1024 lds
  s_add_u32 s60, s72, 276480
  buffer_load_dwordx4 v2, s[24:27], s60 offen offset:2048 lds
  s_add_u32 s60, s72, 279552
  buffer_load_dwordx4 v2, s[24:27], s60 offen offset:3072 lds
  s_waitcnt vmcnt(0)
  s_barrier
  s_branch L_fin
L_lidle:
  s_mov_b32 s4, s36
  s_mov_b32 s5, s37
  s_mov_b32 s6, 0x200000
  s_mov_b32 s7, 0x20000
  s_add_u32 s28, s54, 0x100000
  s_addc_u32 s29, s55, 0
  s_mov_b32 s30, 0x200000
  s_mov_b32 s31, 0x20000
  s_mov_b32 s32, s52
  s_mov_b32 s33, s53
  s_mov_b32 s34, 0x100
  s_mov_b32 s35, 0x20000
  s_bitcmp1_b32 s59, 6
  s_cbranch_scc0 L_nopub
  s_cmp_lg_u32 s56, 0
  s_cbranch_scc1 L_nopub
  v_mov_b32 v25, 0
  s_mov_b32 s60, 0x80000
  s_mov_b64 exec, 1
  buffer_load_dword v24, v25, s[28:31], s60 offen sc0 sc1
  s_waitcnt vmcnt(0)
  v_add_u32 v24, 0x9e3779b9, v24
  v_max_u32 v24, 1, v24
  buffer_store_dword v24, v25, s[32:35], 0 offen sc0 sc1
  buffer_store_dword v24, v25, s[28:31], s60 offen sc0 sc1
  s_mov_b64 exec, -1
L_nopub:
  v_mov_b32 v26, 155648
  v_mov_b32 v27, 0
  ds_write_b32 v26, v27 offset:0
  ds_write_b32 v26, v27 offset:4
  ds_write_b32 v26, v27 offset:8
  ds_write_b32 v26, v27 offset:12
  s_waitcnt lgkmcnt(0)
  s_cmp_eq_u32 s56, 0
  s_cselect_b32 s72, 0, 0x7f000000
  v_mov_b32 v26, 0
  buffer_load_dword v27, v26, s[32:35], s72 offen sc1
  s_waitcnt vmcnt(0)
  s_cmp_lg_u32 s56, 0
  s_cbranch_scc1 L_tokidle
  v_readfirstlane_b32 s3, v27
  s_mov_b32 s61, 0
  s_nop 1
  s_cmp_lg_u32 s3, 0
  s_cbranch_scc1 L_tgotidle
L_tspinidle:
  s_sleep 2
  buffer_load_dword v27, v26, s[32:35], 0 offen sc1
  s_add_u32 s61, s61, 1
  s_waitcnt vmcnt(0)
  v_readfirstlane_b32 s3, v27
  s_cmp_ge_u32 s61, 40000
  s_cbranch_scc1 L_tgotidle
  s_cmp_eq_u32 s3, 0
  s_cbranch_scc1 L_tspinidle
L_tgotidle:
  v_mov_b32 v26, 155664
  v_mov_b32 v27, s3
  ds_write_b32 v26, v27
  s_waitcnt lgkmcnt(0)
L_tokidle:
  s_barrier
  s_cmp_lg_u32 s56, 0
  s_cbranch_scc1 L_pubidle
  v_lshlrev_b32 v26, 2, v1
  v_add_u32 v26, 155680, v26
  s_mov_b64 exec, 0xff
  ds_read_b32 v28, v26
  v_mov_b32 v29, s3
  v_lshlrev_b32 v26, 3, v1
  s_lshl_b32 s60, s2, 6
  s_waitcnt lgkmcnt(0)
  buffer_store_dwordx2 v[28:29], v26, s[28:31], s60 offen sc0 sc1
  s_mov_b64 exec, -1
L_pubidle:
  s_and_b32 s60, s2, 6
  s_lshl_b32 s60, s60, 2
  s_lshr_b32 s61, s2, 5
  s_add_u32 s57, s60, s61
  s_and_b32 s60, s2, 1
  s_lshl_b32 s60, s60, 2
  s_bfe_u32 s61, s2, 0x20003
  s_add_u32 s58, s60, s61
  s_and_b32 s75, s58, 1
  s_mul_i32 s76, s56, 15
  s_lshl_b32 s77, s58, 7
  s_lshl_b32 s78, s75, 1
  s_add_u32 s61, s76, s78
  s_cmp_lt_u32 s61, 16
  s_cselect_b32 s20, s40, s48
  s_cselect_b32 s21, s41, s49
  s_mov_b32 s60, 0x80000
  s_cselect_b32 s22, s60, 0x158000
  s_mov_b32 s23, 0x20000
  s_cselect_b32 s60, 0, 16
  s_sub_u32 s61, s61, s60
  s_lshl_b32 s61, s61, 15
  s_add_u32 s64, s61, s77
  s_add_u32 s61, s76, 2
  s_sub_u32 s61, s61, s78
  s_cmp_lt_u32 s61, 16
  s_cselect_b32 s12, s40, s48
  s_cselect_b32 s13, s41, s49
  s_mov_b32 s60, 0x80000
  s_cselect_b32 s14, s60, 0x158000
  s_mov_b32 s15, 0x20000
  s_cselect_b32 s60, 0, 16
  s_sub_u32 s61, s61, s60
  s_lshl_b32 s61, s61, 15
  s_add_u32 s65, s61, s77
  s_add_u32 s61, s76, 1
  s_cmp_lt_u32 s61, 16
  s_cselect_b32 s24, s40, s48
  s_cselect_b32 s25, s41, s49
  s_mov_b32 s60, 0x80000
  s_cselect_b32 s26, s60, 0x158000
  s_mov_b32 s27, 0x20000
  s_cselect_b32 s60, 0, 16
  s_sub_u32 s61, s61, s60
  s_lshl_b32 s61, s61, 15
  s_add_u32 s72, s61, s77
  s_sub_u32 s72, s72, 0x8000
  s_lshl_b32 s60, s75, 16
  s_sub_u32 s73, s72, s60
  s_add_u32 s72, s72, s60
  s_sub_u32 s84, s72, s60
  s_mul_i32 s66, s56, 12288
  v_lshrrev_b32 v11, 3, v1
  v_lshrrev_b32 v12, 2, v11
  v_and_b32 v11, 3, v11
  v_lshl_add_u32 v11, v12, 3, v11
  v_lshrrev_b32 v12, 4, v1
  v_lshlrev_b32 v13, 1, v12
  v_and_b32 v14, 7, v1
  v_xor_b32 v14, v14, v13
  v_lshlrev_b32 v14, 4, v14
  v_lshl_add_u32 v2, v11, 10, v14
  s_add_u32 m0, s66, 102400
  s_add_u32 s60, s64, 0
  buffer_load_dwordx4 v2, s[20:23], s60 offen offset:0 lds
  s_add_u32 s60, s64, 3072
  buffer_load_dwordx4 v2, s[20:23], s60 offen offset:1024 lds
  s_add_u32 s60, s64, 14336
  buffer_load_dwordx4 v2, s[20:23], s60 offen offset:2048 lds
  s_add_u32 s60, s64, 17408
  buffer_load_dwordx4 v2, s[20:23], s60 offen offset:3072 lds
  s_add_u32 m0, s66, 106496
  s_add_u32 s60, s72, 32768
  buffer_load_dwordx4 v2, s[24:27], s60 offen offset:0 lds
  s_add_u32 s60, s72, 35840
  buffer_load_dwordx4 v2, s[24:27], s60 offen offset:1024 lds
  s_add_u32 s60, s72, 47104
  buffer_load_dwordx4 v2, s[24:27], s60 offen offset:2048 lds
  s_add_u32 s60, s72, 50176
  buffer_load_dwordx4 v2, s[24:27], s60 offen offset:3072 lds
  s_add_u32 m0, s66, 110592
  s_add_u32 s60, s65, 0
  buffer_load_dwordx4 v2, s[12:15], s60 offen offset:0 lds
  s_add_u32 s60, s65, 3072
  buffer_load_dwordx4 v2, s[12:15], s60 offen offset:1024 lds
  s_add_u32 s60, s65, 14336
  buffer_load_dwordx4 v2, s[12:15], s60 offen offset:2048 lds
  s_add_u32 s60, s65, 17408
  buffer_load_dwordx4 v2, s[12:15], s60 offen offset:3072 lds
  s_branch L_lw2b
L_compute:
  s_and_b32 s57, s59, 15
  s_bfe_u32 s58, s59, 0x50008
  s_waitcnt vmcnt(0)
  s_add_u32 s28, s54, 0x100000
  s_addc_u32 s29, s55, 0
  s_mov_b32 s30, 0x200000
  s_mov_b32 s31, 0x20000
  s_add_u32 s16, s54, 0x400000
  s_addc_u32 s17, s55, 0
  s_mov_b32 s18, 0x760000
  s_mov_b32 s19, 0x20000
  v_lshlrev_b32 v48, 16, v40
  v_and_b32 v49, 0xffff0000, v40
  v_lshlrev_b32 v50, 16, v41
  v_and_b32 v51, 0xffff0000, v41
  v_lshlrev_b32 v52, 16, v42
  v_and_b32 v53, 0xffff0000, v42
  v_lshlrev_b32 v54, 16, v43
  v_and_b32 v55, 0xffff0000, v43
  v_add_f32 v30, v48, v49
  v_add_f32 v30, v30, v50
  v_add_f32 v30, v30, v51
  v_add_f32 v30, v30, v52
  v_add_f32 v30, v30, v53
  v_add_f32 v30, v30, v54
  v_add_f32 v30, v30, v55
  v_lshlrev_b32 v56, 16, v44
  v_and_b32 v57, 0xffff0000, v44
  v_lshlrev_b32 v58, 16, v45
  v_and_b32 v59, 0xffff0000, v45
  v_lshlrev_b32 v60, 16, v46
  v_and_b32 v61, 0xffff0000, v46
  v_lshlrev_b32 v62, 16, v47
  v_and_b32 v63, 0xffff0000, v47
  v_add_f32 v31, v56, v57
  v_add_f32 v31, v31, v58
  v_add_f32 v31, v31, v59
  v_add_f32 v31, v31, v60
  v_add_f32 v31, v31, v61
  v_add_f32 v31, v31, v62
  v_add_f32 v31, v31, v63
  v_add_f32_dpp v30, v30, v30 quad_perm:[1,0,3,2] row_mask:0xf bank_mask:0xf
  s_nop 0
  v_add_f32_dpp v31, v31, v31 quad_perm:[1,0,3,2] row_mask:0xf bank_mask:0xf
  v_add_f32_dpp v30, v30, v30 quad_perm:[2,3,0,1] row_mask:0xf bank_mask:0xf
  s_nop 0
  v_add_f32_dpp v31, v31, v31 quad_perm:[2,3,0,1] row_mask:0xf bank_mask:0xf
  v_add_f32_dpp v30, v30, v30 row_half_mirror row_mask:0xf bank_mask:0xf
  s_nop 0
  v_add_f32_dpp v31, v31, v31 row_half_mirror row_mask:0xf bank_mask:0xf
  v_add_f32_dpp v30, v30, v30 row_mirror row_mask:0xf bank_mask:0xf
  s_nop 0
  v_add_f32_dpp v31, v31, v31 row_mirror row_mask:0xf bank_mask:0xf
  v_mov_b32 v34, v30
  v_mov_b32 v35, v31
  s_nop 0
  v_permlane16_swap_b32 v30, v34
  v_permlane16_swap_b32 v31, v35
  v_add_f32 v30, v30, v34
  v_add_f32 v31, v31, v35
  v_mov_b32 v34, v30
  v_mov_b32 v35, v31
  s_nop 0
  v_permlane32_swap_b32 v30, v34
  v_permlane32_swap_b32 v31, v35
  v_add_f32 v30, v30, v34
  v_add_f32 v31, v31, v35
  v_mul_f32 v30, 0x3b000000, v30
  v_mul_f32 v31, 0x3b000000, v31
  v_sub_f32 v34, v48, v30
  v_sub_f32 v35, v56, v31
  v_mul_f32 v32, v34, v34
  v_mul_f32 v33, v35, v35
  v_sub_f32 v34, v49, v30
  v_sub_f32 v35, v57, v31
  v_fmac_f32 v32, v34, v34
  v_fmac_f32 v33, v35, v35
  v_sub_f32 v34, v50, v30
  v_sub_f32 v35, v58, v31
  v_fmac_f32 v32, v34, v34
  v_fmac_f32 v33, v35, v35
  v_sub_f32 v34, v51, v30
  v_sub_f32 v35, v59, v31
  v_fmac_f32 v32, v34, v34
  v_fmac_f32 v33, v35, v35
  v_sub_f32 v34, v52, v30
  v_sub_f32 v35, v60, v31
  v_fmac_f32 v32, v34, v34
  v_fmac_f32 v33, v35, v35
  v_sub_f32 v34, v53, v30
  v_sub_f32 v35, v61, v31
  v_fmac_f32 v32, v34, v34
  v_fmac_f32 v33, v35, v35
  v_sub_f32 v34, v54, v30
  v_sub_f32 v35, v62, v31
  v_fmac_f32 v32, v34, v34
  v_fmac_f32 v33, v35, v35
  v_sub_f32 v34, v55, v30
  v_sub_f32 v35, v63, v31
  v_fmac_f32 v32, v34, v34
  v_fmac_f32 v33, v35, v35
  s_nop 0
  v_add_f32_dpp v32, v32, v32 quad_perm:[1,0,3,2] row_mask:0xf bank_mask:0xf
  v_add_f32_dpp v33, v33, v33 quad_perm:[1,0,3,2] row_mask:0xf bank_mask:0xf
  s_nop 0
  v_add_f32_dpp v32, v32, v32 quad_perm:[2,3,0,1] row_mask:0xf bank_mask:0xf
  v_add_f32_dpp v33, v33, v33 quad_perm:[2,3,0,1] row_mask:0xf bank_mask:0xf
  s_nop 0
  v_add_f32_dpp v32, v32, v32 row_half_mirror row_mask:0xf bank_mask:0xf
  v_add_f32_dpp v33, v33, v33 row_half_mirror row_mask:0xf bank_mask:0xf
  s_nop 0
  v_add_f32_dpp v32, v32, v32 row_mirror row_mask:0xf bank_mask:0xf
  v_add_f32_dpp v33, v33, v33 row_mirror row_mask:0xf bank_mask:0xf
  v_mov_b32 v34, v32
  v_mov_b32 v35, v33
  s_nop 0
  v_permlane16_swap_b32 v32, v34
  v_permlane16_swap_b32 v33, v35
  v_add_f32 v32, v32, v34
  v_add_f32 v33, v33, v35
  v_mov_b32 v34, v32
  v_mov_b32 v35, v33
  s_nop 0
  v_permlane32_swap_b32 v32, v34
  v_permlane32_swap_b32 v33, v35
  v_add_f32 v32, v32, v34
  v_add_f32 v33, v33, v35
  v_mul_f32 v32, 0x3b000000, v32
  v_mul_f32 v33, 0x3b000000, v33
  v_cvt_pk_bf16_f32 v32, v32, v32
  v_cvt_pk_bf16_f32 v33, v33, v33
  v_lshlrev_b32 v32, 16, v32
  v_lshlrev_b32 v33, 16, v33
  v_add_f32 v32, 0x3727c5ac, v32
  v_add_f32 v33, 0x3727c5ac, v33
  v_cvt_pk_bf16_f32 v32, v32, v32
  v_cvt_pk_bf16_f32 v33, v33, v33
  v_lshlrev_b32 v32, 16, v32
  v_lshlrev_b32 v33, 16, v33
  v_sqrt_f32 v32, v32
  v_sqrt_f32 v33, v33
  v_nop
  v_nop
  v_cvt_pk_bf16_f32 v30, v30, v32
  v_cvt_pk_bf16_f32 v31, v31, v33
  s_lshl_b32 s60, s56, 3
  s_add_u32 s60, s60, 155680
  v_mov_b32 v34, s60
  ds_write_b64 v34, v[30:31]
  s_waitcnt lgkmcnt(0)
  s_bitcmp1_b32 s59, 7
  s_cbranch_scc1 L_cidle
  s_cmp_lt_u32 s58, 8
  s_cbranch_scc1 L_catt
  v_and_b32 v11, 15, v1
  v_lshrrev_b32 v12, 4, v1
  v_lshrrev_b32 v13, 1, v11
  v_xor_b32 v13, v13, v12
  v_lshlrev_b32 v13, 4, v13
  v_lshl_add_u32 v7, v11, 7, v13
  s_lshr_b32 s60, s56, 1
  s_mul_i32 s60, s60, 12288
  v_add_u32 v7, s60, v7
  v_xor_b32 v8, 64, v7
  v_bfe_u32 v13, v1, 2, 2
  v_and_b32 v14, 3, v1
  v_and_b32 v15, 1, v12
  v_lshrrev_b32 v16, 1, v12
  v_lshl_add_u32 v17, v15, 2, v13
  v_lshl_add_u32 v17, v16, 4, v17
  v_mul_u32_u24 v17, 0xc0, v17
  v_lshl_add_u32 v17, v14, 3, v17
  s_and_b32 s60, s56, 1
  s_mul_i32 s61, s60, 3
  v_xor_b32 v18, s61, v15
  v_lshl_add_u32 v9, v18, 5, v17
  s_add_u32 s61, s61, 1
  v_xor_b32 v18, s61, v15
  v_lshl_add_u32 v10, v18, 5, v17
  v_subrev_u32 v10, 32, v10
  s_lshr_b32 s60, s56, 1
  s_lshl_b32 s61, s60, 6
  s_mul_i32 s62, s60, 6144
  s_lshl_b32 s63, s62, 1
  s_sub_u32 s63, 6144, s63
  v_xor_b32 v7, s61, v7
  v_xor_b32 v8, 64, v7
  v_add_u32 v9, s62, v9
  v_add_u32 v10, s62, v10
  v_add_u32 v2, s63, v9
  v_add_u32 v3, s63, v10
  v_lshrrev_b32 v11, 4, v1
  v_lshlrev_b32 v11, 4, v11
  s_lshl_b32 s60, s56, 10
  s_add_u32 s60, s60, 155776
  v_and_b32 v6, 15, v1
  v_lshl_add_u32 v4, v6, 6, v11
  v_add_u32 v4, s60, v4
  s_xor_b32 s60, s60, 0x800
  v_add_u32 v5, s60, v11
  v_cmp_eq_u32 s[64:65], 1, v6
  v_cmp_eq_u32 s[66:67], 2, v6
  v_cmp_eq_u32 s[68:69], 3, v6
  v_cmp_eq_u32 s[70:71], 4, v6
  v_cmp_eq_u32 s[72:73], 5, v6
  v_mov_b32 v16, 0x3f803f80
  v_mov_b32 v17, 0x3f803f80
  v_mov_b32 v18, 0x3f803f80
  v_mov_b32 v19, 0x3f803f80
  s_waitcnt vmcnt(0)
  s_setprio 1
  s_barrier
  ds_read_b128 v[40:43], v7 offset:0
  ds_read_b128 v[44:47], v7 offset:2048
  ds_read_b128 v[48:51], v7 offset:4096
  ds_read_b128 v[52:55], v7 offset:6144
  ds_read_b128 v[56:59], v7 offset:8192
  ds_read_b128 v[60:63], v7 offset:10240
  ds_read_b64_tr_b16 v[88:89], v9 offset:24576
  ds_read_b64_tr_b16 v[90:91], v9 offset:26112
  ds_read_b64_tr_b16 v[92:93], v9 offset:36864
  ds_read_b64_tr_b16 v[94:95], v9 offset:38400
  s_waitcnt lgkmcnt(2)
  v_mfma_f32_16x16x32_bf16 v[104:107], v[88:91], v[40:43], 0
  ds_read_b64_tr_b16 v[96:97], v10 offset:24608
  v_mfma_f32_16x16x32_bf16 v[108:111], v[88:91], v[44:47], 0
  ds_read_b64_tr_b16 v[98:99], v10 offset:26144
  v_mfma_f32_16x16x32_bf16 v[112:115], v[88:91], v[48:51], 0
  ds_read_b128 v[64:67], v8 offset:0
  v_mfma_f32_16x16x32_bf16 v[116:119], v[88:91], v[52:55], 0
  ds_read_b128 v[68:71], v8 offset:2048
  v_mfma_f32_16x16x32_bf16 v[120:123], v[88:91], v[56:59], 0
  v_mfma_f32_16x16x32_bf16 v[124:127], v[88:91], v[60:63], 0
  v_mfma_f32_16x16x32_bf16 v[20:23], v[88:91], v[16:19], 0
  s_waitcnt lgkmcnt(4)
  v_mfma_f32_16x16x32_bf16 v[128:131], v[92:95], v[40:43], 0
  ds_read_b64_tr_b16 v[88:89], v10 offset:36896
  v_mfma_f32_16x16x32_bf16 v[132:135], v[92:95], v[44:47], 0
  ds_read_b64_tr_b16 v[90:91], v10 offset:38432
  v_mfma_f32_16x16x32_bf16 v[136:139], v[92:95], v[48:51], 0
  ds_read_b128 v[72:75], v8 offset:4096
  v_mfma_f32_16x16x32_bf16 v[140:143], v[92:95], v[52:55], 0
  ds_read_b128 v[76:79], v8 offset:6144
  v_mfma_f32_16x16x32_bf16 v[144:147], v[92:95], v[56:59], 0
  v_mfma_f32_16x16x32_bf16 v[148:151], v[92:95], v[60:63], 0
  v_mfma_f32_16x16x32_bf16 v[24:27], v[92:95], v[16:19], 0
  s_waitcnt lgkmcnt(6)
  v_mfma_f32_16x16x32_bf16 v[152:155], v[96:99], v[40:43], 0
  ds_read_b64_tr_b16 v[92:93], v9 offset:24640
  v_mfma_f32_16x16x32_bf16 v[156:159], v[96:99], v[44:47], 0
  ds_read_b64_tr_b16 v[94:95], v9 offset:26176
  v_mfma_f32_16x16x32_bf16 v[160:163], v[96:99], v[48:51], 0
  ds_read_b128 v[80:83], v8 offset:8192
  v_mfma_f32_16x16x32_bf16 v[164:167], v[96:99], v[52:55], 0
  ds_read_b128 v[84:87], v8 offset:10240
  v_mfma_f32_16x16x32_bf16 v[168:171], v[96:99], v[56:59], 0
  v_mfma_f32_16x16x32_bf16 v[172:175], v[96:99], v[60:63], 0
  v_mfma_f32_16x16x32_bf16 v[28:31], v[96:99], v[16:19], 0
  s_waitcnt lgkmcnt(6)
  v_mfma_f32_16x16x32_bf16 v[176:179], v[88:91], v[40:43], 0
  ds_read_b64_tr_b16 v[96:97], v9 offset:36928
  v_mfma_f32_16x16x32_bf16 v[180:183], v[88:91], v[44:47], 0
  ds_read_b64_tr_b16 v[98:99], v9 offset:38464
  v_mfma_f32_16x16x32_bf16 v[184:187], v[88:91], v[48:51], 0
  v_mfma_f32_16x16x32_bf16 v[188:191], v[88:91], v[52:55], 0
  v_mfma_f32_16x16x32_bf16 v[192:195], v[88:91], v[56:59], 0
  v_mfma_f32_16x16x32_bf16 v[196:199], v[88:91], v[60:63], 0
  v_mfma_f32_16x16x32_bf16 v[32:35], v[88:91], v[16:19], 0
  s_waitcnt lgkmcnt(4)
  v_mfma_f32_16x16x32_bf16 v[200:203], v[92:95], v[40:43], 0
  ds_read_b64_tr_b16 v[88:89], v2 offset:24576
  v_mfma_f32_16x16x32_bf16 v[204:207], v[92:95], v[44:47], 0
  ds_read_b64_tr_b16 v[90:91], v2 offset:26112
  v_mfma_f32_16x16x32_bf16 v[208:211], v[92:95], v[48:51], 0
  v_mfma_f32_16x16x32_bf16 v[212:215], v[92:95], v[52:55], 0
  v_mfma_f32_16x16x32_bf16 v[216:219], v[92:95], v[56:59], 0
  v_mfma_f32_16x16x32_bf16 v[220:223], v[92:95], v[60:63], 0
  v_mfma_f32_16x16x32_bf16 v[248:251], v[92:95], v[16:19], 0
  s_waitcnt lgkmcnt(2)
  v_mfma_f32_16x16x32_bf16 v[224:227], v[96:99], v[40:43], 0
  ds_read_b64_tr_b16 v[92:93], v2 offset:36864
  v_mfma_f32_16x16x32_bf16 v[228:231], v[96:99], v[44:47], 0
  ds_read_b64_tr_b16 v[94:95], v2 offset:38400
  v_mfma_f32_16x16x32_bf16 v[232:235], v[96:99], v[48:51], 0
  v_mfma_f32_16x16x32_bf16 v[236:239], v[96:99], v[52:55], 0
  v_mfma_f32_16x16x32_bf16 v[240:243], v[96:99], v[56:59], 0
  v_mfma_f32_16x16x32_bf16 v[244:247], v[96:99], v[60:63], 0
  v_mfma_f32_16x16x32_bf16 v[252:255], v[96:99], v[16:19], 0
  s_waitcnt lgkmcnt(2)
  v_mfma_f32_16x16x32_bf16 v[104:107], v[88:91], v[64:67], v[104:107]
  ds_read_b64_tr_b16 v[96:97], v3 offset:24608
  v_mfma_f32_16x16x32_bf16 v[108:111], v[88:91], v[68:71], v[108:111]
  ds_read_b64_tr_b16 v[98:99], v3 offset:26144
  v_mfma_f32_16x16x32_bf16 v[112:115], v[88:91], v[72:75], v[112:115]
  v_mfma_f32_16x16x32_bf16 v[116:119], v[88:91], v[76:79], v[116:119]
  v_mfma_f32_16x16x32_bf16 v[120:123], v[88:91], v[80:83], v[120:123]
  v_mfma_f32_16x16x32_bf16 v[124:127], v[88:91], v[84:87], v[124:127]
  s_waitcnt lgkmcnt(2)
  v_mfma_f32_16x16x32_bf16 v[128:131], v[92:95], v[64:67], v[128:131]
  ds_read_b64_tr_b16 v[88:89], v3 offset:36896
  v_mfma_f32_16x16x32_bf16 v[132:135], v[92:95], v[68:71], v[132:135]
  ds_read_b64_tr_b16 v[90:91], v3 offset:38432
  v_mfma_f32_16x16x32_bf16 v[136:139], v[92:95], v[72:75], v[136:139]
  v_mfma_f32_16x16x32_bf16 v[140:143], v[92:95], v[76:79], v[140:143]
  v_mfma_f32_16x16x32_bf16 v[144:147], v[92:95], v[80:83], v[144:147]
  v_mfma_f32_16x16x32_bf16 v[148:151], v[92:95], v[84:87], v[148:151]
  s_waitcnt lgkmcnt(2)
  v_mfma_f32_16x16x32_bf16 v[152:155], v[96:99], v[64:67], v[152:155]
  ds_read_b64_tr_b16 v[92:93], v2 offset:24640
  v_mfma_f32_16x16x32_bf16 v[156:159], v[96:99], v[68:71], v[156:159]
  ds_read_b64_tr_b16 v[94:95], v2 offset:26176
  v_mfma_f32_16x16x32_bf16 v[160:163], v[96:99], v[72:75], v[160:163]
  v_mfma_f32_16x16x32_bf16 v[164:167], v[96:99], v[76:79], v[164:167]
  v_mfma_f32_16x16x32_bf16 v[168:171], v[96:99], v[80:83], v[168:171]
  v_mfma_f32_16x16x32_bf16 v[172:175], v[96:99], v[84:87], v[172:175]
  s_waitcnt lgkmcnt(2)
  v_mfma_f32_16x16x32_bf16 v[176:179], v[88:91], v[64:67], v[176:179]
  ds_read_b64_tr_b16 v[96:97], v2 offset:36928
  v_mfma_f32_16x16x32_bf16 v[180:183], v[88:91], v[68:71], v[180:183]
  ds_read_b64_tr_b16 v[98:99], v2 offset:38464
  v_mfma_f32_16x16x32_bf16 v[184:187], v[88:91], v[72:75], v[184:187]
  v_add_u32 v7, 51200, v7
  v_add_u32 v8, 51200, v8
  v_mfma_f32_16x16x32_bf16 v[188:191], v[88:91], v[76:79], v[188:191]
  v_add_u32 v9, 51200, v9
  v_add_u32 v2, 51200, v2
  v_mfma_f32_16x16x32_bf16 v[192:195], v[88:91], v[80:83], v[192:195]
  v_add_u32 v10, 51200, v10
  v_add_u32 v3, 51200, v3
  v_mfma_f32_16x16x32_bf16 v[196:199], v[88:91], v[84:87], v[196:199]
  s_waitcnt lgkmcnt(0)
  s_barrier
  v_mfma_f32_16x16x32_bf16 v[200:203], v[92:95], v[64:67], v[200:203]
  ds_read_b64_tr_b16 v[88:89], v9 offset:24576
  v_mfma_f32_16x16x32_bf16 v[204:207], v[92:95], v[68:71], v[204:207]
  ds_read_b64_tr_b16 v[90:91], v9 offset:26112
  v_mfma_f32_16x16x32_bf16 v[208:211], v[92:95], v[72:75], v[208:211]
  ds_read_b128 v[40:43], v7 offset:0
  v_mfma_f32_16x16x32_bf16 v[212:215], v[92:95], v[76:79], v[212:215]
  ds_read_b128 v[44:47], v7 offset:2048
  v_mfma_f32_16x16x32_bf16 v[216:219], v[92:95], v[80:83], v[216:219]
  ds_read_b128 v[48:51], v7 offset:4096
  v_mfma_f32_16x16x32_bf16 v[220:223], v[92:95], v[84:87], v[220:223]
  v_mfma_f32_16x16x32_bf16 v[224:227], v[96:99], v[64:67], v[224:227]
  ds_read_b64_tr_b16 v[92:93], v9 offset:36864
  v_mfma_f32_16x16x32_bf16 v[228:231], v[96:99], v[68:71], v[228:231]
  ds_read_b64_tr_b16 v[94:95], v9 offset:38400
  v_mfma_f32_16x16x32_bf16 v[232:235], v[96:99], v[72:75], v[232:235]
  ds_read_b128 v[52:55], v7 offset:6144
  v_mfma_f32_16x16x32_bf16 v[236:239], v[96:99], v[76:79], v[236:239]
  ds_read_b128 v[56:59], v7 offset:8192
  v_mfma_f32_16x16x32_bf16 v[240:243], v[96:99], v[80:83], v[240:243]
  ds_read_b128 v[60:63], v7 offset:10240
  v_mfma_f32_16x16x32_bf16 v[244:247], v[96:99], v[84:87], v[244:247]
  s_waitcnt lgkmcnt(7)
  v_mfma_f32_16x16x32_bf16 v[104:107], v[88:91], v[40:43], v[104:107]
  ds_read_b64_tr_b16 v[96:97], v10 offset:24608
  s_waitcnt lgkmcnt(7)
  v_mfma_f32_16x16x32_bf16 v[108:111], v[88:91], v[44:47], v[108:111]
  ds_read_b64_tr_b16 v[98:99], v10 offset:26144
  s_waitcnt lgkmcnt(7)
  v_mfma_f32_16x16x32_bf16 v[112:115], v[88:91], v[48:51], v[112:115]
  ds_read_b128 v[64:67], v8 offset:0
  s_waitcnt lgkmcnt(5)
  v_mfma_f32_16x16x32_bf16 v[116:119], v[88:91], v[52:55], v[116:119]
  ds_read_b128 v[68:71], v8 offset:2048
  s_waitcnt lgkmcnt(5)
  v_mfma_f32_16x16x32_bf16 v[120:123], v[88:91], v[56:59], v[120:123]
  s_waitcnt lgkmcnt(4)
  v_mfma_f32_16x16x32_bf16 v[124:127], v[88:91], v[60:63], v[124:127]
  v_mfma_f32_16x16x32_bf16 v[20:23], v[88:91], v[16:19], v[20:23]
  v_mfma_f32_16x16x32_bf16 v[128:131], v[92:95], v[40:43], v[128:131]
  ds_read_b64_tr_b16 v[88:89], v10 offset:36896
  v_mfma_f32_16x16x32_bf16 v[132:135], v[92:95], v[44:47], v[132:135]
  ds_read_b64_tr_b16 v[90:91], v10 offset:38432
  v_mfma_f32_16x16x32_bf16 v[136:139], v[92:95], v[48:51], v[136:139]
  ds_read_b128 v[72:75], v8 offset:4096
  v_mfma_f32_16x16x32_bf16 v[140:143], v[92:95], v[52:55], v[140:143]
  ds_read_b128 v[76:79], v8 offset:6144
  v_mfma_f32_16x16x32_bf16 v[144:147], v[92:95], v[56:59], v[144:147]
  v_mfma_f32_16x16x32_bf16 v[148:151], v[92:95], v[60:63], v[148:151]
  v_mfma_f32_16x16x32_bf16 v[24:27], v[92:95], v[16:19], v[24:27]
  s_waitcnt lgkmcnt(6)
  v_mfma_f32_16x16x32_bf16 v[152:155], v[96:99], v[40:43], v[152:155]
  ds_read_b64_tr_b16 v[92:93], v9 offset:24640
  v_mfma_f32_16x16x32_bf16 v[156:159], v[96:99], v[44:47], v[156:159]
  ds_read_b64_tr_b16 v[94:95], v9 offset:26176
  v_mfma_f32_16x16x32_bf16 v[160:163], v[96:99], v[48:51], v[160:163]
  ds_read_b128 v[80:83], v8 offset:8192
  v_mfma_f32_16x16x32_bf16 v[164:167], v[96:99], v[52:55], v[164:167]
  ds_read_b128 v[84:87], v8 offset:10240
  v_mfma_f32_16x16x32_bf16 v[168:171], v[96:99], v[56:59], v[168:171]
  v_mfma_f32_16x16x32_bf16 v[172:175], v[96:99], v[60:63], v[172:175]
  v_mfma_f32_16x16x32_bf16 v[28:31], v[96:99], v[16:19], v[28:31]
  s_waitcnt lgkmcnt(6)
  v_mfma_f32_16x16x32_bf16 v[176:179], v[88:91], v[40:43], v[176:179]
  ds_read_b64_tr_b16 v[96:97], v9 offset:36928
  v_mfma_f32_16x16x32_bf16 v[180:183], v[88:91], v[44:47], v[180:183]
  ds_read_b64_tr_b16 v[98:99], v9 offset:38464
  v_mfma_f32_16x16x32_bf16 v[184:187], v[88:91], v[48:51], v[184:187]
  v_mfma_f32_16x16x32_bf16 v[188:191], v[88:91], v[52:55], v[188:191]
  v_mfma_f32_16x16x32_bf16 v[192:195], v[88:91], v[56:59], v[192:195]
  v_mfma_f32_16x16x32_bf16 v[196:199], v[88:91], v[60:63], v[196:199]
  v_mfma_f32_16x16x32_bf16 v[32:35], v[88:91], v[16:19], v[32:35]
  s_waitcnt lgkmcnt(4)
  v_mfma_f32_16x16x32_bf16 v[200:203], v[92:95], v[40:43], v[200:203]
  ds_read_b64_tr_b16 v[88:89], v2 offset:24576
  v_mfma_f32_16x16x32_bf16 v[204:207], v[92:95], v[44:47], v[204:207]
  ds_read_b64_tr_b16 v[90:91], v2 offset:26112
  v_mfma_f32_16x16x32_bf16 v[208:211], v[92:95], v[48:51], v[208:211]
  v_mfma_f32_16x16x32_bf16 v[212:215], v[92:95], v[52:55], v[212:215]
  v_mfma_f32_16x16x32_bf16 v[216:219], v[92:95], v[56:59], v[216:219]
  v_mfma_f32_16x16x32_bf16 v[220:223], v[92:95], v[60:63], v[220:223]
  v_mfma_f32_16x16x32_bf16 v[248:251], v[92:95], v[16:19], v[248:251]
  s_waitcnt lgkmcnt(2)
  v_mfma_f32_16x16x32_bf16 v[224:227], v[96:99], v[40:43], v[224:227]
  ds_read_b64_tr_b16 v[92:93], v2 offset:36864
  v_mfma_f32_16x16x32_bf16 v[228:231], v[96:99], v[44:47], v[228:231]
  ds_read_b64_tr_b16 v[94:95], v2 offset:38400
  v_mfma_f32_16x16x32_bf16 v[232:235], v[96:99], v[48:51], v[232:235]
  v_mfma_f32_16x16x32_bf16 v[236:239], v[96:99], v[52:55], v[236:239]
  v_mfma_f32_16x16x32_bf16 v[240:243], v[96:99], v[56:59], v[240:243]
  v_mfma_f32_16x16x32_bf16 v[244:247], v[96:99], v[60:63], v[244:247]
  v_mfma_f32_16x16x32_bf16 v[252:255], v[96:99], v[16:19], v[252:255]
  s_waitcnt lgkmcnt(2)
  v_mfma_f32_16x16x32_bf16 v[104:107], v[88:91], v[64:67], v[104:107]
  ds_read_b64_tr_b16 v[96:97], v3 offset:24608
  v_mfma_f32_16x16x32_bf16 v[108:111], v[88:91], v[68:71], v[108:111]
  ds_read_b64_tr_b16 v[98:99], v3 offset:26144
  v_mfma_f32_16x16x32_bf16 v[112:115], v[88:91], v[72:75], v[112:115]
  v_mfma_f32_16x16x32_bf16 v[116:119], v[88:91], v[76:79], v[116:119]
  v_mfma_f32_16x16x32_bf16 v[120:123], v[88:91], v[80:83], v[120:123]
  v_mfma_f32_16x16x32_bf16 v[124:127], v[88:91], v[84:87], v[124:127]
  s_waitcnt lgkmcnt(2)
  v_mfma_f32_16x16x32_bf16 v[128:131], v[92:95], v[64:67], v[128:131]
  ds_read_b64_tr_b16 v[88:89], v3 offset:36896
  v_mfma_f32_16x16x32_bf16 v[132:135], v[92:95], v[68:71], v[132:135]
  ds_read_b64_tr_b16 v[90:91], v3 offset:38432
  v_mfma_f32_16x16x32_bf16 v[136:139], v[92:95], v[72:75], v[136:139]
  v_mfma_f32_16x16x32_bf16 v[140:143], v[92:95], v[76:79], v[140:143]
  v_mfma_f32_16x16x32_bf16 v[144:147], v[92:95], v[80:83], v[144:147]
  v_mfma_f32_16x16x32_bf16 v[148:151], v[92:95], v[84:87], v[148:151]
  s_waitcnt lgkmcnt(2)
  v_mfma_f32_16x16x32_bf16 v[152:155], v[96:99], v[64:67], v[152:155]
  ds_read_b64_tr_b16 v[92:93], v2 offset:24640
  v_mfma_f32_16x16x32_bf16 v[156:159], v[96:99], v[68:71], v[156:159]
  ds_read_b64_tr_b16 v[94:95], v2 offset:26176
  v_mfma_f32_16x16x32_bf16 v[160:163], v[96:99], v[72:75], v[160:163]
  v_mfma_f32_16x16x32_bf16 v[164:167], v[96:99], v[76:79], v[164:167]
  v_mfma_f32_16x16x32_bf16 v[168:171], v[96:99], v[80:83], v[168:171]
  v_mfma_f32_16x16x32_bf16 v[172:175], v[96:99], v[84:87], v[172:175]
  s_waitcnt lgkmcnt(2)
  v_mfma_f32_16x16x32_bf16 v[176:179], v[88:91], v[64:67], v[176:179]
  ds_read_b64_tr_b16 v[96:97], v2 offset:36928
  v_mfma_f32_16x16x32_bf16 v[180:183], v[88:91], v[68:71], v[180:183]
  ds_read_b64_tr_b16 v[98:99], v2 offset:38464
  v_mfma_f32_16x16x32_bf16 v[184:187], v[88:91], v[72:75], v[184:187]
  v_add_u32 v7, 51200, v7
  v_add_u32 v8, 51200, v8
  v_mfma_f32_16x16x32_bf16 v[188:191], v[88:91], v[76:79], v[188:191]
  v_add_u32 v9, 51200, v9
  v_add_u32 v2, 51200, v2
  v_mfma_f32_16x16x32_bf16 v[192:195], v[88:91], v[80:83], v[192:195]
  v_add_u32 v10, 51200, v10
  v_add_u32 v3, 51200, v3
  v_mfma_f32_16x16x32_bf16 v[196:199], v[88:91], v[84:87], v[196:199]
  s_waitcnt lgkmcnt(0)
  s_barrier
  v_mfma_f32_16x16x32_bf16 v[200:203], v[92:95], v[64:67], v[200:203]
  ds_read_b64_tr_b16 v[88:89], v9 offset:24576
  v_mfma_f32_16x16x32_bf16 v[204:207], v[92:95], v[68:71], v[204:207]
  ds_read_b64_tr_b16 v[90:91], v9 offset:26112
  v_mfma_f32_16x16x32_bf16 v[208:211], v[92:95], v[72:75], v[208:211]
  ds_read_b128 v[40:43], v7 offset:0
  v_mfma_f32_16x16x32_bf16 v[212:215], v[92:95], v[76:79], v[212:215]
  ds_read_b128 v[44:47], v7 offset:2048
  v_mfma_f32_16x16x32_bf16 v[216:219], v[92:95], v[80:83], v[216:219]
  ds_read_b128 v[48:51], v7 offset:4096
  v_mfma_f32_16x16x32_bf16 v[220:223], v[92:95], v[84:87], v[220:223]
  v_mfma_f32_16x16x32_bf16 v[224:227], v[96:99], v[64:67], v[224:227]
  ds_read_b64_tr_b16 v[92:93], v9 offset:36864
  v_mfma_f32_16x16x32_bf16 v[228:231], v[96:99], v[68:71], v[228:231]
  ds_read_b64_tr_b16 v[94:95], v9 offset:38400
  v_mfma_f32_16x16x32_bf16 v[232:235], v[96:99], v[72:75], v[232:235]
  ds_read_b128 v[52:55], v7 offset:6144
  v_mfma_f32_16x16x32_bf16 v[236:239], v[96:99], v[76:79], v[236:239]
  ds_read_b128 v[56:59], v7 offset:8192
  v_mfma_f32_16x16x32_bf16 v[240:243], v[96:99], v[80:83], v[240:243]
  ds_read_b128 v[60:63], v7 offset:10240
  v_mfma_f32_16x16x32_bf16 v[244:247], v[96:99], v[84:87], v[244:247]
  s_waitcnt lgkmcnt(7)
  v_mfma_f32_16x16x32_bf16 v[104:107], v[88:91], v[40:43], v[104:107]
  ds_read_b64_tr_b16 v[96:97], v10 offset:24608
  s_waitcnt lgkmcnt(7)
  v_mfma_f32_16x16x32_bf16 v[108:111], v[88:91], v[44:47], v[108:111]
  ds_read_b64_tr_b16 v[98:99], v10 offset:26144
  s_waitcnt lgkmcnt(7)
  v_mfma_f32_16x16x32_bf16 v[112:115], v[88:91], v[48:51], v[112:115]
  ds_read_b128 v[64:67], v8 offset:0
  s_waitcnt lgkmcnt(5)
  v_mfma_f32_16x16x32_bf16 v[116:119], v[88:91], v[52:55], v[116:119]
  ds_read_b128 v[68:71], v8 offset:2048
  s_waitcnt lgkmcnt(5)
  v_mfma_f32_16x16x32_bf16 v[120:123], v[88:91], v[56:59], v[120:123]
  s_waitcnt lgkmcnt(4)
  v_mfma_f32_16x16x32_bf16 v[124:127], v[88:91], v[60:63], v[124:127]
  v_mfma_f32_16x16x32_bf16 v[20:23], v[88:91], v[16:19], v[20:23]
  v_mfma_f32_16x16x32_bf16 v[128:131], v[92:95], v[40:43], v[128:131]
  ds_read_b64_tr_b16 v[88:89], v10 offset:36896
  v_mfma_f32_16x16x32_bf16 v[132:135], v[92:95], v[44:47], v[132:135]
  ds_read_b64_tr_b16 v[90:91], v10 offset:38432
  v_mfma_f32_16x16x32_bf16 v[136:139], v[92:95], v[48:51], v[136:139]
  ds_read_b128 v[72:75], v8 offset:4096
  v_mfma_f32_16x16x32_bf16 v[140:143], v[92:95], v[52:55], v[140:143]
  ds_read_b128 v[76:79], v8 offset:6144
  v_mfma_f32_16x16x32_bf16 v[144:147], v[92:95], v[56:59], v[144:147]
  v_mfma_f32_16x16x32_bf16 v[148:151], v[92:95], v[60:63], v[148:151]
  v_mfma_f32_16x16x32_bf16 v[24:27], v[92:95], v[16:19], v[24:27]
  s_waitcnt lgkmcnt(6)
  v_mfma_f32_16x16x32_bf16 v[152:155], v[96:99], v[40:43], v[152:155]
  ds_read_b64_tr_b16 v[92:93], v9 offset:24640
  v_mfma_f32_16x16x32_bf16 v[156:159], v[96:99], v[44:47], v[156:159]
  ds_read_b64_tr_b16 v[94:95], v9 offset:26176
  v_mfma_f32_16x16x32_bf16 v[160:163], v[96:99], v[48:51], v[160:163]
  ds_read_b128 v[80:83], v8 offset:8192
  v_mfma_f32_16x16x32_bf16 v[164:167], v[96:99], v[52:55], v[164:167]
  ds_read_b128 v[84:87], v8 offset:10240
  v_mfma_f32_16x16x32_bf16 v[168:171], v[96:99], v[56:59], v[168:171]
  v_mfma_f32_16x16x32_bf16 v[172:175], v[96:99], v[60:63], v[172:175]
  v_mfma_f32_16x16x32_bf16 v[28:31], v[96:99], v[16:19], v[28:31]
  s_waitcnt lgkmcnt(6)
  v_mfma_f32_16x16x32_bf16 v[176:179], v[88:91], v[40:43], v[176:179]
  ds_read_b64_tr_b16 v[96:97], v9 offset:36928
  v_mfma_f32_16x16x32_bf16 v[180:183], v[88:91], v[44:47], v[180:183]
  ds_read_b64_tr_b16 v[98:99], v9 offset:38464
  v_mfma_f32_16x16x32_bf16 v[184:187], v[88:91], v[48:51], v[184:187]
  v_mfma_f32_16x16x32_bf16 v[188:191], v[88:91], v[52:55], v[188:191]
  v_mfma_f32_16x16x32_bf16 v[192:195], v[88:91], v[56:59], v[192:195]
  v_mfma_f32_16x16x32_bf16 v[196:199], v[88:91], v[60:63], v[196:199]
  v_mfma_f32_16x16x32_bf16 v[32:35], v[88:91], v[16:19], v[32:35]
  s_waitcnt lgkmcnt(4)
  v_mfma_f32_16x16x32_bf16 v[200:203], v[92:95], v[40:43], v[200:203]
  ds_read_b64_tr_b16 v[88:89], v2 offset:24576
  v_mfma_f32_16x16x32_bf16 v[204:207], v[92:95], v[44:47], v[204:207]
  ds_read_b64_tr_b16 v[90:91], v2 offset:26112
  v_mfma_f32_16x16x32_bf16 v[208:211], v[92:95], v[48:51], v[208:211]
  v_mfma_f32_16x16x32_bf16 v[212:215], v[92:95], v[52:55], v[212:215]
  v_mfma_f32_16x16x32_bf16 v[216:219], v[92:95], v[56:59], v[216:219]
  v_mfma_f32_16x16x32_bf16 v[220:223], v[92:95], v[60:63], v[220:223]
  v_mfma_f32_16x16x32_bf16 v[248:251], v[92:95], v[16:19], v[248:251]
  s_waitcnt lgkmcnt(2)
  v_mfma_f32_16x16x32_bf16 v[224:227], v[96:99], v[40:43], v[224:227]
  ds_read_b64_tr_b16 v[92:93], v2 offset:36864
  v_mfma_f32_16x16x32_bf16 v[228:231], v[96:99], v[44:47], v[228:231]
  ds_read_b64_tr_b16 v[94:95], v2 offset:38400
  v_mfma_f32_16x16x32_bf16 v[232:235], v[96:99], v[48:51], v[232:235]
  v_mfma_f32_16x16x32_bf16 v[236:239], v[96:99], v[52:55], v[236:239]
  v_mfma_f32_16x16x32_bf16 v[240:243], v[96:99], v[56:59], v[240:243]
  v_mfma_f32_16x16x32_bf16 v[244:247], v[96:99], v[60:63], v[244:247]
  v_mfma_f32_16x16x32_bf16 v[252:255], v[96:99], v[16:19], v[252:255]
  s_waitcnt lgkmcnt(2)
  v_mfma_f32_16x16x32_bf16 v[104:107], v[88:91], v[64:67], v[104:107]
  ds_read_b64_tr_b16 v[96:97], v3 offset:24608
  v_mfma_f32_16x16x32_bf16 v[108:111], v[88:91], v[68:71], v[108:111]
  ds_read_b64_tr_b16 v[98:99], v3 offset:26144
  v_mfma_f32_16x16x32_bf16 v[112:115], v[88:91], v[72:75], v[112:115]
  v_mfma_f32_16x16x32_bf16 v[116:119], v[88:91], v[76:79], v[116:119]
  v_mfma_f32_16x16x32_bf16 v[120:123], v[88:91], v[80:83], v[120:123]
  v_mfma_f32_16x16x32_bf16 v[124:127], v[88:91], v[84:87], v[124:127]
  s_waitcnt lgkmcnt(2)
  v_mfma_f32_16x16x32_bf16 v[128:131], v[92:95], v[64:67], v[128:131]
  ds_read_b64_tr_b16 v[88:89], v3 offset:36896
  v_mfma_f32_16x16x32_bf16 v[132:135], v[92:95], v[68:71], v[132:135]
  ds_read_b64_tr_b16 v[90:91], v3 offset:38432
  v_mfma_f32_16x16x32_bf16 v[136:139], v[92:95], v[72:75], v[136:139]
  v_mfma_f32_16x16x32_bf16 v[140:143], v[92:95], v[76:79], v[140:143]
  v_mfma_f32_16x16x32_bf16 v[144:147], v[92:95], v[80:83], v[144:147]
  v_mfma_f32_16x16x32_bf16 v[148:151], v[92:95], v[84:87], v[148:151]
  s_waitcnt lgkmcnt(2)
  v_mfma_f32_16x16x32_bf16 v[152:155], v[96:99], v[64:67], v[152:155]
  ds_read_b64_tr_b16 v[92:93], v2 offset:24640
  v_mfma_f32_16x16x32_bf16 v[156:159], v[96:99], v[68:71], v[156:159]
  ds_read_b64_tr_b16 v[94:95], v2 offset:26176
  v_mfma_f32_16x16x32_bf16 v[160:163], v[96:99], v[72:75], v[160:163]
  v_mfma_f32_16x16x32_bf16 v[164:167], v[96:99], v[76:79], v[164:167]
  v_mfma_f32_16x16x32_bf16 v[168:171], v[96:99], v[80:83], v[168:171]
  v_mfma_f32_16x16x32_bf16 v[172:175], v[96:99], v[84:87], v[172:175]
  s_waitcnt lgkmcnt(2)
  v_mfma_f32_16x16x32_bf16 v[176:179], v[88:91], v[64:67], v[176:179]
  ds_read_b64_tr_b16 v[96:97], v2 offset:36928
  v_mfma_f32_16x16x32_bf16 v[180:183], v[88:91], v[68:71], v[180:183]
  ds_read_b64_tr_b16 v[98:99], v2 offset:38464
  v_mfma_f32_16x16x32_bf16 v[184:187], v[88:91], v[72:75], v[184:187]
  v_add_u32 v7, -102400, v7
  v_add_u32 v8, -102400, v8
  v_mfma_f32_16x16x32_bf16 v[188:191], v[88:91], v[76:79], v[188:191]
  v_add_u32 v9, -102400, v9
  v_add_u32 v2, -102400, v2
  v_mfma_f32_16x16x32_bf16 v[192:195], v[88:91], v[80:83], v[192:195]
  v_add_u32 v10, -102400, v10
  v_add_u32 v3, -102400, v3
  v_mfma_f32_16x16x32_bf16 v[196:199], v[88:91], v[84:87], v[196:199]
  s_waitcnt lgkmcnt(0)
  s_barrier
  v_mfma_f32_16x16x32_bf16 v[200:203], v[92:95], v[64:67], v[200:203]
  ds_read_b64_tr_b16 v[88:89], v9 offset:24576
  v_mfma_f32_16x16x32_bf16 v[204:207], v[92:95], v[68:71], v[204:207]
  ds_read_b64_tr_b16 v[90:91], v9 offset:26112
  v_mfma_f32_16x16x32_bf16 v[208:211], v[92:95], v[72:75], v[208:211]
  ds_read_b128 v[40:43], v7 offset:0
  v_mfma_f32_16x16x32_bf16 v[212:215], v[92:95], v[76:79], v[212:215]
  ds_read_b128 v[44:47], v7 offset:2048
  v_mfma_f32_16x16x32_bf16 v[216:219], v[92:95], v[80:83], v[216:219]
  ds_read_b128 v[48:51], v7 offset:4096
  v_mfma_f32_16x16x32_bf16 v[220:223], v[92:95], v[84:87], v[220:223]
  v_mfma_f32_16x16x32_bf16 v[224:227], v[96:99], v[64:67], v[224:227]
  ds_read_b64_tr_b16 v[92:93], v9 offset:36864
  v_mfma_f32_16x16x32_bf16 v[228:231], v[96:99], v[68:71], v[228:231]
  ds_read_b64_tr_b16 v[94:95], v9 offset:38400
  v_mfma_f32_16x16x32_bf16 v[232:235], v[96:99], v[72:75], v[232:235]
  ds_read_b128 v[52:55], v7 offset:6144
  v_mfma_f32_16x16x32_bf16 v[236:239], v[96:99], v[76:79], v[236:239]
  ds_read_b128 v[56:59], v7 offset:8192
  v_mfma_f32_16x16x32_bf16 v[240:243], v[96:99], v[80:83], v[240:243]
  ds_read_b128 v[60:63], v7 offset:10240
  v_mfma_f32_16x16x32_bf16 v[244:247], v[96:99], v[84:87], v[244:247]
  s_waitcnt lgkmcnt(7)
  v_mfma_f32_16x16x32_bf16 v[104:107], v[88:91], v[40:43], v[104:107]
  ds_read_b64_tr_b16 v[96:97], v10 offset:24608
  s_waitcnt lgkmcnt(7)
  v_mfma_f32_16x16x32_bf16 v[108:111], v[88:91], v[44:47], v[108:111]
  ds_read_b64_tr_b16 v[98:99], v10 offset:26144
  s_waitcnt lgkmcnt(7)
  v_mfma_f32_16x16x32_bf16 v[112:115], v[88:91], v[48:51], v[112:115]
  ds_read_b128 v[64:67], v8 offset:0
  s_waitcnt lgkmcnt(5)
  v_mfma_f32_16x16x32_bf16 v[116:119], v[88:91], v[52:55], v[116:119]
  ds_read_b128 v[68:71], v8 offset:2048
  s_waitcnt lgkmcnt(5)
  v_mfma_f32_16x16x32_bf16 v[120:123], v[88:91], v[56:59], v[120:123]
  s_waitcnt lgkmcnt(4)
  v_mfma_f32_16x16x32_bf16 v[124:127], v[88:91], v[60:63], v[124:127]
  v_mfma_f32_16x16x32_bf16 v[20:23], v[88:91], v[16:19], v[20:23]
  v_mfma_f32_16x16x32_bf16 v[128:131], v[92:95], v[40:43], v[128:131]
  ds_read_b64_tr_b16 v[88:89], v10 offset:36896
  v_mfma_f32_16x16x32_bf16 v[132:135], v[92:95], v[44:47], v[132:135]
  ds_read_b64_tr_b16 v[90:91], v10 offset:38432
  v_mfma_f32_16x16x32_bf16 v[136:139], v[92:95], v[48:51], v[136:139]
  ds_read_b128 v[72:75], v8 offset:4096
  v_mfma_f32_16x16x32_bf16 v[140:143], v[92:95], v[52:55], v[140:143]
  ds_read_b128 v[76:79], v8 offset:6144
  v_mfma_f32_16x16x32_bf16 v[144:147], v[92:95], v[56:59], v[144:147]
  v_mfma_f32_16x16x32_bf16 v[148:151], v[92:95], v[60:63], v[148:151]
  v_mfma_f32_16x16x32_bf16 v[24:27], v[92:95], v[16:19], v[24:27]
  s_waitcnt lgkmcnt(6)
  v_mfma_f32_16x16x32_bf16 v[152:155], v[96:99], v[40:43], v[152:155]
  ds_read_b64_tr_b16 v[92:93], v9 offset:24640
  v_mfma_f32_16x16x32_bf16 v[156:159], v[96:99], v[44:47], v[156:159]
  ds_read_b64_tr_b16 v[94:95], v9 offset:26176
  v_mfma_f32_16x16x32_bf16 v[160:163], v[96:99], v[48:51], v[160:163]
  ds_read_b128 v[80:83], v8 offset:8192
  v_mfma_f32_16x16x32_bf16 v[164:167], v[96:99], v[52:55], v[164:167]
  ds_read_b128 v[84:87], v8 offset:10240
  v_mfma_f32_16x16x32_bf16 v[168:171], v[96:99], v[56:59], v[168:171]
  v_mfma_f32_16x16x32_bf16 v[172:175], v[96:99], v[60:63], v[172:175]
  v_mfma_f32_16x16x32_bf16 v[28:31], v[96:99], v[16:19], v[28:31]
  s_waitcnt lgkmcnt(6)
  v_mfma_f32_16x16x32_bf16 v[176:179], v[88:91], v[40:43], v[176:179]
  ds_read_b64_tr_b16 v[96:97], v9 offset:36928
  v_mfma_f32_16x16x32_bf16 v[180:183], v[88:91], v[44:47], v[180:183]
  ds_read_b64_tr_b16 v[98:99], v9 offset:38464
  v_mfma_f32_16x16x32_bf16 v[184:187], v[88:91], v[48:51], v[184:187]
  v_mfma_f32_16x16x32_bf16 v[188:191], v[88:91], v[52:55], v[188:191]
  v_mfma_f32_16x16x32_bf16 v[192:195], v[88:91], v[56:59], v[192:195]
  v_mfma_f32_16x16x32_bf16 v[196:199], v[88:91], v[60:63], v[196:199]
  v_mfma_f32_16x16x32_bf16 v[32:35], v[88:91], v[16:19], v[32:35]
  s_waitcnt lgkmcnt(4)
  v_mfma_f32_16x16x32_bf16 v[200:203], v[92:95], v[40:43], v[200:203]
  ds_read_b64_tr_b16 v[88:89], v2 offset:24576
  v_mfma_f32_16x16x32_bf16 v[204:207], v[92:95], v[44:47], v[204:207]
  ds_read_b64_tr_b16 v[90:91], v2 offset:26112
  v_mfma_f32_16x16x32_bf16 v[208:211], v[92:95], v[48:51], v[208:211]
  v_mfma_f32_16x16x32_bf16 v[212:215], v[92:95], v[52:55], v[212:215]
  v_mfma_f32_16x16x32_bf16 v[216:219], v[92:95], v[56:59], v[216:219]
  v_mfma_f32_16x16x32_bf16 v[220:223], v[92:95], v[60:63], v[220:223]
  v_mfma_f32_16x16x32_bf16 v[248:251], v[92:95], v[16:19], v[248:251]
  s_waitcnt lgkmcnt(2)
  v_mfma_f32_16x16x32_bf16 v[224:227], v[96:99], v[40:43], v[224:227]
  ds_read_b64_tr_b16 v[92:93], v2 offset:36864
  v_mfma_f32_16x16x32_bf16 v[228:231], v[96:99], v[44:47], v[228:231]
  ds_read_b64_tr_b16 v[94:95], v2 offset:38400
  v_mfma_f32_16x16x32_bf16 v[232:235], v[96:99], v[48:51], v[232:235]
  v_mfma_f32_16x16x32_bf16 v[236:239], v[96:99], v[52:55], v[236:239]
  v_mfma_f32_16x16x32_bf16 v[240:243], v[96:99], v[56:59], v[240:243]
  v_mfma_f32_16x16x32_bf16 v[244:247], v[96:99], v[60:63], v[244:247]
  v_mfma_f32_16x16x32_bf16 v[252:255], v[96:99], v[16:19], v[252:255]
  s_waitcnt lgkmcnt(2)
  v_mfma_f32_16x16x32_bf16 v[104:107], v[88:91], v[64:67], v[104:107]
  ds_read_b64_tr_b16 v[96:97], v3 offset:24608
  v_mfma_f32_16x16x32_bf16 v[108:111], v[88:91], v[68:71], v[108:111]
  ds_read_b64_tr_b16 v[98:99], v3 offset:26144
  v_mfma_f32_16x16x32_bf16 v[112:115], v[88:91], v[72:75], v[112:115]
  v_mfma_f32_16x16x32_bf16 v[116:119], v[88:91], v[76:79], v[116:119]
  v_mfma_f32_16x16x32_bf16 v[120:123], v[88:91], v[80:83], v[120:123]
  v_mfma_f32_16x16x32_bf16 v[124:127], v[88:91], v[84:87], v[124:127]
  s_waitcnt lgkmcnt(2)
  v_mfma_f32_16x16x32_bf16 v[128:131], v[92:95], v[64:67], v[128:131]
  ds_read_b64_tr_b16 v[88:89], v3 offset:36896
  v_mfma_f32_16x16x32_bf16 v[132:135], v[92:95], v[68:71], v[132:135]
  ds_read_b64_tr_b16 v[90:91], v3 offset:38432
  v_mfma_f32_16x16x32_bf16 v[136:139], v[92:95], v[72:75], v[136:139]
  v_mfma_f32_16x16x32_bf16 v[140:143], v[92:95], v[76:79], v[140:143]
  v_mfma_f32_16x16x32_bf16 v[144:147], v[92:95], v[80:83], v[144:147]
  v_mfma_f32_16x16x32_bf16 v[148:151], v[92:95], v[84:87], v[148:151]
  s_waitcnt lgkmcnt(2)
  v_mfma_f32_16x16x32_bf16 v[152:155], v[96:99], v[64:67], v[152:155]
  ds_read_b64_tr_b16 v[92:93], v2 offset:24640
  v_mfma_f32_16x16x32_bf16 v[156:159], v[96:99], v[68:71], v[156:159]
  ds_read_b64_tr_b16 v[94:95], v2 offset:26176
  v_mfma_f32_16x16x32_bf16 v[160:163], v[96:99], v[72:75], v[160:163]
  v_mfma_f32_16x16x32_bf16 v[164:167], v[96:99], v[76:79], v[164:167]
  v_mfma_f32_16x16x32_bf16 v[168:171], v[96:99], v[80:83], v[168:171]
  v_mfma_f32_16x16x32_bf16 v[172:175], v[96:99], v[84:87], v[172:175]
  s_waitcnt lgkmcnt(2)
  v_mfma_f32_16x16x32_bf16 v[176:179], v[88:91], v[64:67], v[176:179]
  ds_read_b64_tr_b16 v[96:97], v2 offset:36928
  v_mfma_f32_16x16x32_bf16 v[180:183], v[88:91], v[68:71], v[180:183]
  ds_read_b64_tr_b16 v[98:99], v2 offset:38464
  v_mfma_f32_16x16x32_bf16 v[184:187], v[88:91], v[72:75], v[184:187]
  v_add_u32 v7, 51200, v7
  v_add_u32 v8, 51200, v8
  v_mfma_f32_16x16x32_bf16 v[188:191], v[88:91], v[76:79], v[188:191]
  v_add_u32 v9, 51200, v9
  v_add_u32 v2, 51200, v2
  v_mfma_f32_16x16x32_bf16 v[192:195], v[88:91], v[80:83], v[192:195]
  v_add_u32 v10, 51200, v10
  v_add_u32 v3, 51200, v3
  v_mfma_f32_16x16x32_bf16 v[196:199], v[88:91], v[84:87], v[196:199]
  s_waitcnt lgkmcnt(0)
  s_barrier
  v_mfma_f32_16x16x32_bf16 v[200:203], v[92:95], v[64:67], v[200:203]
  ds_read_b64_tr_b16 v[88:89], v9 offset:24576
  v_mfma_f32_16x16x32_bf16 v[204:207], v[92:95], v[68:71], v[204:207]
  ds_read_b64_tr_b16 v[90:91], v9 offset:26112
  v_mfma_f32_16x16x32_bf16 v[208:211], v[92:95], v[72:75], v[208:211]
  ds_read_b128 v[40:43], v7 offset:0
  v_mfma_f32_16x16x32_bf16 v[212:215], v[92:95], v[76:79], v[212:215]
  ds_read_b128 v[44:47], v7 offset:2048
  v_mfma_f32_16x16x32_bf16 v[216:219], v[92:95], v[80:83], v[216:219]
  ds_read_b128 v[48:51], v7 offset:4096
  v_mfma_f32_16x16x32_bf16 v[220:223], v[92:95], v[84:87], v[220:223]
  v_mfma_f32_16x16x32_bf16 v[224:227], v[96:99], v[64:67], v[224:227]
  ds_read_b64_tr_b16 v[92:93], v9 offset:36864
  v_mfma_f32_16x16x32_bf16 v[228:231], v[96:99], v[68:71], v[228:231]
  ds_read_b64_tr_b16 v[94:95], v9 offset:38400
  v_mfma_f32_16x16x32_bf16 v[232:235], v[96:99], v[72:75], v[232:235]
  ds_read_b128 v[52:55], v7 offset:6144
  v_mfma_f32_16x16x32_bf16 v[236:239], v[96:99], v[76:79], v[236:239]
  ds_read_b128 v[56:59], v7 offset:8192
  v_mfma_f32_16x16x32_bf16 v[240:243], v[96:99], v[80:83], v[240:243]
  ds_read_b128 v[60:63], v7 offset:10240
  v_mfma_f32_16x16x32_bf16 v[244:247], v[96:99], v[84:87], v[244:247]
  s_waitcnt lgkmcnt(7)
  v_mfma_f32_16x16x32_bf16 v[104:107], v[88:91], v[40:43], v[104:107]
  ds_read_b64_tr_b16 v[96:97], v10 offset:24608
  s_waitcnt lgkmcnt(7)
  v_mfma_f32_16x16x32_bf16 v[108:111], v[88:91], v[44:47], v[108:111]
  ds_read_b64_tr_b16 v[98:99], v10 offset:26144
  s_waitcnt lgkmcnt(7)
  v_mfma_f32_16x16x32_bf16 v[112:115], v[88:91], v[48:51], v[112:115]
  ds_read_b128 v[64:67], v8 offset:0
  s_waitcnt lgkmcnt(5)
  v_mfma_f32_16x16x32_bf16 v[116:119], v[88:91], v[52:55], v[116:119]
  ds_read_b128 v[68:71], v8 offset:2048
  s_waitcnt lgkmcnt(5)
  v_mfma_f32_16x16x32_bf16 v[120:123], v[88:91], v[56:59], v[120:123]
  s_waitcnt lgkmcnt(4)
  v_mfma_f32_16x16x32_bf16 v[124:127], v[88:91], v[60:63], v[124:127]
  v_mfma_f32_16x16x32_bf16 v[20:23], v[88:91], v[16:19], v[20:23]
  v_mfma_f32_16x16x32_bf16 v[128:131], v[92:95], v[40:43], v[128:131]
  ds_read_b64_tr_b16 v[88:89], v10 offset:36896
  v_mfma_f32_16x16x32_bf16 v[132:135], v[92:95], v[44:47], v[132:135]
  ds_read_b64_tr_b16 v[90:91], v10 offset:38432
  v_mfma_f32_16x16x32_bf16 v[136:139], v[92:95], v[48:51], v[136:139]
  ds_read_b128 v[72:75], v8 offset:4096
  v_mfma_f32_16x16x32_bf16 v[140:143], v[92:95], v[52:55], v[140:143]
  ds_read_b128 v[76:79], v8 offset:6144
  v_mfma_f32_16x16x32_bf16 v[144:147], v[92:95], v[56:59], v[144:147]
  v_mfma_f32_16x16x32_bf16 v[148:151], v[92:95], v[60:63], v[148:151]
  v_mfma_f32_16x16x32_bf16 v[24:27], v[92:95], v[16:19], v[24:27]
  s_waitcnt lgkmcnt(6)
  v_mfma_f32_16x16x32_bf16 v[152:155], v[96:99], v[40:43], v[152:155]
  ds_read_b64_tr_b16 v[92:93], v9 offset:24640
  v_mfma_f32_16x16x32_bf16 v[156:159], v[96:99], v[44:47], v[156:159]
  ds_read_b64_tr_b16 v[94:95], v9 offset:26176
  v_mfma_f32_16x16x32_bf16 v[160:163], v[96:99], v[48:51], v[160:163]
  ds_read_b128 v[80:83], v8 offset:8192
  v_mfma_f32_16x16x32_bf16 v[164:167], v[96:99], v[52:55], v[164:167]
  ds_read_b128 v[84:87], v8 offset:10240
  v_mfma_f32_16x16x32_bf16 v[168:171], v[96:99], v[56:59], v[168:171]
  v_mfma_f32_16x16x32_bf16 v[172:175], v[96:99], v[60:63], v[172:175]
  v_mfma_f32_16x16x32_bf16 v[28:31], v[96:99], v[16:19], v[28:31]
  s_waitcnt lgkmcnt(6)
  v_mfma_f32_16x16x32_bf16 v[176:179], v[88:91], v[40:43], v[176:179]
  ds_read_b64_tr_b16 v[96:97], v9 offset:36928
  v_mfma_f32_16x16x32_bf16 v[180:183], v[88:91], v[44:47], v[180:183]
  ds_read_b64_tr_b16 v[98:99], v9 offset:38464
  v_mfma_f32_16x16x32_bf16 v[184:187], v[88:91], v[48:51], v[184:187]
  v_mfma_f32_16x16x32_bf16 v[188:191], v[88:91], v[52:55], v[188:191]
  v_mfma_f32_16x16x32_bf16 v[192:195], v[88:91], v[56:59], v[192:195]
  v_mfma_f32_16x16x32_bf16 v[196:199], v[88:91], v[60:63], v[196:199]
  v_mfma_f32_16x16x32_bf16 v[32:35], v[88:91], v[16:19], v[32:35]
  s_waitcnt lgkmcnt(4)
  v_mfma_f32_16x16x32_bf16 v[200:203], v[92:95], v[40:43], v[200:203]
  ds_read_b64_tr_b16 v[88:89], v2 offset:24576
  v_mfma_f32_16x16x32_bf16 v[204:207], v[92:95], v[44:47], v[204:207]
  ds_read_b64_tr_b16 v[90:91], v2 offset:26112
  v_mfma_f32_16x16x32_bf16 v[208:211], v[92:95], v[48:51], v[208:211]
  v_mfma_f32_16x16x32_bf16 v[212:215], v[92:95], v[52:55], v[212:215]
  v_mfma_f32_16x16x32_bf16 v[216:219], v[92:95], v[56:59], v[216:219]
  v_mfma_f32_16x16x32_bf16 v[220:223], v[92:95], v[60:63], v[220:223]
  v_mfma_f32_16x16x32_bf16 v[248:251], v[92:95], v[16:19], v[248:251]
  s_waitcnt lgkmcnt(2)
  v_mfma_f32_16x16x32_bf16 v[224:227], v[96:99], v[40:43], v[224:227]
  ds_read_b64_tr_b16 v[92:93], v2 offset:36864
  v_mfma_f32_16x16x32_bf16 v[228:231], v[96:99], v[44:47], v[228:231]
  ds_read_b64_tr_b16 v[94:95], v2 offset:38400
  v_mfma_f32_16x16x32_bf16 v[232:235], v[96:99], v[48:51], v[232:235]
  v_mfma_f32_16x16x32_bf16 v[236:239], v[96:99], v[52:55], v[236:239]
  v_mfma_f32_16x16x32_bf16 v[240:243], v[96:99], v[56:59], v[240:243]
  v_mfma_f32_16x16x32_bf16 v[244:247], v[96:99], v[60:63], v[244:247]
  v_mfma_f32_16x16x32_bf16 v[252:255], v[96:99], v[16:19], v[252:255]
  s_waitcnt lgkmcnt(2)
  v_mfma_f32_16x16x32_bf16 v[104:107], v[88:91], v[64:67], v[104:107]
  ds_read_b64_tr_b16 v[96:97], v3 offset:24608
  v_mfma_f32_16x16x32_bf16 v[108:111], v[88:91], v[68:71], v[108:111]
  ds_read_b64_tr_b16 v[98:99], v3 offset:26144
  v_mfma_f32_16x16x32_bf16 v[112:115], v[88:91], v[72:75], v[112:115]
  v_mfma_f32_16x16x32_bf16 v[116:119], v[88:91], v[76:79], v[116:119]
  v_mfma_f32_16x16x32_bf16 v[120:123], v[88:91], v[80:83], v[120:123]
  v_mfma_f32_16x16x32_bf16 v[124:127], v[88:91], v[84:87], v[124:127]
  s_waitcnt lgkmcnt(2)
  v_mfma_f32_16x16x32_bf16 v[128:131], v[92:95], v[64:67], v[128:131]
  ds_read_b64_tr_b16 v[88:89], v3 offset:36896
  v_mfma_f32_16x16x32_bf16 v[132:135], v[92:95], v[68:71], v[132:135]
  ds_read_b64_tr_b16 v[90:91], v3 offset:38432
  v_mfma_f32_16x16x32_bf16 v[136:139], v[92:95], v[72:75], v[136:139]
  v_mfma_f32_16x16x32_bf16 v[140:143], v[92:95], v[76:79], v[140:143]
  v_mfma_f32_16x16x32_bf16 v[144:147], v[92:95], v[80:83], v[144:147]
  v_mfma_f32_16x16x32_bf16 v[148:151], v[92:95], v[84:87], v[148:151]
  s_waitcnt lgkmcnt(2)
  v_mfma_f32_16x16x32_bf16 v[152:155], v[96:99], v[64:67], v[152:155]
  ds_read_b64_tr_b16 v[92:93], v2 offset:24640
  v_mfma_f32_16x16x32_bf16 v[156:159], v[96:99], v[68:71], v[156:159]
  ds_read_b64_tr_b16 v[94:95], v2 offset:26176
  v_mfma_f32_16x16x32_bf16 v[160:163], v[96:99], v[72:75], v[160:163]
  v_mfma_f32_16x16x32_bf16 v[164:167], v[96:99], v[76:79], v[164:167]
  v_mfma_f32_16x16x32_bf16 v[168:171], v[96:99], v[80:83], v[168:171]
  v_mfma_f32_16x16x32_bf16 v[172:175], v[96:99], v[84:87], v[172:175]
  s_waitcnt lgkmcnt(2)
  v_mfma_f32_16x16x32_bf16 v[176:179], v[88:91], v[64:67], v[176:179]
  ds_read_b64_tr_b16 v[96:97], v2 offset:36928
  v_mfma_f32_16x16x32_bf16 v[180:183], v[88:91], v[68:71], v[180:183]
  ds_read_b64_tr_b16 v[98:99], v2 offset:38464
  v_mfma_f32_16x16x32_bf16 v[184:187], v[88:91], v[72:75], v[184:187]
  v_add_u32 v7, 51200, v7
  v_add_u32 v8, 51200, v8
  v_mfma_f32_16x16x32_bf16 v[188:191], v[88:91], v[76:79], v[188:191]
  v_add_u32 v9, 51200, v9
  v_add_u32 v2, 51200, v2
  v_mfma_f32_16x16x32_bf16 v[192:195], v[88:91], v[80:83], v[192:195]
  v_add_u32 v10, 51200, v10
  v_add_u32 v3, 51200, v3
  v_mfma_f32_16x16x32_bf16 v[196:199], v[88:91], v[84:87], v[196:199]
  s_waitcnt lgkmcnt(0)
  s_barrier
  v_mfma_f32_16x16x32_bf16 v[200:203], v[92:95], v[64:67], v[200:203]
  ds_read_b64_tr_b16 v[88:89], v9 offset:24576
  v_mfma_f32_16x16x32_bf16 v[204:207], v[92:95], v[68:71], v[204:207]
  ds_read_b64_tr_b16 v[90:91], v9 offset:26112
  v_mfma_f32_16x16x32_bf16 v[208:211], v[92:95], v[72:75], v[208:211]
  ds_read_b128 v[40:43], v7 offset:0
  v_mfma_f32_16x16x32_bf16 v[212:215], v[92:95], v[76:79], v[212:215]
  ds_read_b128 v[44:47], v7 offset:2048
  v_mfma_f32_16x16x32_bf16 v[216:219], v[92:95], v[80:83], v[216:219]
  ds_read_b128 v[48:51], v7 offset:4096
  v_mfma_f32_16x16x32_bf16 v[220:223], v[92:95], v[84:87], v[220:223]
  v_mfma_f32_16x16x32_bf16 v[224:227], v[96:99], v[64:67], v[224:227]
  ds_read_b64_tr_b16 v[92:93], v9 offset:36864
  v_mfma_f32_16x16x32_bf16 v[228:231], v[96:99], v[68:71], v[228:231]
  ds_read_b64_tr_b16 v[94:95], v9 offset:38400
  v_mfma_f32_16x16x32_bf16 v[232:235], v[96:99], v[72:75], v[232:235]
  ds_read_b128 v[52:55], v7 offset:6144
  v_mfma_f32_16x16x32_bf16 v[236:239], v[96:99], v[76:79], v[236:239]
  ds_read_b128 v[56:59], v7 offset:8192
  v_mfma_f32_16x16x32_bf16 v[240:243], v[96:99], v[80:83], v[240:243]
  ds_read_b128 v[60:63], v7 offset:10240
  v_mfma_f32_16x16x32_bf16 v[244:247], v[96:99], v[84:87], v[244:247]
  s_waitcnt lgkmcnt(7)
  v_mfma_f32_16x16x32_bf16 v[104:107], v[88:91], v[40:43], v[104:107]
  ds_read_b64_tr_b16 v[96:97], v10 offset:24608
  s_waitcnt lgkmcnt(7)
  v_mfma_f32_16x16x32_bf16 v[108:111], v[88:91], v[44:47], v[108:111]
  ds_read_b64_tr_b16 v[98:99], v10 offset:26144
  s_waitcnt lgkmcnt(7)
  v_mfma_f32_16x16x32_bf16 v[112:115], v[88:91], v[48:51], v[112:115]
  ds_read_b128 v[64:67], v8 offset:0
  s_waitcnt lgkmcnt(5)
  v_mfma_f32_16x16x32_bf16 v[116:119], v[88:91], v[52:55], v[116:119]
  ds_read_b128 v[68:71], v8 offset:2048
  s_waitcnt lgkmcnt(5)
  v_mfma_f32_16x16x32_bf16 v[120:123], v[88:91], v[56:59], v[120:123]
  s_waitcnt lgkmcnt(4)
  v_mfma_f32_16x16x32_bf16 v[124:127], v[88:91], v[60:63], v[124:127]
  v_mfma_f32_16x16x32_bf16 v[20:23], v[88:91], v[16:19], v[20:23]
  v_mfma_f32_16x16x32_bf16 v[128:131], v[92:95], v[40:43], v[128:131]
  ds_read_b64_tr_b16 v[88:89], v10 offset:36896
  v_mfma_f32_16x16x32_bf16 v[132:135], v[92:95], v[44:47], v[132:135]
  ds_read_b64_tr_b16 v[90:91], v10 offset:38432
  v_mfma_f32_16x16x32_bf16 v[136:139], v[92:95], v[48:51], v[136:139]
  ds_read_b128 v[72:75], v8 offset:4096
  v_mfma_f32_16x16x32_bf16 v[140:143], v[92:95], v[52:55], v[140:143]
  ds_read_b128 v[76:79], v8 offset:6144
  v_mfma_f32_16x16x32_bf16 v[144:147], v[92:95], v[56:59], v[144:147]
  v_mfma_f32_16x16x32_bf16 v[148:151], v[92:95], v[60:63], v[148:151]
  v_mfma_f32_16x16x32_bf16 v[24:27], v[92:95], v[16:19], v[24:27]
  s_waitcnt lgkmcnt(6)
  v_mfma_f32_16x16x32_bf16 v[152:155], v[96:99], v[40:43], v[152:155]
  ds_read_b64_tr_b16 v[92:93], v9 offset:24640
  v_mfma_f32_16x16x32_bf16 v[156:159], v[96:99], v[44:47], v[156:159]
  ds_read_b64_tr_b16 v[94:95], v9 offset:26176
  v_mfma_f32_16x16x32_bf16 v[160:163], v[96:99], v[48:51], v[160:163]
  ds_read_b128 v[80:83], v8 offset:8192
  v_mfma_f32_16x16x32_bf16 v[164:167], v[96:99], v[52:55], v[164:167]
  ds_read_b128 v[84:87], v8 offset:10240
  v_mfma_f32_16x16x32_bf16 v[168:171], v[96:99], v[56:59], v[168:171]
  v_mfma_f32_16x16x32_bf16 v[172:175], v[96:99], v[60:63], v[172:175]
  v_mfma_f32_16x16x32_bf16 v[28:31], v[96:99], v[16:19], v[28:31]
  s_waitcnt lgkmcnt(6)
  v_mfma_f32_16x16x32_bf16 v[176:179], v[88:91], v[40:43], v[176:179]
  ds_read_b64_tr_b16 v[96:97], v9 offset:36928
  v_mfma_f32_16x16x32_bf16 v[180:183], v[88:91], v[44:47], v[180:183]
  ds_read_b64_tr_b16 v[98:99], v9 offset:38464
  v_mfma_f32_16x16x32_bf16 v[184:187], v[88:91], v[48:51], v[184:187]
  v_mfma_f32_16x16x32_bf16 v[188:191], v[88:91], v[52:55], v[188:191]
  v_mfma_f32_16x16x32_bf16 v[192:195], v[88:91], v[56:59], v[192:195]
  v_mfma_f32_16x16x32_bf16 v[196:199], v[88:91], v[60:63], v[196:199]
  v_mfma_f32_16x16x32_bf16 v[32:35], v[88:91], v[16:19], v[32:35]
  s_waitcnt lgkmcnt(4)
  v_mfma_f32_16x16x32_bf16 v[200:203], v[92:95], v[40:43], v[200:203]
  ds_read_b64_tr_b16 v[88:89], v2 offset:24576
  v_mfma_f32_16x16x32_bf16 v[204:207], v[92:95], v[44:47], v[204:207]
  ds_read_b64_tr_b16 v[90:91], v2 offset:26112
  v_mfma_f32_16x16x32_bf16 v[208:211], v[92:95], v[48:51], v[208:211]
  v_mfma_f32_16x16x32_bf16 v[212:215], v[92:95], v[52:55], v[212:215]
  v_mfma_f32_16x16x32_bf16 v[216:219], v[92:95], v[56:59], v[216:219]
  v_mfma_f32_16x16x32_bf16 v[220:223], v[92:95], v[60:63], v[220:223]
  v_mfma_f32_16x16x32_bf16 v[248:251], v[92:95], v[16:19], v[248:251]
  s_waitcnt lgkmcnt(2)
  v_mfma_f32_16x16x32_bf16 v[224:227], v[96:99], v[40:43], v[224:227]
  ds_read_b64_tr_b16 v[92:93], v2 offset:36864
  v_mfma_f32_16x16x32_bf16 v[228:231], v[96:99], v[44:47], v[228:231]
  ds_read_b64_tr_b16 v[94:95], v2 offset:38400
  v_mfma_f32_16x16x32_bf16 v[232:235], v[96:99], v[48:51], v[232:235]
  v_mfma_f32_16x16x32_bf16 v[236:239], v[96:99], v[52:55], v[236:239]
  v_mfma_f32_16x16x32_bf16 v[240:243], v[96:99], v[56:59], v[240:243]
  v_mfma_f32_16x16x32_bf16 v[244:247], v[96:99], v[60:63], v[244:247]
  v_mfma_f32_16x16x32_bf16 v[252:255], v[96:99], v[16:19], v[252:255]
  s_waitcnt lgkmcnt(2)
  v_mfma_f32_16x16x32_bf16 v[104:107], v[88:91], v[64:67], v[104:107]
  ds_read_b64_tr_b16 v[96:97], v3 offset:24608
  v_mfma_f32_16x16x32_bf16 v[108:111], v[88:91], v[68:71], v[108:111]
  ds_read_b64_tr_b16 v[98:99], v3 offset:26144
  v_mfma_f32_16x16x32_bf16 v[112:115], v[88:91], v[72:75], v[112:115]
  v_mfma_f32_16x16x32_bf16 v[116:119], v[88:91], v[76:79], v[116:119]
  v_mfma_f32_16x16x32_bf16 v[120:123], v[88:91], v[80:83], v[120:123]
  v_mfma_f32_16x16x32_bf16 v[124:127], v[88:91], v[84:87], v[124:127]
  s_waitcnt lgkmcnt(2)
  v_mfma_f32_16x16x32_bf16 v[128:131], v[92:95], v[64:67], v[128:131]
  ds_read_b64_tr_b16 v[88:89], v3 offset:36896
  v_mfma_f32_16x16x32_bf16 v[132:135], v[92:95], v[68:71], v[132:135]
  ds_read_b64_tr_b16 v[90:91], v3 offset:38432
  v_mfma_f32_16x16x32_bf16 v[136:139], v[92:95], v[72:75], v[136:139]
  v_mfma_f32_16x16x32_bf16 v[140:143], v[92:95], v[76:79], v[140:143]
  v_mfma_f32_16x16x32_bf16 v[144:147], v[92:95], v[80:83], v[144:147]
  v_mfma_f32_16x16x32_bf16 v[148:151], v[92:95], v[84:87], v[148:151]
  s_waitcnt lgkmcnt(2)
  v_mfma_f32_16x16x32_bf16 v[152:155], v[96:99], v[64:67], v[152:155]
  ds_read_b64_tr_b16 v[92:93], v2 offset:24640
  v_mfma_f32_16x16x32_bf16 v[156:159], v[96:99], v[68:71], v[156:159]
  ds_read_b64_tr_b16 v[94:95], v2 offset:26176
  v_mfma_f32_16x16x32_bf16 v[160:163], v[96:99], v[72:75], v[160:163]
  v_mfma_f32_16x16x32_bf16 v[164:167], v[96:99], v[76:79], v[164:167]
  v_mfma_f32_16x16x32_bf16 v[168:171], v[96:99], v[80:83], v[168:171]
  v_mfma_f32_16x16x32_bf16 v[172:175], v[96:99], v[84:87], v[172:175]
  s_waitcnt lgkmcnt(2)
  v_mfma_f32_16x16x32_bf16 v[176:179], v[88:91], v[64:67], v[176:179]
  ds_read_b64_tr_b16 v[96:97], v2 offset:36928
  v_mfma_f32_16x16x32_bf16 v[180:183], v[88:91], v[68:71], v[180:183]
  ds_read_b64_tr_b16 v[98:99], v2 offset:38464
  v_mfma_f32_16x16x32_bf16 v[184:187], v[88:91], v[72:75], v[184:187]
  v_add_u32 v7, -102400, v7
  v_add_u32 v8, -102400, v8
  v_mfma_f32_16x16x32_bf16 v[188:191], v[88:91], v[76:79], v[188:191]
  v_add_u32 v9, -102400, v9
  v_add_u32 v2, -102400, v2
  v_mfma_f32_16x16x32_bf16 v[192:195], v[88:91], v[80:83], v[192:195]
  v_add_u32 v10, -102400, v10
  v_add_u32 v3, -102400, v3
  v_mfma_f32_16x16x32_bf16 v[196:199], v[88:91], v[84:87], v[196:199]
  s_waitcnt lgkmcnt(0)
  s_barrier
  v_mfma_f32_16x16x32_bf16 v[200:203], v[92:95], v[64:67], v[200:203]
  ds_read_b64_tr_b16 v[88:89], v9 offset:24576
  v_mfma_f32_16x16x32_bf16 v[204:207], v[92:95], v[68:71], v[204:207]
  ds_read_b64_tr_b16 v[90:91], v9 offset:26112
  v_mfma_f32_16x16x32_bf16 v[208:211], v[92:95], v[72:75], v[208:211]
  ds_read_b128 v[40:43], v7 offset:0
  v_mfma_f32_16x16x32_bf16 v[212:215], v[92:95], v[76:79], v[212:215]
  ds_read_b128 v[44:47], v7 offset:2048
  v_mfma_f32_16x16x32_bf16 v[216:219], v[92:95], v[80:83], v[216:219]
  ds_read_b128 v[48:51], v7 offset:4096
  v_mfma_f32_16x16x32_bf16 v[220:223], v[92:95], v[84:87], v[220:223]
  v_mfma_f32_16x16x32_bf16 v[224:227], v[96:99], v[64:67], v[224:227]
  ds_read_b64_tr_b16 v[92:93], v9 offset:36864
  v_mfma_f32_16x16x32_bf16 v[228:231], v[96:99], v[68:71], v[228:231]
  ds_read_b64_tr_b16 v[94:95], v9 offset:38400
  v_mfma_f32_16x16x32_bf16 v[232:235], v[96:99], v[72:75], v[232:235]
  ds_read_b128 v[52:55], v7 offset:6144
  v_mfma_f32_16x16x32_bf16 v[236:239], v[96:99], v[76:79], v[236:239]
  ds_read_b128 v[56:59], v7 offset:8192
  v_mfma_f32_16x16x32_bf16 v[240:243], v[96:99], v[80:83], v[240:243]
  ds_read_b128 v[60:63], v7 offset:10240
  v_mfma_f32_16x16x32_bf16 v[244:247], v[96:99], v[84:87], v[244:247]
  s_waitcnt lgkmcnt(7)
  v_mfma_f32_16x16x32_bf16 v[104:107], v[88:91], v[40:43], v[104:107]
  ds_read_b64_tr_b16 v[96:97], v10 offset:24608
  s_waitcnt lgkmcnt(7)
  v_mfma_f32_16x16x32_bf16 v[108:111], v[88:91], v[44:47], v[108:111]
  ds_read_b64_tr_b16 v[98:99], v10 offset:26144
  s_waitcnt lgkmcnt(7)
  v_mfma_f32_16x16x32_bf16 v[112:115], v[88:91], v[48:51], v[112:115]
  ds_read_b128 v[64:67], v8 offset:0
  s_waitcnt lgkmcnt(5)
  v_mfma_f32_16x16x32_bf16 v[116:119], v[88:91], v[52:55], v[116:119]
  ds_read_b128 v[68:71], v8 offset:2048
  s_waitcnt lgkmcnt(5)
  v_mfma_f32_16x16x32_bf16 v[120:123], v[88:91], v[56:59], v[120:123]
  s_waitcnt lgkmcnt(4)
  v_mfma_f32_16x16x32_bf16 v[124:127], v[88:91], v[60:63], v[124:127]
  v_mfma_f32_16x16x32_bf16 v[20:23], v[88:91], v[16:19], v[20:23]
  v_mfma_f32_16x16x32_bf16 v[128:131], v[92:95], v[40:43], v[128:131]
  ds_read_b64_tr_b16 v[88:89], v10 offset:36896
  v_mfma_f32_16x16x32_bf16 v[132:135], v[92:95], v[44:47], v[132:135]
  ds_read_b64_tr_b16 v[90:91], v10 offset:38432
  v_mfma_f32_16x16x32_bf16 v[136:139], v[92:95], v[48:51], v[136:139]
  ds_read_b128 v[72:75], v8 offset:4096
  v_mfma_f32_16x16x32_bf16 v[140:143], v[92:95], v[52:55], v[140:143]
  ds_read_b128 v[76:79], v8 offset:6144
  v_mfma_f32_16x16x32_bf16 v[144:147], v[92:95], v[56:59], v[144:147]
  v_mfma_f32_16x16x32_bf16 v[148:151], v[92:95], v[60:63], v[148:151]
  v_mfma_f32_16x16x32_bf16 v[24:27], v[92:95], v[16:19], v[24:27]
  s_waitcnt lgkmcnt(6)
  v_mfma_f32_16x16x32_bf16 v[152:155], v[96:99], v[40:43], v[152:155]
  ds_read_b64_tr_b16 v[92:93], v9 offset:24640
  v_mfma_f32_16x16x32_bf16 v[156:159], v[96:99], v[44:47], v[156:159]
  ds_read_b64_tr_b16 v[94:95], v9 offset:26176
  v_mfma_f32_16x16x32_bf16 v[160:163], v[96:99], v[48:51], v[160:163]
  ds_read_b128 v[80:83], v8 offset:8192
  v_mfma_f32_16x16x32_bf16 v[164:167], v[96:99], v[52:55], v[164:167]
  ds_read_b128 v[84:87], v8 offset:10240
  v_mfma_f32_16x16x32_bf16 v[168:171], v[96:99], v[56:59], v[168:171]
  v_mfma_f32_16x16x32_bf16 v[172:175], v[96:99], v[60:63], v[172:175]
  v_mfma_f32_16x16x32_bf16 v[28:31], v[96:99], v[16:19], v[28:31]
  s_waitcnt lgkmcnt(6)
  v_mfma_f32_16x16x32_bf16 v[176:179], v[88:91], v[40:43], v[176:179]
  ds_read_b64_tr_b16 v[96:97], v9 offset:36928
  v_mfma_f32_16x16x32_bf16 v[180:183], v[88:91], v[44:47], v[180:183]
  ds_read_b64_tr_b16 v[98:99], v9 offset:38464
  v_mfma_f32_16x16x32_bf16 v[184:187], v[88:91], v[48:51], v[184:187]
  v_mfma_f32_16x16x32_bf16 v[188:191], v[88:91], v[52:55], v[188:191]
  v_mfma_f32_16x16x32_bf16 v[192:195], v[88:91], v[56:59], v[192:195]
  v_mfma_f32_16x16x32_bf16 v[196:199], v[88:91], v[60:63], v[196:199]
  v_mfma_f32_16x16x32_bf16 v[32:35], v[88:91], v[16:19], v[32:35]
  s_waitcnt lgkmcnt(4)
  v_mfma_f32_16x16x32_bf16 v[200:203], v[92:95], v[40:43], v[200:203]
  ds_read_b64_tr_b16 v[88:89], v2 offset:24576
  v_mfma_f32_16x16x32_bf16 v[204:207], v[92:95], v[44:47], v[204:207]
  ds_read_b64_tr_b16 v[90:91], v2 offset:26112
  v_mfma_f32_16x16x32_bf16 v[208:211], v[92:95], v[48:51], v[208:211]
  v_mfma_f32_16x16x32_bf16 v[212:215], v[92:95], v[52:55], v[212:215]
  v_mfma_f32_16x16x32_bf16 v[216:219], v[92:95], v[56:59], v[216:219]
  v_mfma_f32_16x16x32_bf16 v[220:223], v[92:95], v[60:63], v[220:223]
  v_mfma_f32_16x16x32_bf16 v[248:251], v[92:95], v[16:19], v[248:251]
  s_waitcnt lgkmcnt(2)
  v_mfma_f32_16x16x32_bf16 v[224:227], v[96:99], v[40:43], v[224:227]
  ds_read_b64_tr_b16 v[92:93], v2 offset:36864
  v_mfma_f32_16x16x32_bf16 v[228:231], v[96:99], v[44:47], v[228:231]
  ds_read_b64_tr_b16 v[94:95], v2 offset:38400
  v_mfma_f32_16x16x32_bf16 v[232:235], v[96:99], v[48:51], v[232:235]
  v_mfma_f32_16x16x32_bf16 v[236:239], v[96:99], v[52:55], v[236:239]
  v_mfma_f32_16x16x32_bf16 v[240:243], v[96:99], v[56:59], v[240:243]
  v_mfma_f32_16x16x32_bf16 v[244:247], v[96:99], v[60:63], v[244:247]
  v_mfma_f32_16x16x32_bf16 v[252:255], v[96:99], v[16:19], v[252:255]
  s_waitcnt lgkmcnt(2)
  v_mfma_f32_16x16x32_bf16 v[104:107], v[88:91], v[64:67], v[104:107]
  ds_read_b64_tr_b16 v[96:97], v3 offset:24608
  v_mfma_f32_16x16x32_bf16 v[108:111], v[88:91], v[68:71], v[108:111]
  ds_read_b64_tr_b16 v[98:99], v3 offset:26144
  v_mfma_f32_16x16x32_bf16 v[112:115], v[88:91], v[72:75], v[112:115]
  v_mfma_f32_16x16x32_bf16 v[116:119], v[88:91], v[76:79], v[116:119]
  v_mfma_f32_16x16x32_bf16 v[120:123], v[88:91], v[80:83], v[120:123]
  v_mfma_f32_16x16x32_bf16 v[124:127], v[88:91], v[84:87], v[124:127]
  s_waitcnt lgkmcnt(2)
  v_mfma_f32_16x16x32_bf16 v[128:131], v[92:95], v[64:67], v[128:131]
  ds_read_b64_tr_b16 v[88:89], v3 offset:36896
  v_mfma_f32_16x16x32_bf16 v[132:135], v[92:95], v[68:71], v[132:135]
  ds_read_b64_tr_b16 v[90:91], v3 offset:38432
  v_mfma_f32_16x16x32_bf16 v[136:139], v[92:95], v[72:75], v[136:139]
  v_mfma_f32_16x16x32_bf16 v[140:143], v[92:95], v[76:79], v[140:143]
  v_mfma_f32_16x16x32_bf16 v[144:147], v[92:95], v[80:83], v[144:147]
  v_mfma_f32_16x16x32_bf16 v[148:151], v[92:95], v[84:87], v[148:151]
  s_waitcnt lgkmcnt(2)
  v_mfma_f32_16x16x32_bf16 v[152:155], v[96:99], v[64:67], v[152:155]
  ds_read_b64_tr_b16 v[92:93], v2 offset:24640
  v_mfma_f32_16x16x32_bf16 v[156:159], v[96:99], v[68:71], v[156:159]
  ds_read_b64_tr_b16 v[94:95], v2 offset:26176
  v_mfma_f32_16x16x32_bf16 v[160:163], v[96:99], v[72:75], v[160:163]
  v_mfma_f32_16x16x32_bf16 v[164:167], v[96:99], v[76:79], v[164:167]
  v_mfma_f32_16x16x32_bf16 v[168:171], v[96:99], v[80:83], v[168:171]
  v_mfma_f32_16x16x32_bf16 v[172:175], v[96:99], v[84:87], v[172:175]
  s_waitcnt lgkmcnt(2)
  v_mfma_f32_16x16x32_bf16 v[176:179], v[88:91], v[64:67], v[176:179]
  ds_read_b64_tr_b16 v[96:97], v2 offset:36928
  v_mfma_f32_16x16x32_bf16 v[180:183], v[88:91], v[68:71], v[180:183]
  ds_read_b64_tr_b16 v[98:99], v2 offset:38464
  v_mfma_f32_16x16x32_bf16 v[184:187], v[88:91], v[72:75], v[184:187]
  v_add_u32 v7, 51200, v7
  v_add_u32 v8, 51200, v8
  v_mfma_f32_16x16x32_bf16 v[188:191], v[88:91], v[76:79], v[188:191]
  v_add_u32 v9, 51200, v9
  v_add_u32 v2, 51200, v2
  v_mfma_f32_16x16x32_bf16 v[192:195], v[88:91], v[80:83], v[192:195]
  v_add_u32 v10, 51200, v10
  v_add_u32 v3, 51200, v3
  v_mfma_f32_16x16x32_bf16 v[196:199], v[88:91], v[84:87], v[196:199]
  s_waitcnt lgkmcnt(0)
  s_barrier
  v_mfma_f32_16x16x32_bf16 v[200:203], v[92:95], v[64:67], v[200:203]
  ds_read_b64_tr_b16 v[88:89], v9 offset:24576
  v_mfma_f32_16x16x32_bf16 v[204:207], v[92:95], v[68:71], v[204:207]
  ds_read_b64_tr_b16 v[90:91], v9 offset:26112
  v_mfma_f32_16x16x32_bf16 v[208:211], v[92:95], v[72:75], v[208:211]
  ds_read_b128 v[40:43], v7 offset:0
  v_mfma_f32_16x16x32_bf16 v[212:215], v[92:95], v[76:79], v[212:215]
  ds_read_b128 v[44:47], v7 offset:2048
  v_mfma_f32_16x16x32_bf16 v[216:219], v[92:95], v[80:83], v[216:219]
  ds_read_b128 v[48:51], v7 offset:4096
  v_mfma_f32_16x16x32_bf16 v[220:223], v[92:95], v[84:87], v[220:223]
  v_mfma_f32_16x16x32_bf16 v[224:227], v[96:99], v[64:67], v[224:227]
  ds_read_b64_tr_b16 v[92:93], v9 offset:36864
  v_mfma_f32_16x16x32_bf16 v[228:231], v[96:99], v[68:71], v[228:231]
  ds_read_b64_tr_b16 v[94:95], v9 offset:38400
  v_mfma_f32_16x16x32_bf16 v[232:235], v[96:99], v[72:75], v[232:235]
  ds_read_b128 v[52:55], v7 offset:6144
  v_mfma_f32_16x16x32_bf16 v[236:239], v[96:99], v[76:79], v[236:239]
  ds_read_b128 v[56:59], v7 offset:8192
  v_mfma_f32_16x16x32_bf16 v[240:243], v[96:99], v[80:83], v[240:243]
  ds_read_b128 v[60:63], v7 offset:10240
  v_mfma_f32_16x16x32_bf16 v[244:247], v[96:99], v[84:87], v[244:247]
  s_waitcnt lgkmcnt(7)
  v_mfma_f32_16x16x32_bf16 v[104:107], v[88:91], v[40:43], v[104:107]
  ds_read_b64_tr_b16 v[96:97], v10 offset:24608
  s_waitcnt lgkmcnt(7)
  v_mfma_f32_16x16x32_bf16 v[108:111], v[88:91], v[44:47], v[108:111]
  ds_read_b64_tr_b16 v[98:99], v10 offset:26144
  s_waitcnt lgkmcnt(7)
  v_mfma_f32_16x16x32_bf16 v[112:115], v[88:91], v[48:51], v[112:115]
  ds_read_b128 v[64:67], v8 offset:0
  s_waitcnt lgkmcnt(5)
  v_mfma_f32_16x16x32_bf16 v[116:119], v[88:91], v[52:55], v[116:119]
  ds_read_b128 v[68:71], v8 offset:2048
  s_waitcnt lgkmcnt(5)
  v_mfma_f32_16x16x32_bf16 v[120:123], v[88:91], v[56:59], v[120:123]
  s_waitcnt lgkmcnt(4)
  v_mfma_f32_16x16x32_bf16 v[124:127], v[88:91], v[60:63], v[124:127]
  v_mfma_f32_16x16x32_bf16 v[20:23], v[88:91], v[16:19], v[20:23]
  v_mfma_f32_16x16x32_bf16 v[128:131], v[92:95], v[40:43], v[128:131]
  ds_read_b64_tr_b16 v[88:89], v10 offset:36896
  v_mfma_f32_16x16x32_bf16 v[132:135], v[92:95], v[44:47], v[132:135]
  ds_read_b64_tr_b16 v[90:91], v10 offset:38432
  v_mfma_f32_16x16x32_bf16 v[136:139], v[92:95], v[48:51], v[136:139]
  ds_read_b128 v[72:75], v8 offset:4096
  v_mfma_f32_16x16x32_bf16 v[140:143], v[92:95], v[52:55], v[140:143]
  ds_read_b128 v[76:79], v8 offset:6144
  v_mfma_f32_16x16x32_bf16 v[144:147], v[92:95], v[56:59], v[144:147]
  v_mfma_f32_16x16x32_bf16 v[148:151], v[92:95], v[60:63], v[148:151]
  v_mfma_f32_16x16x32_bf16 v[24:27], v[92:95], v[16:19], v[24:27]
  s_waitcnt lgkmcnt(6)
  v_mfma_f32_16x16x32_bf16 v[152:155], v[96:99], v[40:43], v[152:155]
  ds_read_b64_tr_b16 v[92:93], v9 offset:24640
  v_mfma_f32_16x16x32_bf16 v[156:159], v[96:99], v[44:47], v[156:159]
  ds_read_b64_tr_b16 v[94:95], v9 offset:26176
  v_mfma_f32_16x16x32_bf16 v[160:163], v[96:99], v[48:51], v[160:163]
  ds_read_b128 v[80:83], v8 offset:8192
  v_mfma_f32_16x16x32_bf16 v[164:167], v[96:99], v[52:55], v[164:167]
  ds_read_b128 v[84:87], v8 offset:10240
  v_mfma_f32_16x16x32_bf16 v[168:171], v[96:99], v[56:59], v[168:171]
  v_mfma_f32_16x16x32_bf16 v[172:175], v[96:99], v[60:63], v[172:175]
  v_mfma_f32_16x16x32_bf16 v[28:31], v[96:99], v[16:19], v[28:31]
  s_waitcnt lgkmcnt(6)
  v_mfma_f32_16x16x32_bf16 v[176:179], v[88:91], v[40:43], v[176:179]
  ds_read_b64_tr_b16 v[96:97], v9 offset:36928
  v_mfma_f32_16x16x32_bf16 v[180:183], v[88:91], v[44:47], v[180:183]
  ds_read_b64_tr_b16 v[98:99], v9 offset:38464
  v_mfma_f32_16x16x32_bf16 v[184:187], v[88:91], v[48:51], v[184:187]
  v_and_b32 v12, 15, v1
  v_lshlrev_b32 v12, 3, v12
  v_mfma_f32_16x16x32_bf16 v[188:191], v[88:91], v[52:55], v[188:191]
  s_lshr_b32 s60, s56, 1
  s_mul_i32 s60, s60, 768
  v_mfma_f32_16x16x32_bf16 v[192:195], v[88:91], v[56:59], v[192:195]
  s_add_u32 s60, s60, 160000
  v_add_u32 v15, s60, v12
  v_mfma_f32_16x16x32_bf16 v[196:199], v[88:91], v[60:63], v[196:199]
  v_lshlrev_b32 v12, 1, v12
  v_bfe_u32 v13, v1, 4, 1
  v_mfma_f32_16x16x32_bf16 v[32:35], v[88:91], v[16:19], v[32:35]
  v_mul_u32_u24 v13, 60416, v13
  v_lshrrev_b32 v14, 5, v1
  s_waitcnt lgkmcnt(4)
  v_mfma_f32_16x16x32_bf16 v[200:203], v[92:95], v[40:43], v[200:203]
  ds_read_b64_tr_b16 v[88:89], v2 offset:24576
  v_mfma_f32_16x16x32_bf16 v[204:207], v[92:95], v[44:47], v[204:207]
  ds_read_b64_tr_b16 v[90:91], v2 offset:26112
  v_mfma_f32_16x16x32_bf16 v[208:211], v[92:95], v[48:51], v[208:211]
  v_lshl_add_u32 v12, v14, 8, v12
  v_add_u32 v11, v12, v13
  v_mfma_f32_16x16x32_bf16 v[212:215], v[92:95], v[52:55], v[212:215]
  s_lshr_b32 s60, s56, 1
  s_mul_i32 s60, s60, 6
  v_mfma_f32_16x16x32_bf16 v[216:219], v[92:95], v[56:59], v[216:219]
  s_mul_i32 s61, s57, 12
  s_add_u32 s60, s60, s61
  v_mfma_f32_16x16x32_bf16 v[220:223], v[92:95], v[60:63], v[220:223]
  s_mul_i32 s78, s60, 60416
  s_and_b32 s60, s56, 1
  v_mfma_f32_16x16x32_bf16 v[248:251], v[92:95], v[16:19], v[248:251]
  s_mul_i32 s60, s60, 3
  s_mul_i32 s61, s58, 6
  s_waitcnt lgkmcnt(2)
  v_mfma_f32_16x16x32_bf16 v[224:227], v[96:99], v[40:43], v[224:227]
  ds_read_b64_tr_b16 v[92:93], v2 offset:36864
  v_mfma_f32_16x16x32_bf16 v[228:231], v[96:99], v[44:47], v[228:231]
  ds_read_b64_tr_b16 v[94:95], v2 offset:38400
  v_mfma_f32_16x16x32_bf16 v[232:235], v[96:99], v[48:51], v[232:235]
  s_add_u32 s60, s60, s61
  s_sub_u32 s76, s60, 16
  v_mfma_f32_16x16x32_bf16 v[236:239], v[96:99], v[52:55], v[236:239]
  v_mfma_f32_16x16x32_bf16 v[240:243], v[96:99], v[56:59], v[240:243]
  v_mfma_f32_16x16x32_bf16 v[244:247], v[96:99], v[60:63], v[244:247]
  v_mfma_f32_16x16x32_bf16 v[252:255], v[96:99], v[16:19], v[252:255]
  s_waitcnt lgkmcnt(2)
  v_mfma_f32_16x16x32_bf16 v[104:107], v[88:91], v[64:67], v[104:107]
  ds_read_b64_tr_b16 v[96:97], v3 offset:24608
  v_mfma_f32_16x16x32_bf16 v[108:111], v[88:91], v[68:71], v[108:111]
  ds_read_b64_tr_b16 v[98:99], v3 offset:26144
  ds_read_b64 v[40:41], v15 offset:0
  v_mfma_f32_16x16x32_bf16 v[112:115], v[88:91], v[72:75], v[112:115]
  ds_read_b64 v[44:45], v15 offset:128
  ds_read_b64 v[48:49], v15 offset:256
  v_mfma_f32_16x16x32_bf16 v[116:119], v[88:91], v[76:79], v[116:119]
  ds_read_b64 v[52:53], v15 offset:384
  ds_read_b64 v[56:57], v15 offset:512
  v_mfma_f32_16x16x32_bf16 v[120:123], v[88:91], v[80:83], v[120:123]
  ds_read_b64 v[60:61], v15 offset:640
  v_cndmask_b32 v36, v20, v24, s[64:65]
  v_mfma_f32_16x16x32_bf16 v[124:127], v[88:91], v[84:87], v[124:127]
  v_cndmask_b32 v37, v21, v25, s[64:65]
  v_cndmask_b32 v38, v22, v26, s[64:65]
  s_waitcnt lgkmcnt(8)
  v_mfma_f32_16x16x32_bf16 v[128:131], v[92:95], v[64:67], v[128:131]
  ds_read_b64_tr_b16 v[88:89], v3 offset:36896
  v_cndmask_b32 v39, v23, v27, s[64:65]
  v_mfma_f32_16x16x32_bf16 v[132:135], v[92:95], v[68:71], v[132:135]
  ds_read_b64_tr_b16 v[90:91], v3 offset:38432
  v_cndmask_b32 v36, v36, v28, s[66:67]
  v_mfma_f32_16x16x32_bf16 v[136:139], v[92:95], v[72:75], v[136:139]
  v_cndmask_b32 v37, v37, v29, s[66:67]
  v_cndmask_b32 v38, v38, v30, s[66:67]
  v_mfma_f32_16x16x32_bf16 v[140:143], v[92:95], v[76:79], v[140:143]
  v_cndmask_b32 v39, v39, v31, s[66:67]
  v_cndmask_b32 v36, v36, v32, s[68:69]
  v_mfma_f32_16x16x32_bf16 v[144:147], v[92:95], v[80:83], v[144:147]
  v_cndmask_b32 v37, v37, v33, s[68:69]
  v_cndmask_b32 v38, v38, v34, s[68:69]
  v_mfma_f32_16x16x32_bf16 v[148:151], v[92:95], v[84:87], v[148:151]
  v_cndmask_b32 v39, v39, v35, s[68:69]
  v_cndmask_b32 v36, v36, v248, s[70:71]
  s_waitcnt lgkmcnt(8)
  v_mfma_f32_16x16x32_bf16 v[152:155], v[96:99], v[64:67], v[152:155]
  ds_read_b64_tr_b16 v[92:93], v2 offset:24640
  v_cndmask_b32 v37, v37, v249, s[70:71]
  v_mfma_f32_16x16x32_bf16 v[156:159], v[96:99], v[68:71], v[156:159]
  ds_read_b64_tr_b16 v[94:95], v2 offset:26176
  v_cndmask_b32 v38, v38, v250, s[70:71]
  v_mfma_f32_16x16x32_bf16 v[160:163], v[96:99], v[72:75], v[160:163]
  v_cndmask_b32 v39, v39, v251, s[70:71]
  v_cndmask_b32 v36, v36, v252, s[72:73]
  v_mfma_f32_16x16x32_bf16 v[164:167], v[96:99], v[76:79], v[164:167]
  v_cndmask_b32 v37, v37, v253, s[72:73]
  v_cndmask_b32 v38, v38, v254, s[72:73]
  v_mfma_f32_16x16x32_bf16 v[168:171], v[96:99], v[80:83], v[168:171]
  v_cndmask_b32 v39, v39, v255, s[72:73]
  ds_write_b128 v4, v[36:39]
  v_mfma_f32_16x16x32_bf16 v[172:175], v[96:99], v[84:87], v[172:175]
  s_waitcnt lgkmcnt(10)
  v_mul_f32 v42, 0xc0135761, v41
  s_waitcnt lgkmcnt(9)
  v_mul_f32 v46, 0xc0135761, v45
  s_waitcnt lgkmcnt(3)
  v_mfma_f32_16x16x32_bf16 v[176:179], v[88:91], v[64:67], v[176:179]
  ds_read_b64_tr_b16 v[96:97], v2 offset:36928
  v_mul_f32 v50, 0xc0135761, v49
  v_mfma_f32_16x16x32_bf16 v[180:183], v[88:91], v[68:71], v[180:183]
  ds_read_b64_tr_b16 v[98:99], v2 offset:38464
  v_mul_f32 v54, 0xc0135761, v53
  v_mfma_f32_16x16x32_bf16 v[184:187], v[88:91], v[72:75], v[184:187]
  v_mul_f32 v58, 0xc0135761, v57
  v_mul_f32 v62, 0xc0135761, v61
  v_mfma_f32_16x16x32_bf16 v[188:191], v[88:91], v[76:79], v[188:191]
  v_mul_f32 v41, v41, v41
  v_mul_f32 v45, v45, v45
  v_mfma_f32_16x16x32_bf16 v[192:195], v[88:91], v[80:83], v[192:195]
  v_mul_f32 v49, v49, v49
  v_mul_f32 v53, v53, v53
  v_mfma_f32_16x16x32_bf16 v[196:199], v[88:91], v[84:87], v[196:199]
  v_mul_f32 v57, v57, v57
  v_mul_f32 v61, v61, v61
  s_waitcnt lgkmcnt(0)
  s_barrier
  v_mfma_f32_16x16x32_bf16 v[200:203], v[92:95], v[64:67], v[200:203]
  ds_read_b128 v[36:39], v5 offset:0
  ds_read_b128 v[100:103], v5 offset:64
  v_mfma_f32_16x16x32_bf16 v[204:207], v[92:95], v[68:71], v[204:207]
  ds_read_b128 v[88:91], v5 offset:128
  v_mul_f32 v43, v41, v42
  v_mfma_f32_16x16x32_bf16 v[208:211], v[92:95], v[72:75], v[208:211]
  v_mul_f32 v47, v45, v46
  v_mul_f32 v51, v49, v50
  v_mfma_f32_16x16x32_bf16 v[212:215], v[92:95], v[76:79], v[212:215]
  v_mul_f32 v55, v53, v54
  v_mul_f32 v59, v57, v58
  v_mfma_f32_16x16x32_bf16 v[216:219], v[92:95], v[80:83], v[216:219]
  v_mul_f32 v63, v61, v62
  v_rcp_f32 v41, v41
  v_mfma_f32_16x16x32_bf16 v[220:223], v[92:95], v[84:87], v[220:223]
  v_rcp_f32 v45, v45
  v_rcp_f32 v49, v49
  v_mfma_f32_16x16x32_bf16 v[224:227], v[96:99], v[64:67], v[224:227]
  v_rcp_f32 v53, v53
  v_rcp_f32 v57, v57
  v_mfma_f32_16x16x32_bf16 v[228:231], v[96:99], v[68:71], v[228:231]
  v_rcp_f32 v61, v61
  v_mul_f32 v43, 0x3d372713, v43
  v_mul_f32 v47, 0x3d372713, v47
  v_mul_f32 v51, 0x3d372713, v51
  v_mul_f32 v55, 0x3d372713, v55
  v_mul_f32 v59, 0x3d372713, v59
  v_mul_f32 v63, 0x3d372713, v63
  v_mfma_f32_16x16x32_bf16 v[232:235], v[96:99], v[72:75], v[232:235]
  s_waitcnt lgkmcnt(2)
  v_add_f32 v20, v20, v36
  v_add_f32 v21, v21, v37
  v_mfma_f32_16x16x32_bf16 v[236:239], v[96:99], v[76:79], v[236:239]
  v_add_f32 v22, v22, v38
  v_add_f32 v23, v23, v39
  v_mfma_f32_16x16x32_bf16 v[240:243], v[96:99], v[80:83], v[240:243]
  s_waitcnt lgkmcnt(1)
  v_add_f32 v24, v24, v100
  v_add_f32 v25, v25, v101
  v_mfma_f32_16x16x32_bf16 v[244:247], v[96:99], v[84:87], v[244:247]
  v_add_f32 v26, v26, v102
  v_add_f32 v27, v27, v103
  ds_read_b128 v[92:95], v5 offset:192
  ds_read_b128 v[36:39], v5 offset:256
  ds_read_b128 v[100:103], v5 offset:320
  s_add_u32 s60, s76, 0
  s_cmp_lt_u32 s60, 118
  s_cselect_b32 s61, s78, 0x7f000000
  s_lshl_b32 s60, s60, 9
  s_add_u32 s77, s61, s60
  s_add_u32 s64, s77, 0
  v_pk_fma_f32 v[104:105], v[20:21], v[40:41], v[104:105] op_sel_hi:[1,0,1]
  v_pk_fma_f32 v[106:107], v[22:23], v[40:41], v[106:107] op_sel_hi:[1,0,1]
  v_pk_fma_f32 v[108:109], v[20:21], v[44:45], v[108:109] op_sel_hi:[1,0,1]
  v_pk_fma_f32 v[110:111], v[22:23], v[44:45], v[110:111] op_sel_hi:[1,0,1]
  v_pk_mul_f32 v[64:65], v[104:105], v[104:105]
  v_pk_mul_f32 v[66:67], v[106:107], v[106:107]
  v_pk_mul_f32 v[68:69], v[108:109], v[108:109]
  v_pk_mul_f32 v[70:71], v[110:111], v[110:111]
  v_pk_fma_f32 v[64:65], v[64:65], v[42:43], v[42:43] op_sel:[0,1,0] op_sel_hi:[1,1,0]
  v_pk_fma_f32 v[66:67], v[66:67], v[42:43], v[42:43] op_sel:[0,1,0] op_sel_hi:[1,1,0]
  v_pk_fma_f32 v[68:69], v[68:69], v[46:47], v[46:47] op_sel:[0,1,0] op_sel_hi:[1,1,0]
  v_pk_fma_f32 v[70:71], v[70:71], v[46:47], v[46:47] op_sel:[0,1,0] op_sel_hi:[1,1,0]
  v_pk_mul_f32 v[64:65], v[64:65], v[104:105]
  v_pk_mul_f32 v[66:67], v[66:67], v[106:107]
  v_pk_mul_f32 v[68:69], v[68:69], v[108:109]
  v_pk_mul_f32 v[70:71], v[70:71], v[110:111]
  v_exp_f32 v64, v64
  v_exp_f32 v65, v65
  v_exp_f32 v66, v66
  v_exp_f32 v67, v67
  v_exp_f32 v68, v68
  v_exp_f32 v69, v69
  v_exp_f32 v70, v70
  v_exp_f32 v71, v71
  v_pk_fma_f32 v[128:129], v[24:25], v[40:41], v[128:129] op_sel_hi:[1,0,1]
  v_pk_fma_f32 v[130:131], v[26:27], v[40:41], v[130:131] op_sel_hi:[1,0,1]
  v_pk_fma_f32 v[132:133], v[24:25], v[44:45], v[132:133] op_sel_hi:[1,0,1]
  v_pk_fma_f32 v[134:135], v[26:27], v[44:45], v[134:135] op_sel_hi:[1,0,1]
  v_pk_fma_f32 v[64:65], v[64:65], v[40:41], v[40:41] op_sel:[0,1,1]
  v_pk_fma_f32 v[66:67], v[66:67], v[40:41], v[40:41] op_sel:[0,1,1]
  v_pk_fma_f32 v[68:69], v[68:69], v[44:45], v[44:45] op_sel:[0,1,1]
  v_pk_fma_f32 v[70:71], v[70:71], v[44:45], v[44:45] op_sel:[0,1,1]
  v_rcp_f32 v64, v64
  v_rcp_f32 v65, v65
  v_rcp_f32 v66, v66
  v_rcp_f32 v67, v67
  v_rcp_f32 v68, v68
  v_rcp_f32 v69, v69
  v_rcp_f32 v70, v70
  v_rcp_f32 v71, v71
  v_pk_mul_f32 v[128:129], v[128:129], v[104:105]
  v_pk_mul_f32 v[130:131], v[130:131], v[106:107]
  v_pk_mul_f32 v[132:133], v[132:133], v[108:109]
  v_pk_mul_f32 v[134:135], v[134:135], v[110:111]
  v_pk_mul_f32 v[64:65], v[64:65], v[128:129]
  v_pk_mul_f32 v[66:67], v[66:67], v[130:131]
  v_pk_mul_f32 v[68:69], v[68:69], v[132:133]
  v_pk_mul_f32 v[70:71], v[70:71], v[134:135]
  v_cvt_pk_bf16_f32 v104, v64, v65
  v_cvt_pk_bf16_f32 v105, v66, v67
  v_cvt_pk_bf16_f32 v106, v68, v69
  v_cvt_pk_bf16_f32 v107, v70, v71
  s_nop 0
  v_permlane16_swap_b32 v104, v106
  v_permlane16_swap_b32 v105, v107
  s_add_u32 s65, s77, 120832
  v_pk_fma_f32 v[112:113], v[20:21], v[48:49], v[112:113] op_sel_hi:[1,0,1]
  v_pk_fma_f32 v[114:115], v[22:23], v[48:49], v[114:115] op_sel_hi:[1,0,1]
  v_pk_fma_f32 v[116:117], v[20:21], v[52:53], v[116:117] op_sel_hi:[1,0,1]
  v_pk_fma_f32 v[118:119], v[22:23], v[52:53], v[118:119] op_sel_hi:[1,0,1]
  v_pk_mul_f32 v[80:81], v[112:113], v[112:113]
  v_pk_mul_f32 v[82:83], v[114:115], v[114:115]
  v_pk_mul_f32 v[84:85], v[116:117], v[116:117]
  v_pk_mul_f32 v[86:87], v[118:119], v[118:119]
  v_pk_fma_f32 v[80:81], v[80:81], v[50:51], v[50:51] op_sel:[0,1,0] op_sel_hi:[1,1,0]
  v_pk_fma_f32 v[82:83], v[82:83], v[50:51], v[50:51] op_sel:[0,1,0] op_sel_hi:[1,1,0]
  v_pk_fma_f32 v[84:85], v[84:85], v[54:55], v[54:55] op_sel:[0,1,0] op_sel_hi:[1,1,0]
  v_pk_fma_f32 v[86:87], v[86:87], v[54:55], v[54:55] op_sel:[0,1,0] op_sel_hi:[1,1,0]
  v_pk_mul_f32 v[80:81], v[80:81], v[112:113]
  v_pk_mul_f32 v[82:83], v[82:83], v[114:115]
  v_pk_mul_f32 v[84:85], v[84:85], v[116:117]
  v_pk_mul_f32 v[86:87], v[86:87], v[118:119]
  v_exp_f32 v80, v80
  v_exp_f32 v81, v81
  v_exp_f32 v82, v82
  v_exp_f32 v83, v83
  v_exp_f32 v84, v84
  v_exp_f32 v85, v85
  v_exp_f32 v86, v86
  v_exp_f32 v87, v87
  v_pk_fma_f32 v[136:137], v[24:25], v[48:49], v[136:137] op_sel_hi:[1,0,1]
  v_pk_fma_f32 v[138:139], v[26:27], v[48:49], v[138:139] op_sel_hi:[1,0,1]
  v_pk_fma_f32 v[140:141], v[24:25], v[52:53], v[140:141] op_sel_hi:[1,0,1]
  v_pk_fma_f32 v[142:143], v[26:27], v[52:53], v[142:143] op_sel_hi:[1,0,1]
  v_pk_fma_f32 v[80:81], v[80:81], v[48:49], v[48:49] op_sel:[0,1,1]
  v_pk_fma_f32 v[82:83], v[82:83], v[48:49], v[48:49] op_sel:[0,1,1]
  v_pk_fma_f32 v[84:85], v[84:85], v[52:53], v[52:53] op_sel:[0,1,1]
  v_pk_fma_f32 v[86:87], v[86:87], v[52:53], v[52:53] op_sel:[0,1,1]
  v_rcp_f32 v80, v80
  v_rcp_f32 v81, v81
  v_rcp_f32 v82, v82
  v_rcp_f32 v83, v83
  v_rcp_f32 v84, v84
  v_rcp_f32 v85, v85
  v_rcp_f32 v86, v86
  v_rcp_f32 v87, v87
  v_pk_mul_f32 v[136:137], v[136:137], v[112:113]
  v_pk_mul_f32 v[138:139], v[138:139], v[114:115]
  v_pk_mul_f32 v[140:141], v[140:141], v[116:117]
  v_pk_mul_f32 v[142:143], v[142:143], v[118:119]
  v_pk_mul_f32 v[80:81], v[80:81], v[136:137]
  v_pk_mul_f32 v[82:83], v[82:83], v[138:139]
  v_pk_mul_f32 v[84:85], v[84:85], v[140:141]
  v_pk_mul_f32 v[86:87], v[86:87], v[142:143]
  v_cvt_pk_bf16_f32 v112, v80, v81
  v_cvt_pk_bf16_f32 v113, v82, v83
  v_cvt_pk_bf16_f32 v114, v84, v85
  v_cvt_pk_bf16_f32 v115, v86, v87
  s_nop 0
  v_permlane16_swap_b32 v112, v114
  v_permlane16_swap_b32 v113, v115
  s_add_u32 s66, s77, 241664
  v_pk_fma_f32 v[120:121], v[20:21], v[56:57], v[120:121] op_sel_hi:[1,0,1]
  v_pk_fma_f32 v[122:123], v[22:23], v[56:57], v[122:123] op_sel_hi:[1,0,1]
  v_pk_fma_f32 v[124:125], v[20:21], v[60:61], v[124:125] op_sel_hi:[1,0,1]
  v_pk_fma_f32 v[126:127], v[22:23], v[60:61], v[126:127] op_sel_hi:[1,0,1]
  v_pk_mul_f32 v[64:65], v[120:121], v[120:121]
  v_pk_mul_f32 v[66:67], v[122:123], v[122:123]
  v_pk_mul_f32 v[68:69], v[124:125], v[124:125]
  v_pk_mul_f32 v[70:71], v[126:127], v[126:127]
  v_pk_fma_f32 v[64:65], v[64:65], v[58:59], v[58:59] op_sel:[0,1,0] op_sel_hi:[1,1,0]
  v_pk_fma_f32 v[66:67], v[66:67], v[58:59], v[58:59] op_sel:[0,1,0] op_sel_hi:[1,1,0]
  v_pk_fma_f32 v[68:69], v[68:69], v[62:63], v[62:63] op_sel:[0,1,0] op_sel_hi:[1,1,0]
  v_pk_fma_f32 v[70:71], v[70:71], v[62:63], v[62:63] op_sel:[0,1,0] op_sel_hi:[1,1,0]
  v_pk_mul_f32 v[64:65], v[64:65], v[120:121]
  v_pk_mul_f32 v[66:67], v[66:67], v[122:123]
  v_pk_mul_f32 v[68:69], v[68:69], v[124:125]
  v_pk_mul_f32 v[70:71], v[70:71], v[126:127]
  v_exp_f32 v64, v64
  v_exp_f32 v65, v65
  v_exp_f32 v66, v66
  v_exp_f32 v67, v67
  v_exp_f32 v68, v68
  v_exp_f32 v69, v69
  v_exp_f32 v70, v70
  v_exp_f32 v71, v71
  v_pk_fma_f32 v[144:145], v[24:25], v[56:57], v[144:145] op_sel_hi:[1,0,1]
  v_pk_fma_f32 v[146:147], v[26:27], v[56:57], v[146:147] op_sel_hi:[1,0,1]
  v_pk_fma_f32 v[148:149], v[24:25], v[60:61], v[148:149] op_sel_hi:[1,0,1]
  v_pk_fma_f32 v[150:151], v[26:27], v[60:61], v[150:151] op_sel_hi:[1,0,1]
  v_pk_fma_f32 v[64:65], v[64:65], v[56:57], v[56:57] op_sel:[0,1,1]
  v_pk_fma_f32 v[66:67], v[66:67], v[56:57], v[56:57] op_sel:[0,1,1]
  v_pk_fma_f32 v[68:69], v[68:69], v[60:61], v[60:61] op_sel:[0,1,1]
  v_pk_fma_f32 v[70:71], v[70:71], v[60:61], v[60:61] op_sel:[0,1,1]
  v_rcp_f32 v64, v64
  v_rcp_f32 v65, v65
  v_rcp_f32 v66, v66
  v_rcp_f32 v67, v67
  v_rcp_f32 v68, v68
  v_rcp_f32 v69, v69
  v_rcp_f32 v70, v70
  v_rcp_f32 v71, v71
  v_pk_mul_f32 v[144:145], v[144:145], v[120:121]
  v_pk_mul_f32 v[146:147], v[146:147], v[122:123]
  v_pk_mul_f32 v[148:149], v[148:149], v[124:125]
  v_pk_mul_f32 v[150:151], v[150:151], v[126:127]
  v_pk_mul_f32 v[64:65], v[64:65], v[144:145]
  v_pk_mul_f32 v[66:67], v[66:67], v[146:147]
  v_pk_mul_f32 v[68:69], v[68:69], v[148:149]
  v_pk_mul_f32 v[70:71], v[70:71], v[150:151]
  v_cvt_pk_bf16_f32 v120, v64, v65
  v_cvt_pk_bf16_f32 v121, v66, v67
  v_cvt_pk_bf16_f32 v122, v68, v69
  v_cvt_pk_bf16_f32 v123, v70, v71
  s_nop 0
  v_permlane16_swap_b32 v120, v122
  v_permlane16_swap_b32 v121, v123
  buffer_store_dwordx4 v[104:107], v11, s[16:19], s64 offen sc0 sc1
  buffer_store_dwordx4 v[112:115], v11, s[16:19], s65 offen sc0 sc1
  s_waitcnt lgkmcnt(3)
  v_pk_add_f32 v[28:29], v[28:29], v[88:89]
  v_pk_add_f32 v[30:31], v[30:31], v[90:91]
  s_waitcnt lgkmcnt(2)
  v_pk_add_f32 v[32:33], v[32:33], v[92:93]
  v_pk_add_f32 v[34:35], v[34:35], v[94:95]
  s_add_u32 s60, s76, 1
  s_cmp_lt_u32 s60, 118
  s_cselect_b32 s61, s78, 0x7f000000
  s_lshl_b32 s60, s60, 9
  s_add_u32 s77, s61, s60
  s_add_u32 s67, s77, 0
  v_pk_fma_f32 v[152:153], v[28:29], v[40:41], v[152:153] op_sel_hi:[1,0,1]
  v_pk_fma_f32 v[154:155], v[30:31], v[40:41], v[154:155] op_sel_hi:[1,0,1]
  v_pk_fma_f32 v[156:157], v[28:29], v[44:45], v[156:157] op_sel_hi:[1,0,1]
  v_pk_fma_f32 v[158:159], v[30:31], v[44:45], v[158:159] op_sel_hi:[1,0,1]
  v_pk_mul_f32 v[80:81], v[152:153], v[152:153]
  v_pk_mul_f32 v[82:83], v[154:155], v[154:155]
  v_pk_mul_f32 v[84:85], v[156:157], v[156:157]
  v_pk_mul_f32 v[86:87], v[158:159], v[158:159]
  v_pk_fma_f32 v[80:81], v[80:81], v[42:43], v[42:43] op_sel:[0,1,0] op_sel_hi:[1,1,0]
  v_pk_fma_f32 v[82:83], v[82:83], v[42:43], v[42:43] op_sel:[0,1,0] op_sel_hi:[1,1,0]
  v_pk_fma_f32 v[84:85], v[84:85], v[46:47], v[46:47] op_sel:[0,1,0] op_sel_hi:[1,1,0]
  v_pk_fma_f32 v[86:87], v[86:87], v[46:47], v[46:47] op_sel:[0,1,0] op_sel_hi:[1,1,0]
  v_pk_mul_f32 v[80:81], v[80:81], v[152:153]
  v_pk_mul_f32 v[82:83], v[82:83], v[154:155]
  v_pk_mul_f32 v[84:85], v[84:85], v[156:157]
  v_pk_mul_f32 v[86:87], v[86:87], v[158:159]
  v_exp_f32 v80, v80
  v_exp_f32 v81, v81
  v_exp_f32 v82, v82
  v_exp_f32 v83, v83
  v_exp_f32 v84, v84
  v_exp_f32 v85, v85
  v_exp_f32 v86, v86
  v_exp_f32 v87, v87
  v_pk_fma_f32 v[176:177], v[32:33], v[40:41], v[176:177] op_sel_hi:[1,0,1]
  v_pk_fma_f32 v[178:179], v[34:35], v[40:41], v[178:179] op_sel_hi:[1,0,1]
  v_pk_fma_f32 v[180:181], v[32:33], v[44:45], v[180:181] op_sel_hi:[1,0,1]
  v_pk_fma_f32 v[182:183], v[34:35], v[44:45], v[182:183] op_sel_hi:[1,0,1]
  v_pk_fma_f32 v[80:81], v[80:81], v[40:41], v[40:41] op_sel:[0,1,1]
  v_pk_fma_f32 v[82:83], v[82:83], v[40:41], v[40:41] op_sel:[0,1,1]
  v_pk_fma_f32 v[84:85], v[84:85], v[44:45], v[44:45] op_sel:[0,1,1]
  v_pk_fma_f32 v[86:87], v[86:87], v[44:45], v[44:45] op_sel:[0,1,1]
  v_rcp_f32 v80, v80
  v_rcp_f32 v81, v81
  v_rcp_f32 v82, v82
  v_rcp_f32 v83, v83
  v_rcp_f32 v84, v84
  v_rcp_f32 v85, v85
  v_rcp_f32 v86, v86
  v_rcp_f32 v87, v87
  v_pk_mul_f32 v[176:177], v[176:177], v[152:153]
  v_pk_mul_f32 v[178:179], v[178:179], v[154:155]
  v_pk_mul_f32 v[180:181], v[180:181], v[156:157]
  v_pk_mul_f32 v[182:183], v[182:183], v[158:159]
  v_pk_mul_f32 v[80:81], v[80:81], v[176:177]
  v_pk_mul_f32 v[82:83], v[82:83], v[178:179]
  v_pk_mul_f32 v[84:85], v[84:85], v[180:181]
  v_pk_mul_f32 v[86:87], v[86:87], v[182:183]
  v_cvt_pk_bf16_f32 v152, v80, v81
  v_cvt_pk_bf16_f32 v153, v82, v83
  v_cvt_pk_bf16_f32 v154, v84, v85
  v_cvt_pk_bf16_f32 v155, v86, v87
  s_nop 0
  v_permlane16_swap_b32 v152, v154
  v_permlane16_swap_b32 v153, v155
  buffer_store_dwordx4 v[120:123], v11, s[16:19], s66 offen sc0 sc1
  buffer_store_dwordx4 v[152:155], v11, s[16:19], s67 offen sc0 sc1
  s_add_u32 s68, s77, 120832
  v_pk_fma_f32 v[160:161], v[28:29], v[48:49], v[160:161] op_sel_hi:[1,0,1]
  v_pk_fma_f32 v[162:163], v[30:31], v[48:49], v[162:163] op_sel_hi:[1,0,1]
  v_pk_fma_f32 v[164:165], v[28:29], v[52:53], v[164:165] op_sel_hi:[1,0,1]
  v_pk_fma_f32 v[166:167], v[30:31], v[52:53], v[166:167] op_sel_hi:[1,0,1]
  v_pk_mul_f32 v[64:65], v[160:161], v[160:161]
  v_pk_mul_f32 v[66:67], v[162:163], v[162:163]
  v_pk_mul_f32 v[68:69], v[164:165], v[164:165]
  v_pk_mul_f32 v[70:71], v[166:167], v[166:167]
  v_pk_fma_f32 v[64:65], v[64:65], v[50:51], v[50:51] op_sel:[0,1,0] op_sel_hi:[1,1,0]
  v_pk_fma_f32 v[66:67], v[66:67], v[50:51], v[50:51] op_sel:[0,1,0] op_sel_hi:[1,1,0]
  v_pk_fma_f32 v[68:69], v[68:69], v[54:55], v[54:55] op_sel:[0,1,0] op_sel_hi:[1,1,0]
  v_pk_fma_f32 v[70:71], v[70:71], v[54:55], v[54:55] op_sel:[0,1,0] op_sel_hi:[1,1,0]
  v_pk_mul_f32 v[64:65], v[64:65], v[160:161]
  v_pk_mul_f32 v[66:67], v[66:67], v[162:163]
  v_pk_mul_f32 v[68:69], v[68:69], v[164:165]
  v_pk_mul_f32 v[70:71], v[70:71], v[166:167]
  v_exp_f32 v64, v64
  v_exp_f32 v65, v65
  v_exp_f32 v66, v66
  v_exp_f32 v67, v67
  v_exp_f32 v68, v68
  v_exp_f32 v69, v69
  v_exp_f32 v70, v70
  v_exp_f32 v71, v71
  v_pk_fma_f32 v[184:185], v[32:33], v[48:49], v[184:185] op_sel_hi:[1,0,1]
  v_pk_fma_f32 v[186:187], v[34:35], v[48:49], v[186:187] op_sel_hi:[1,0,1]
  v_pk_fma_f32 v[188:189], v[32:33], v[52:53], v[188:189] op_sel_hi:[1,0,1]
  v_pk_fma_f32 v[190:191], v[34:35], v[52:53], v[190:191] op_sel_hi:[1,0,1]
  v_pk_fma_f32 v[64:65], v[64:65], v[48:49], v[48:49] op_sel:[0,1,1]
  v_pk_fma_f32 v[66:67], v[66:67], v[48:49], v[48:49] op_sel:[0,1,1]
  v_pk_fma_f32 v[68:69], v[68:69], v[52:53], v[52:53] op_sel:[0,1,1]
  v_pk_fma_f32 v[70:71], v[70:71], v[52:53], v[52:53] op_sel:[0,1,1]
  v_rcp_f32 v64, v64
  v_rcp_f32 v65, v65
  v_rcp_f32 v66, v66
  v_rcp_f32 v67, v67
  v_rcp_f32 v68, v68
  v_rcp_f32 v69, v69
  v_rcp_f32 v70, v70
  v_rcp_f32 v71, v71
  v_pk_mul_f32 v[184:185], v[184:185], v[160:161]
  v_pk_mul_f32 v[186:187], v[186:187], v[162:163]
  v_pk_mul_f32 v[188:189], v[188:189], v[164:165]
  v_pk_mul_f32 v[190:191], v[190:191], v[166:167]
  v_pk_mul_f32 v[64:65], v[64:65], v[184:185]
  v_pk_mul_f32 v[66:67], v[66:67], v[186:187]
  v_pk_mul_f32 v[68:69], v[68:69], v[188:189]
  v_pk_mul_f32 v[70:71], v[70:71], v[190:191]
  v_cvt_pk_bf16_f32 v160, v64, v65
  v_cvt_pk_bf16_f32 v161, v66, v67
  v_cvt_pk_bf16_f32 v162, v68, v69
  v_cvt_pk_bf16_f32 v163, v70, v71
  s_nop 0
  v_permlane16_swap_b32 v160, v162
  v_permlane16_swap_b32 v161, v163
  buffer_store_dwordx4 v[160:163], v11, s[16:19], s68 offen sc0 sc1
  s_add_u32 s69, s77, 241664
  v_pk_fma_f32 v[168:169], v[28:29], v[56:57], v[168:169] op_sel_hi:[1,0,1]
  v_pk_fma_f32 v[170:171], v[30:31], v[56:57], v[170:171] op_sel_hi:[1,0,1]
  v_pk_fma_f32 v[172:173], v[28:29], v[60:61], v[172:173] op_sel_hi:[1,0,1]
  v_pk_fma_f32 v[174:175], v[30:31], v[60:61], v[174:175] op_sel_hi:[1,0,1]
  v_pk_mul_f32 v[80:81], v[168:169], v[168:169]
  v_pk_mul_f32 v[82:83], v[170:171], v[170:171]
  v_pk_mul_f32 v[84:85], v[172:173], v[172:173]
  v_pk_mul_f32 v[86:87], v[174:175], v[174:175]
  v_pk_fma_f32 v[80:81], v[80:81], v[58:59], v[58:59] op_sel:[0,1,0] op_sel_hi:[1,1,0]
  v_pk_fma_f32 v[82:83], v[82:83], v[58:59], v[58:59] op_sel:[0,1,0] op_sel_hi:[1,1,0]
  v_pk_fma_f32 v[84:85], v[84:85], v[62:63], v[62:63] op_sel:[0,1,0] op_sel_hi:[1,1,0]
  v_pk_fma_f32 v[86:87], v[86:87], v[62:63], v[62:63] op_sel:[0,1,0] op_sel_hi:[1,1,0]
  v_pk_mul_f32 v[80:81], v[80:81], v[168:169]
  v_pk_mul_f32 v[82:83], v[82:83], v[170:171]
  v_pk_mul_f32 v[84:85], v[84:85], v[172:173]
  v_pk_mul_f32 v[86:87], v[86:87], v[174:175]
  v_exp_f32 v80, v80
  v_exp_f32 v81, v81
  v_exp_f32 v82, v82
  v_exp_f32 v83, v83
  v_exp_f32 v84, v84
  v_exp_f32 v85, v85
  v_exp_f32 v86, v86
  v_exp_f32 v87, v87
  v_pk_fma_f32 v[192:193], v[32:33], v[56:57], v[192:193] op_sel_hi:[1,0,1]
  v_pk_fma_f32 v[194:195], v[34:35], v[56:57], v[194:195] op_sel_hi:[1,0,1]
  v_pk_fma_f32 v[196:197], v[32:33], v[60:61], v[196:197] op_sel_hi:[1,0,1]
  v_pk_fma_f32 v[198:199], v[34:35], v[60:61], v[198:199] op_sel_hi:[1,0,1]
  v_pk_fma_f32 v[80:81], v[80:81], v[56:57], v[56:57] op_sel:[0,1,1]
  v_pk_fma_f32 v[82:83], v[82:83], v[56:57], v[56:57] op_sel:[0,1,1]
  v_pk_fma_f32 v[84:85], v[84:85], v[60:61], v[60:61] op_sel:[0,1,1]
  v_pk_fma_f32 v[86:87], v[86:87], v[60:61], v[60:61] op_sel:[0,1,1]
  v_rcp_f32 v80, v80
  v_rcp_f32 v81, v81
  v_rcp_f32 v82, v82
  v_rcp_f32 v83, v83
  v_rcp_f32 v84, v84
  v_rcp_f32 v85, v85
  v_rcp_f32 v86, v86
  v_rcp_f32 v87, v87
  v_pk_mul_f32 v[192:193], v[192:193], v[168:169]
  v_pk_mul_f32 v[194:195], v[194:195], v[170:171]
  v_pk_mul_f32 v[196:197], v[196:197], v[172:173]
  v_pk_mul_f32 v[198:199], v[198:199], v[174:175]
  v_pk_mul_f32 v[80:81], v[80:81], v[192:193]
  v_pk_mul_f32 v[82:83], v[82:83], v[194:195]
  v_pk_mul_f32 v[84:85], v[84:85], v[196:197]
  v_pk_mul_f32 v[86:87], v[86:87], v[198:199]
  v_cvt_pk_bf16_f32 v168, v80, v81
  v_cvt_pk_bf16_f32 v169, v82, v83
  v_cvt_pk_bf16_f32 v170, v84, v85
  v_cvt_pk_bf16_f32 v171, v86, v87
  s_nop 0
  v_permlane16_swap_b32 v168, v170
  v_permlane16_swap_b32 v169, v171
  buffer_store_dwordx4 v[168:171], v11, s[16:19], s69 offen sc0 sc1
  s_waitcnt lgkmcnt(1)
  v_pk_add_f32 v[248:249], v[248:249], v[36:37]
  v_pk_add_f32 v[250:251], v[250:251], v[38:39]
  s_waitcnt lgkmcnt(0)
  v_pk_add_f32 v[252:253], v[252:253], v[100:101]
  v_pk_add_f32 v[254:255], v[254:255], v[102:103]
  s_add_u32 s60, s76, 2
  s_cmp_lt_u32 s60, 118
  s_cselect_b32 s61, s78, 0x7f000000
  s_lshl_b32 s60, s60, 9
  s_add_u32 s77, s61, s60
  s_add_u32 s70, s77, 0
  v_pk_fma_f32 v[200:201], v[248:249], v[40:41], v[200:201] op_sel_hi:[1,0,1]
  v_pk_fma_f32 v[202:203], v[250:251], v[40:41], v[202:203] op_sel_hi:[1,0,1]
  v_pk_fma_f32 v[204:205], v[248:249], v[44:45], v[204:205] op_sel_hi:[1,0,1]
  v_pk_fma_f32 v[206:207], v[250:251], v[44:45], v[206:207] op_sel_hi:[1,0,1]
  v_pk_mul_f32 v[64:65], v[200:201], v[200:201]
  v_pk_mul_f32 v[66:67], v[202:203], v[202:203]
  v_pk_mul_f32 v[68:69], v[204:205], v[204:205]
  v_pk_mul_f32 v[70:71], v[206:207], v[206:207]
  v_pk_fma_f32 v[64:65], v[64:65], v[42:43], v[42:43] op_sel:[0,1,0] op_sel_hi:[1,1,0]
  v_pk_fma_f32 v[66:67], v[66:67], v[42:43], v[42:43] op_sel:[0,1,0] op_sel_hi:[1,1,0]
  v_pk_fma_f32 v[68:69], v[68:69], v[46:47], v[46:47] op_sel:[0,1,0] op_sel_hi:[1,1,0]
  v_pk_fma_f32 v[70:71], v[70:71], v[46:47], v[46:47] op_sel:[0,1,0] op_sel_hi:[1,1,0]
  v_pk_mul_f32 v[64:65], v[64:65], v[200:201]
  v_pk_mul_f32 v[66:67], v[66:67], v[202:203]
  v_pk_mul_f32 v[68:69], v[68:69], v[204:205]
  v_pk_mul_f32 v[70:71], v[70:71], v[206:207]
  v_exp_f32 v64, v64
  v_exp_f32 v65, v65
  v_exp_f32 v66, v66
  v_exp_f32 v67, v67
  v_exp_f32 v68, v68
  v_exp_f32 v69, v69
  v_exp_f32 v70, v70
  v_exp_f32 v71, v71
  v_pk_fma_f32 v[224:225], v[252:253], v[40:41], v[224:225] op_sel_hi:[1,0,1]
  v_pk_fma_f32 v[226:227], v[254:255], v[40:41], v[226:227] op_sel_hi:[1,0,1]
  v_pk_fma_f32 v[228:229], v[252:253], v[44:45], v[228:229] op_sel_hi:[1,0,1]
  v_pk_fma_f32 v[230:231], v[254:255], v[44:45], v[230:231] op_sel_hi:[1,0,1]
  v_pk_fma_f32 v[64:65], v[64:65], v[40:41], v[40:41] op_sel:[0,1,1]
  v_pk_fma_f32 v[66:67], v[66:67], v[40:41], v[40:41] op_sel:[0,1,1]
  v_pk_fma_f32 v[68:69], v[68:69], v[44:45], v[44:45] op_sel:[0,1,1]
  v_pk_fma_f32 v[70:71], v[70:71], v[44:45], v[44:45] op_sel:[0,1,1]
  v_rcp_f32 v64, v64
  v_rcp_f32 v65, v65
  v_rcp_f32 v66, v66
  v_rcp_f32 v67, v67
  v_rcp_f32 v68, v68
  v_rcp_f32 v69, v69
  v_rcp_f32 v70, v70
  v_rcp_f32 v71, v71
  v_pk_mul_f32 v[224:225], v[224:225], v[200:201]
  v_pk_mul_f32 v[226:227], v[226:227], v[202:203]
  v_pk_mul_f32 v[228:229], v[228:229], v[204:205]
  v_pk_mul_f32 v[230:231], v[230:231], v[206:207]
  v_pk_mul_f32 v[64:65], v[64:65], v[224:225]
  v_pk_mul_f32 v[66:67], v[66:67], v[226:227]
  v_pk_mul_f32 v[68:69], v[68:69], v[228:229]
  v_pk_mul_f32 v[70:71], v[70:71], v[230:231]
  v_cvt_pk_bf16_f32 v200, v64, v65
  v_cvt_pk_bf16_f32 v201, v66, v67
  v_cvt_pk_bf16_f32 v202, v68, v69
  v_cvt_pk_bf16_f32 v203, v70, v71
  s_nop 0
  v_permlane16_swap_b32 v200, v202
  v_permlane16_swap_b32 v201, v203
  buffer_store_dwordx4 v[200:203], v11, s[16:19], s70 offen sc0 sc1
  s_add_u32 s71, s77, 120832
  v_pk_fma_f32 v[208:209], v[248:249], v[48:49], v[208:209] op_sel_hi:[1,0,1]
  v_pk_fma_f32 v[210:211], v[250:251], v[48:49], v[210:211] op_sel_hi:[1,0,1]
  v_pk_fma_f32 v[212:213], v[248:249], v[52:53], v[212:213] op_sel_hi:[1,0,1]
  v_pk_fma_f32 v[214:215], v[250:251], v[52:53], v[214:215] op_sel_hi:[1,0,1]
  v_pk_mul_f32 v[80:81], v[208:209], v[208:209]
  v_pk_mul_f32 v[82:83], v[210:211], v[210:211]
  v_pk_mul_f32 v[84:85], v[212:213], v[212:213]
  v_pk_mul_f32 v[86:87], v[214:215], v[214:215]
  v_pk_fma_f32 v[80:81], v[80:81], v[50:51], v[50:51] op_sel:[0,1,0] op_sel_hi:[1,1,0]
  v_pk_fma_f32 v[82:83], v[82:83], v[50:51], v[50:51] op_sel:[0,1,0] op_sel_hi:[1,1,0]
  v_pk_fma_f32 v[84:85], v[84:85], v[54:55], v[54:55] op_sel:[0,1,0] op_sel_hi:[1,1,0]
  v_pk_fma_f32 v[86:87], v[86:87], v[54:55], v[54:55] op_sel:[0,1,0] op_sel_hi:[1,1,0]
  v_pk_mul_f32 v[80:81], v[80:81], v[208:209]
  v_pk_mul_f32 v[82:83], v[82:83], v[210:211]
  v_pk_mul_f32 v[84:85], v[84:85], v[212:213]
  v_pk_mul_f32 v[86:87], v[86:87], v[214:215]
  v_exp_f32 v80, v80
  v_exp_f32 v81, v81
  v_exp_f32 v82, v82
  v_exp_f32 v83, v83
  v_exp_f32 v84, v84
  v_exp_f32 v85, v85
  v_exp_f32 v86, v86
  v_exp_f32 v87, v87
  v_pk_fma_f32 v[232:233], v[252:253], v[48:49], v[232:233] op_sel_hi:[1,0,1]
  v_pk_fma_f32 v[234:235], v[254:255], v[48:49], v[234:235] op_sel_hi:[1,0,1]
  v_pk_fma_f32 v[236:237], v[252:253], v[52:53], v[236:237] op_sel_hi:[1,0,1]
  v_pk_fma_f32 v[238:239], v[254:255], v[52:53], v[238:239] op_sel_hi:[1,0,1]
  v_pk_fma_f32 v[80:81], v[80:81], v[48:49], v[48:49] op_sel:[0,1,1]
  v_pk_fma_f32 v[82:83], v[82:83], v[48:49], v[48:49] op_sel:[0,1,1]
  v_pk_fma_f32 v[84:85], v[84:85], v[52:53], v[52:53] op_sel:[0,1,1]
  v_pk_fma_f32 v[86:87], v[86:87], v[52:53], v[52:53] op_sel:[0,1,1]
  v_rcp_f32 v80, v80
  v_rcp_f32 v81, v81
  v_rcp_f32 v82, v82
  v_rcp_f32 v83, v83
  v_rcp_f32 v84, v84
  v_rcp_f32 v85, v85
  v_rcp_f32 v86, v86
  v_rcp_f32 v87, v87
  v_pk_mul_f32 v[232:233], v[232:233], v[208:209]
  v_pk_mul_f32 v[234:235], v[234:235], v[210:211]
  v_pk_mul_f32 v[236:237], v[236:237], v[212:213]
  v_pk_mul_f32 v[238:239], v[238:239], v[214:215]
  v_pk_mul_f32 v[80:81], v[80:81], v[232:233]
  v_pk_mul_f32 v[82:83], v[82:83], v[234:235]
  v_pk_mul_f32 v[84:85], v[84:85], v[236:237]
  v_pk_mul_f32 v[86:87], v[86:87], v[238:239]
  v_cvt_pk_bf16_f32 v208, v80, v81
  v_cvt_pk_bf16_f32 v209, v82, v83
  v_cvt_pk_bf16_f32 v210, v84, v85
  v_cvt_pk_bf16_f32 v211, v86, v87
  s_nop 0
  v_permlane16_swap_b32 v208, v210
  v_permlane16_swap_b32 v209, v211
  buffer_store_dwordx4 v[208:211], v11, s[16:19], s71 offen sc0 sc1
  s_add_u32 s72, s77, 241664
  v_pk_fma_f32 v[216:217], v[248:249], v[56:57], v[216:217] op_sel_hi:[1,0,1]
  v_pk_fma_f32 v[218:219], v[250:251], v[56:57], v[218:219] op_sel_hi:[1,0,1]
  v_pk_fma_f32 v[220:221], v[248:249], v[60:61], v[220:221] op_sel_hi:[1,0,1]
  v_pk_fma_f32 v[222:223], v[250:251], v[60:61], v[222:223] op_sel_hi:[1,0,1]
  v_pk_mul_f32 v[64:65], v[216:217], v[216:217]
  v_pk_mul_f32 v[66:67], v[218:219], v[218:219]
  v_pk_mul_f32 v[68:69], v[220:221], v[220:221]
  v_pk_mul_f32 v[70:71], v[222:223], v[222:223]
  v_pk_fma_f32 v[64:65], v[64:65], v[58:59], v[58:59] op_sel:[0,1,0] op_sel_hi:[1,1,0]
  v_pk_fma_f32 v[66:67], v[66:67], v[58:59], v[58:59] op_sel:[0,1,0] op_sel_hi:[1,1,0]
  v_pk_fma_f32 v[68:69], v[68:69], v[62:63], v[62:63] op_sel:[0,1,0] op_sel_hi:[1,1,0]
  v_pk_fma_f32 v[70:71], v[70:71], v[62:63], v[62:63] op_sel:[0,1,0] op_sel_hi:[1,1,0]
  v_pk_mul_f32 v[64:65], v[64:65], v[216:217]
  v_pk_mul_f32 v[66:67], v[66:67], v[218:219]
  v_pk_mul_f32 v[68:69], v[68:69], v[220:221]
  v_pk_mul_f32 v[70:71], v[70:71], v[222:223]
  v_exp_f32 v64, v64
  v_exp_f32 v65, v65
  v_exp_f32 v66, v66
  v_exp_f32 v67, v67
  v_exp_f32 v68, v68
  v_exp_f32 v69, v69
  v_exp_f32 v70, v70
  v_exp_f32 v71, v71
  v_pk_fma_f32 v[240:241], v[252:253], v[56:57], v[240:241] op_sel_hi:[1,0,1]
  v_pk_fma_f32 v[242:243], v[254:255], v[56:57], v[242:243] op_sel_hi:[1,0,1]
  v_pk_fma_f32 v[244:245], v[252:253], v[60:61], v[244:245] op_sel_hi:[1,0,1]
  v_pk_fma_f32 v[246:247], v[254:255], v[60:61], v[246:247] op_sel_hi:[1,0,1]
  v_pk_fma_f32 v[64:65], v[64:65], v[56:57], v[56:57] op_sel:[0,1,1]
  v_pk_fma_f32 v[66:67], v[66:67], v[56:57], v[56:57] op_sel:[0,1,1]
  v_pk_fma_f32 v[68:69], v[68:69], v[60:61], v[60:61] op_sel:[0,1,1]
  v_pk_fma_f32 v[70:71], v[70:71], v[60:61], v[60:61] op_sel:[0,1,1]
  v_rcp_f32 v64, v64
  v_rcp_f32 v65, v65
  v_rcp_f32 v66, v66
  v_rcp_f32 v67, v67
  v_rcp_f32 v68, v68
  v_rcp_f32 v69, v69
  v_rcp_f32 v70, v70
  v_rcp_f32 v71, v71
  v_pk_mul_f32 v[240:241], v[240:241], v[216:217]
  v_pk_mul_f32 v[242:243], v[242:243], v[218:219]
  v_pk_mul_f32 v[244:245], v[244:245], v[220:221]
  v_pk_mul_f32 v[246:247], v[246:247], v[222:223]
  v_pk_mul_f32 v[64:65], v[64:65], v[240:241]
  v_pk_mul_f32 v[66:67], v[66:67], v[242:243]
  v_pk_mul_f32 v[68:69], v[68:69], v[244:245]
  v_pk_mul_f32 v[70:71], v[70:71], v[246:247]
  v_cvt_pk_bf16_f32 v216, v64, v65
  v_cvt_pk_bf16_f32 v217, v66, v67
  v_cvt_pk_bf16_f32 v218, v68, v69
  v_cvt_pk_bf16_f32 v219, v70, v71
  s_nop 0
  v_permlane16_swap_b32 v216, v218
  v_permlane16_swap_b32 v217, v219
  buffer_store_dwordx4 v[216:219], v11, s[16:19], s72 offen sc0 sc1
  s_branch L_cflag
L_catt:
  v_and_b32 v11, 15, v1
  v_lshrrev_b32 v12, 4, v1
  v_lshrrev_b32 v13, 1, v11
  v_xor_b32 v13, v13, v12
  v_lshlrev_b32 v13, 4, v13
  v_lshl_add_u32 v7, v11, 7, v13
  v_xor_b32 v8, 64, v7
  v_bfe_u32 v13, v1, 2, 2
  v_and_b32 v14, 3, v1
  v_and_b32 v15, 1, v12
  v_lshrrev_b32 v16, 1, v12
  v_lshl_add_u32 v17, v15, 2, v13
  v_lshrrev_b32 v18, 1, v17
  v_xor_b32 v18, s56, v18
  v_lshlrev_b32 v18, 5, v18
  v_lshl_add_u32 v18, v17, 7, v18
  v_lshl_add_u32 v18, v14, 3, v18
  v_mul_u32_u24 v16, 0x1800, v16
  v_add_u32 v9, v16, v18
  v_mov_b32 v16, 0x3f803f80
  v_mov_b32 v17, 0x3f803f80
  v_mov_b32 v18, 0x3f803f80
  v_mov_b32 v19, 0x3f803f80
  s_waitcnt vmcnt(0)
  s_setprio 1
  s_mov_b32 s72, 0x10001
  s_mov_b32 s73, 0x10001
  s_barrier
  ds_read_b64_tr_b16 v[44:45], v9 offset:27648
  ds_read_b64_tr_b16 v[46:47], v9 offset:30720
  ds_read_b64_tr_b16 v[48:49], v9 offset:28672
  ds_read_b64_tr_b16 v[50:51], v9 offset:31744
  ds_read_b128 v[64:67], v7 offset:0
  ds_read_b128 v[68:71], v7 offset:2048
  ds_read_b128 v[72:75], v7 offset:4096
  ds_read_b64_tr_b16 v[40:41], v9 offset:26624
  ds_read_b64_tr_b16 v[42:43], v9 offset:29696
  s_waitcnt lgkmcnt(4)
  v_cndmask_b32 v64, v64, v16, s[72:73]
  v_cndmask_b32 v65, v65, v17, s[72:73]
  v_cndmask_b32 v66, v66, v18, s[72:73]
  v_cndmask_b32 v67, v67, v19, s[72:73]
  s_nop 1
  v_mfma_f32_16x16x32_bf16 v[152:155], v[44:47], v[64:67], 0
  ds_read_b128 v[76:79], v7 offset:6144
  v_mfma_f32_16x16x32_bf16 v[204:207], v[64:67], v[48:51], 0
  s_waitcnt lgkmcnt(1)
  v_mfma_f32_16x16x32_bf16 v[20:23], v[40:43], v[64:67], 0
  v_mfma_f32_16x16x32_bf16 v[156:159], v[44:47], v[68:71], 0
  ds_read_b128 v[80:83], v7 offset:8192
  v_mfma_f32_16x16x32_bf16 v[208:211], v[68:71], v[48:51], 0
  ds_read_b64_tr_b16 v[56:57], v9 offset:39936
  v_mfma_f32_16x16x32_bf16 v[104:107], v[40:43], v[68:71], 0
  v_mfma_f32_16x16x32_bf16 v[160:163], v[44:47], v[72:75], 0
  ds_read_b128 v[64:67], v7 offset:10240
  v_mfma_f32_16x16x32_bf16 v[212:215], v[72:75], v[48:51], 0
  ds_read_b64_tr_b16 v[58:59], v9 offset:43008
  v_mfma_f32_16x16x32_bf16 v[108:111], v[40:43], v[72:75], 0
  s_waitcnt lgkmcnt(4)
  v_mfma_f32_16x16x32_bf16 v[164:167], v[44:47], v[76:79], 0
  ds_read_b128 v[68:71], v7 offset:12288
  v_mfma_f32_16x16x32_bf16 v[216:219], v[76:79], v[48:51], 0
  ds_read_b64_tr_b16 v[60:61], v9 offset:40960
  v_mfma_f32_16x16x32_bf16 v[112:115], v[40:43], v[76:79], 0
  s_waitcnt lgkmcnt(5)
  v_mfma_f32_16x16x32_bf16 v[168:171], v[44:47], v[80:83], 0
  ds_read_b128 v[72:75], v7 offset:14336
  v_mfma_f32_16x16x32_bf16 v[220:223], v[80:83], v[48:51], 0
  ds_read_b64_tr_b16 v[62:63], v9 offset:44032
  v_mfma_f32_16x16x32_bf16 v[116:119], v[40:43], v[80:83], 0
  s_waitcnt lgkmcnt(5)
  v_mfma_f32_16x16x32_bf16 v[172:175], v[44:47], v[64:67], 0
  ds_read_b128 v[76:79], v7 offset:16384
  v_mfma_f32_16x16x32_bf16 v[224:227], v[64:67], v[48:51], 0
  ds_read_b64_tr_b16 v[52:53], v9 offset:38912
  v_mfma_f32_16x16x32_bf16 v[120:123], v[40:43], v[64:67], 0
  s_waitcnt lgkmcnt(5)
  v_mfma_f32_16x16x32_bf16 v[176:179], v[44:47], v[68:71], 0
  ds_read_b128 v[80:83], v7 offset:18432
  v_mfma_f32_16x16x32_bf16 v[228:231], v[68:71], v[48:51], 0
  ds_read_b64_tr_b16 v[54:55], v9 offset:41984
  v_mfma_f32_16x16x32_bf16 v[124:127], v[40:43], v[68:71], 0
  s_waitcnt lgkmcnt(5)
  v_mfma_f32_16x16x32_bf16 v[180:183], v[44:47], v[72:75], 0
  ds_read_b128 v[64:67], v7 offset:20480
  v_mfma_f32_16x16x32_bf16 v[232:235], v[72:75], v[48:51], 0
  v_mfma_f32_16x16x32_bf16 v[128:131], v[40:43], v[72:75], 0
  s_waitcnt lgkmcnt(4)
  v_mfma_f32_16x16x32_bf16 v[184:187], v[44:47], v[76:79], 0
  ds_read_b128 v[68:71], v7 offset:22528
  v_mfma_f32_16x16x32_bf16 v[236:239], v[76:79], v[48:51], 0
  v_mfma_f32_16x16x32_bf16 v[132:135], v[40:43], v[76:79], 0
  s_waitcnt lgkmcnt(3)
  v_mfma_f32_16x16x32_bf16 v[188:191], v[44:47], v[80:83], 0
  ds_read_b128 v[72:75], v7 offset:24576
  v_mfma_f32_16x16x32_bf16 v[240:243], v[80:83], v[48:51], 0
  v_mfma_f32_16x16x32_bf16 v[136:139], v[40:43], v[80:83], 0
  s_waitcnt lgkmcnt(2)
  v_mfma_f32_16x16x32_bf16 v[192:195], v[44:47], v[64:67], 0
  ds_read_b128 v[76:79], v8 offset:0
  v_mfma_f32_16x16x32_bf16 v[244:247], v[64:67], v[48:51], 0
  v_mfma_f32_16x16x32_bf16 v[140:143], v[40:43], v[64:67], 0
  s_waitcnt lgkmcnt(2)
  v_mfma_f32_16x16x32_bf16 v[196:199], v[44:47], v[68:71], 0
  ds_read_b128 v[80:83], v8 offset:2048
  v_mfma_f32_16x16x32_bf16 v[248:251], v[68:71], v[48:51], 0
  v_mfma_f32_16x16x32_bf16 v[144:147], v[40:43], v[68:71], 0
  s_waitcnt lgkmcnt(2)
  v_mfma_f32_16x16x32_bf16 v[200:203], v[44:47], v[72:75], 0
  ds_read_b128 v[64:67], v8 offset:4096
  s_waitcnt lgkmcnt(2)
  v_cndmask_b32 v76, v76, v16, s[72:73]
  v_mfma_f32_16x16x32_bf16 v[252:255], v[72:75], v[48:51], 0
  v_cndmask_b32 v77, v77, v17, s[72:73]
  v_cndmask_b32 v78, v78, v18, s[72:73]
  v_cndmask_b32 v79, v79, v19, s[72:73]
  v_mfma_f32_16x16x32_bf16 v[148:151], v[40:43], v[72:75], 0
  s_nop 0
  v_mfma_f32_16x16x32_bf16 v[152:155], v[56:59], v[76:79], v[152:155]
  ds_read_b128 v[68:71], v8 offset:6144
  v_mfma_f32_16x16x32_bf16 v[204:207], v[76:79], v[60:63], v[204:207]
  v_mfma_f32_16x16x32_bf16 v[20:23], v[52:55], v[76:79], v[20:23]
  s_waitcnt lgkmcnt(2)
  v_mfma_f32_16x16x32_bf16 v[156:159], v[56:59], v[80:83], v[156:159]
  ds_read_b128 v[72:75], v8 offset:8192
  v_mfma_f32_16x16x32_bf16 v[208:211], v[80:83], v[60:63], v[208:211]
  v_mfma_f32_16x16x32_bf16 v[104:107], v[52:55], v[80:83], v[104:107]
  s_waitcnt lgkmcnt(2)
  v_mfma_f32_16x16x32_bf16 v[160:163], v[56:59], v[64:67], v[160:163]
  ds_read_b128 v[76:79], v8 offset:10240
  v_mfma_f32_16x16x32_bf16 v[212:215], v[64:67], v[60:63], v[212:215]
  v_mfma_f32_16x16x32_bf16 v[108:111], v[52:55], v[64:67], v[108:111]
  s_waitcnt lgkmcnt(2)
  v_mfma_f32_16x16x32_bf16 v[164:167], v[56:59], v[68:71], v[164:167]
  ds_read_b128 v[80:83], v8 offset:12288
  v_mfma_f32_16x16x32_bf16 v[216:219], v[68:71], v[60:63], v[216:219]
  v_mfma_f32_16x16x32_bf16 v[112:115], v[52:55], v[68:71], v[112:115]
  s_waitcnt lgkmcnt(2)
  v_mfma_f32_16x16x32_bf16 v[168:171], v[56:59], v[72:75], v[168:171]
  ds_read_b128 v[64:67], v8 offset:14336
  v_mfma_f32_16x16x32_bf16 v[220:223], v[72:75], v[60:63], v[220:223]
  v_mfma_f32_16x16x32_bf16 v[116:119], v[52:55], v[72:75], v[116:119]
  s_waitcnt lgkmcnt(2)
  v_mfma_f32_16x16x32_bf16 v[172:175], v[56:59], v[76:79], v[172:175]
  ds_read_b128 v[68:71], v8 offset:16384
  v_mfma_f32_16x16x32_bf16 v[224:227], v[76:79], v[60:63], v[224:227]
  v_mfma_f32_16x16x32_bf16 v[120:123], v[52:55], v[76:79], v[120:123]
  s_waitcnt lgkmcnt(2)
  v_mfma_f32_16x16x32_bf16 v[176:179], v[56:59], v[80:83], v[176:179]
  ds_read_b128 v[72:75], v8 offset:18432
  v_mfma_f32_16x16x32_bf16 v[228:231], v[80:83], v[60:63], v[228:231]
  v_mfma_f32_16x16x32_bf16 v[124:127], v[52:55], v[80:83], v[124:127]
  s_waitcnt lgkmcnt(2)
  v_mfma_f32_16x16x32_bf16 v[180:183], v[56:59], v[64:67], v[180:183]
  ds_read_b128 v[76:79], v8 offset:20480
  v_mfma_f32_16x16x32_bf16 v[232:235], v[64:67], v[60:63], v[232:235]
  v_mfma_f32_16x16x32_bf16 v[128:131], v[52:55], v[64:67], v[128:131]
  s_waitcnt lgkmcnt(2)
  v_mfma_f32_16x16x32_bf16 v[184:187], v[56:59], v[68:71], v[184:187]
  ds_read_b128 v[80:83], v8 offset:22528
  v_mfma_f32_16x16x32_bf16 v[236:239], v[68:71], v[60:63], v[236:239]
  v_mfma_f32_16x16x32_bf16 v[132:135], v[52:55], v[68:71], v[132:135]
  s_waitcnt lgkmcnt(2)
  v_mfma_f32_16x16x32_bf16 v[188:191], v[56:59], v[72:75], v[188:191]
  ds_read_b128 v[64:67], v8 offset:24576
  v_mfma_f32_16x16x32_bf16 v[240:243], v[72:75], v[60:63], v[240:243]
  v_add_u32 v7, 51200, v7
  v_add_u32 v8, 51200, v8
  v_mfma_f32_16x16x32_bf16 v[136:139], v[52:55], v[72:75], v[136:139]
  v_add_u32 v9, 51200, v9
  s_waitcnt lgkmcnt(0)
  s_barrier
  v_mfma_f32_16x16x32_bf16 v[192:195], v[56:59], v[76:79], v[192:195]
  ds_read_b128 v[68:71], v7 offset:0
  v_mfma_f32_16x16x32_bf16 v[244:247], v[76:79], v[60:63], v[244:247]
  ds_read_b64_tr_b16 v[44:45], v9 offset:27648
  v_mfma_f32_16x16x32_bf16 v[140:143], v[52:55], v[76:79], v[140:143]
  ds_read_b64_tr_b16 v[46:47], v9 offset:30720
  v_mfma_f32_16x16x32_bf16 v[196:199], v[56:59], v[80:83], v[196:199]
  ds_read_b128 v[72:75], v7 offset:2048
  v_mfma_f32_16x16x32_bf16 v[248:251], v[80:83], v[60:63], v[248:251]
  ds_read_b64_tr_b16 v[48:49], v9 offset:28672
  v_mfma_f32_16x16x32_bf16 v[144:147], v[52:55], v[80:83], v[144:147]
  ds_read_b64_tr_b16 v[50:51], v9 offset:31744
  v_mfma_f32_16x16x32_bf16 v[200:203], v[56:59], v[64:67], v[200:203]
  ds_read_b128 v[76:79], v7 offset:4096
  s_waitcnt lgkmcnt(6)
  v_cndmask_b32 v68, v68, v16, s[72:73]
  v_mfma_f32_16x16x32_bf16 v[252:255], v[64:67], v[60:63], v[252:255]
  v_cndmask_b32 v69, v69, v17, s[72:73]
  v_cndmask_b32 v70, v70, v18, s[72:73]
  v_cndmask_b32 v71, v71, v19, s[72:73]
  ds_read_b64_tr_b16 v[40:41], v9 offset:26624
  v_mfma_f32_16x16x32_bf16 v[148:151], v[52:55], v[64:67], v[148:151]
  ds_read_b64_tr_b16 v[42:43], v9 offset:29696
  s_waitcnt lgkmcnt(6)
  v_mfma_f32_16x16x32_bf16 v[152:155], v[44:47], v[68:71], v[152:155]
  ds_read_b128 v[80:83], v7 offset:6144
  s_waitcnt lgkmcnt(4)
  v_mfma_f32_16x16x32_bf16 v[204:207], v[68:71], v[48:51], v[204:207]
  s_waitcnt lgkmcnt(1)
  v_mfma_f32_16x16x32_bf16 v[20:23], v[40:43], v[68:71], v[20:23]
  v_mfma_f32_16x16x32_bf16 v[156:159], v[44:47], v[72:75], v[156:159]
  ds_read_b128 v[64:67], v7 offset:8192
  v_mfma_f32_16x16x32_bf16 v[208:211], v[72:75], v[48:51], v[208:211]
  ds_read_b64_tr_b16 v[56:57], v9 offset:39936
  v_mfma_f32_16x16x32_bf16 v[104:107], v[40:43], v[72:75], v[104:107]
  v_mfma_f32_16x16x32_bf16 v[160:163], v[44:47], v[76:79], v[160:163]
  ds_read_b128 v[68:71], v7 offset:10240
  v_mfma_f32_16x16x32_bf16 v[212:215], v[76:79], v[48:51], v[212:215]
  ds_read_b64_tr_b16 v[58:59], v9 offset:43008
  v_mfma_f32_16x16x32_bf16 v[108:111], v[40:43], v[76:79], v[108:111]
  s_waitcnt lgkmcnt(4)
  v_mfma_f32_16x16x32_bf16 v[164:167], v[44:47], v[80:83], v[164:167]
  ds_read_b128 v[72:75], v7 offset:12288
  v_mfma_f32_16x16x32_bf16 v[216:219], v[80:83], v[48:51], v[216:219]
  ds_read_b64_tr_b16 v[60:61], v9 offset:40960
  v_mfma_f32_16x16x32_bf16 v[112:115], v[40:43], v[80:83], v[112:115]
  s_waitcnt lgkmcnt(5)
  v_mfma_f32_16x16x32_bf16 v[168:171], v[44:47], v[64:67], v[168:171]
  ds_read_b128 v[76:79], v7 offset:14336
  v_mfma_f32_16x16x32_bf16 v[220:223], v[64:67], v[48:51], v[220:223]
  ds_read_b64_tr_b16 v[62:63], v9 offset:44032
  v_mfma_f32_16x16x32_bf16 v[116:119], v[40:43], v[64:67], v[116:119]
  s_waitcnt lgkmcnt(5)
  v_mfma_f32_16x16x32_bf16 v[172:175], v[44:47], v[68:71], v[172:175]
  ds_read_b128 v[80:83], v7 offset:16384
  v_mfma_f32_16x16x32_bf16 v[224:227], v[68:71], v[48:51], v[224:227]
  ds_read_b64_tr_b16 v[52:53], v9 offset:38912
  v_mfma_f32_16x16x32_bf16 v[120:123], v[40:43], v[68:71], v[120:123]
  s_waitcnt lgkmcnt(5)
  v_mfma_f32_16x16x32_bf16 v[176:179], v[44:47], v[72:75], v[176:179]
  ds_read_b128 v[64:67], v7 offset:18432
  v_mfma_f32_16x16x32_bf16 v[228:231], v[72:75], v[48:51], v[228:231]
  ds_read_b64_tr_b16 v[54:55], v9 offset:41984
  v_mfma_f32_16x16x32_bf16 v[124:127], v[40:43], v[72:75], v[124:127]
  s_waitcnt lgkmcnt(5)
  v_mfma_f32_16x16x32_bf16 v[180:183], v[44:47], v[76:79], v[180:183]
  ds_read_b128 v[68:71], v7 offset:20480
  v_mfma_f32_16x16x32_bf16 v[232:235], v[76:79], v[48:51], v[232:235]
  v_mfma_f32_16x16x32_bf16 v[128:131], v[40:43], v[76:79], v[128:131]
  s_waitcnt lgkmcnt(4)
  v_mfma_f32_16x16x32_bf16 v[184:187], v[44:47], v[80:83], v[184:187]
  ds_read_b128 v[72:75], v7 offset:22528
  v_mfma_f32_16x16x32_bf16 v[236:239], v[80:83], v[48:51], v[236:239]
  v_mfma_f32_16x16x32_bf16 v[132:135], v[40:43], v[80:83], v[132:135]
  s_waitcnt lgkmcnt(3)
  v_mfma_f32_16x16x32_bf16 v[188:191], v[44:47], v[64:67], v[188:191]
  ds_read_b128 v[76:79], v7 offset:24576
  v_mfma_f32_16x16x32_bf16 v[240:243], v[64:67], v[48:51], v[240:243]
  v_mfma_f32_16x16x32_bf16 v[136:139], v[40:43], v[64:67], v[136:139]
  s_waitcnt lgkmcnt(2)
  v_mfma_f32_16x16x32_bf16 v[192:195], v[44:47], v[68:71], v[192:195]
  ds_read_b128 v[80:83], v8 offset:0
  v_mfma_f32_16x16x32_bf16 v[244:247], v[68:71], v[48:51], v[244:247]
  v_mfma_f32_16x16x32_bf16 v[140:143], v[40:43], v[68:71], v[140:143]
  s_waitcnt lgkmcnt(2)
  v_mfma_f32_16x16x32_bf16 v[196:199], v[44:47], v[72:75], v[196:199]
  ds_read_b128 v[64:67], v8 offset:2048
  v_mfma_f32_16x16x32_bf16 v[248:251], v[72:75], v[48:51], v[248:251]
  v_mfma_f32_16x16x32_bf16 v[144:147], v[40:43], v[72:75], v[144:147]
  s_waitcnt lgkmcnt(2)
  v_mfma_f32_16x16x32_bf16 v[200:203], v[44:47], v[76:79], v[200:203]
  ds_read_b128 v[68:71], v8 offset:4096
  s_waitcnt lgkmcnt(2)
  v_cndmask_b32 v80, v80, v16, s[72:73]
  v_mfma_f32_16x16x32_bf16 v[252:255], v[76:79], v[48:51], v[252:255]
  v_cndmask_b32 v81, v81, v17, s[72:73]
  v_cndmask_b32 v82, v82, v18, s[72:73]
  v_cndmask_b32 v83, v83, v19, s[72:73]
  v_mfma_f32_16x16x32_bf16 v[148:151], v[40:43], v[76:79], v[148:151]
  s_nop 0
  v_mfma_f32_16x16x32_bf16 v[152:155], v[56:59], v[80:83], v[152:155]
  ds_read_b128 v[72:75], v8 offset:6144
  v_mfma_f32_16x16x32_bf16 v[204:207], v[80:83], v[60:63], v[204:207]
  v_mfma_f32_16x16x32_bf16 v[20:23], v[52:55], v[80:83], v[20:23]
  s_waitcnt lgkmcnt(2)
  v_mfma_f32_16x16x32_bf16 v[156:159], v[56:59], v[64:67], v[156:159]
  ds_read_b128 v[76:79], v8 offset:8192
  v_mfma_f32_16x16x32_bf16 v[208:211], v[64:67], v[60:63], v[208:211]
  v_mfma_f32_16x16x32_bf16 v[104:107], v[52:55], v[64:67], v[104:107]
  s_waitcnt lgkmcnt(2)
  v_mfma_f32_16x16x32_bf16 v[160:163], v[56:59], v[68:71], v[160:163]
  ds_read_b128 v[80:83], v8 offset:10240
  v_mfma_f32_16x16x32_bf16 v[212:215], v[68:71], v[60:63], v[212:215]
  v_mfma_f32_16x16x32_bf16 v[108:111], v[52:55], v[68:71], v[108:111]
  s_waitcnt lgkmcnt(2)
  v_mfma_f32_16x16x32_bf16 v[164:167], v[56:59], v[72:75], v[164:167]
  ds_read_b128 v[64:67], v8 offset:12288
  v_mfma_f32_16x16x32_bf16 v[216:219], v[72:75], v[60:63], v[216:219]
  v_mfma_f32_16x16x32_bf16 v[112:115], v[52:55], v[72:75], v[112:115]
  s_waitcnt lgkmcnt(2)
  v_mfma_f32_16x16x32_bf16 v[168:171], v[56:59], v[76:79], v[168:171]
  ds_read_b128 v[68:71], v8 offset:14336
  v_mfma_f32_16x16x32_bf16 v[220:223], v[76:79], v[60:63], v[220:223]
  v_mfma_f32_16x16x32_bf16 v[116:119], v[52:55], v[76:79], v[116:119]
  s_waitcnt lgkmcnt(2)
  v_mfma_f32_16x16x32_bf16 v[172:175], v[56:59], v[80:83], v[172:175]
  ds_read_b128 v[72:75], v8 offset:16384
  v_mfma_f32_16x16x32_bf16 v[224:227], v[80:83], v[60:63], v[224:227]
  v_mfma_f32_16x16x32_bf16 v[120:123], v[52:55], v[80:83], v[120:123]
  s_waitcnt lgkmcnt(2)
  v_mfma_f32_16x16x32_bf16 v[176:179], v[56:59], v[64:67], v[176:179]
  ds_read_b128 v[76:79], v8 offset:18432
  v_mfma_f32_16x16x32_bf16 v[228:231], v[64:67], v[60:63], v[228:231]
  v_mfma_f32_16x16x32_bf16 v[124:127], v[52:55], v[64:67], v[124:127]
  s_waitcnt lgkmcnt(2)
  v_mfma_f32_16x16x32_bf16 v[180:183], v[56:59], v[68:71], v[180:183]
  ds_read_b128 v[80:83], v8 offset:20480
  v_mfma_f32_16x16x32_bf16 v[232:235], v[68:71], v[60:63], v[232:235]
  v_mfma_f32_16x16x32_bf16 v[128:131], v[52:55], v[68:71], v[128:131]
  s_waitcnt lgkmcnt(2)
  v_mfma_f32_16x16x32_bf16 v[184:187], v[56:59], v[72:75], v[184:187]
  ds_read_b128 v[64:67], v8 offset:22528
  v_mfma_f32_16x16x32_bf16 v[236:239], v[72:75], v[60:63], v[236:239]
  v_mfma_f32_16x16x32_bf16 v[132:135], v[52:55], v[72:75], v[132:135]
  s_waitcnt lgkmcnt(2)
  v_mfma_f32_16x16x32_bf16 v[188:191], v[56:59], v[76:79], v[188:191]
  ds_read_b128 v[68:71], v8 offset:24576
  v_mfma_f32_16x16x32_bf16 v[240:243], v[76:79], v[60:63], v[240:243]
  v_add_u32 v7, 51200, v7
  v_add_u32 v8, 51200, v8
  v_mfma_f32_16x16x32_bf16 v[136:139], v[52:55], v[76:79], v[136:139]
  v_add_u32 v9, 51200, v9
  s_waitcnt lgkmcnt(0)
  s_barrier
  v_mfma_f32_16x16x32_bf16 v[192:195], v[56:59], v[80:83], v[192:195]
  ds_read_b128 v[72:75], v7 offset:0
  v_mfma_f32_16x16x32_bf16 v[244:247], v[80:83], v[60:63], v[244:247]
  ds_read_b64_tr_b16 v[44:45], v9 offset:27648
  v_mfma_f32_16x16x32_bf16 v[140:143], v[52:55], v[80:83], v[140:143]
  ds_read_b64_tr_b16 v[46:47], v9 offset:30720
  v_mfma_f32_16x16x32_bf16 v[196:199], v[56:59], v[64:67], v[196:199]
  ds_read_b128 v[76:79], v7 offset:2048
  v_mfma_f32_16x16x32_bf16 v[248:251], v[64:67], v[60:63], v[248:251]
  ds_read_b64_tr_b16 v[48:49], v9 offset:28672
  v_mfma_f32_16x16x32_bf16 v[144:147], v[52:55], v[64:67], v[144:147]
  ds_read_b64_tr_b16 v[50:51], v9 offset:31744
  v_mfma_f32_16x16x32_bf16 v[200:203], v[56:59], v[68:71], v[200:203]
  ds_read_b128 v[80:83], v7 offset:4096
  s_waitcnt lgkmcnt(6)
  v_cndmask_b32 v72, v72, v16, s[72:73]
  v_mfma_f32_16x16x32_bf16 v[252:255], v[68:71], v[60:63], v[252:255]
  v_cndmask_b32 v73, v73, v17, s[72:73]
  v_cndmask_b32 v74, v74, v18, s[72:73]
  v_cndmask_b32 v75, v75, v19, s[72:73]
  ds_read_b64_tr_b16 v[40:41], v9 offset:26624
  v_mfma_f32_16x16x32_bf16 v[148:151], v[52:55], v[68:71], v[148:151]
  ds_read_b64_tr_b16 v[42:43], v9 offset:29696
  s_waitcnt lgkmcnt(6)
  v_mfma_f32_16x16x32_bf16 v[152:155], v[44:47], v[72:75], v[152:155]
  ds_read_b128 v[64:67], v7 offset:6144
  s_waitcnt lgkmcnt(4)
  v_mfma_f32_16x16x32_bf16 v[204:207], v[72:75], v[48:51], v[204:207]
  s_waitcnt lgkmcnt(1)
  v_mfma_f32_16x16x32_bf16 v[20:23], v[40:43], v[72:75], v[20:23]
  v_mfma_f32_16x16x32_bf16 v[156:159], v[44:47], v[76:79], v[156:159]
  ds_read_b128 v[68:71], v7 offset:8192
  v_mfma_f32_16x16x32_bf16 v[208:211], v[76:79], v[48:51], v[208:211]
  ds_read_b64_tr_b16 v[56:57], v9 offset:39936
  v_mfma_f32_16x16x32_bf16 v[104:107], v[40:43], v[76:79], v[104:107]
  v_mfma_f32_16x16x32_bf16 v[160:163], v[44:47], v[80:83], v[160:163]
  ds_read_b128 v[72:75], v7 offset:10240
  v_mfma_f32_16x16x32_bf16 v[212:215], v[80:83], v[48:51], v[212:215]
  ds_read_b64_tr_b16 v[58:59], v9 offset:43008
  v_mfma_f32_16x16x32_bf16 v[108:111], v[40:43], v[80:83], v[108:111]
  s_waitcnt lgkmcnt(4)
  v_mfma_f32_16x16x32_bf16 v[164:167], v[44:47], v[64:67], v[164:167]
  ds_read_b128 v[76:79], v7 offset:12288
  v_mfma_f32_16x16x32_bf16 v[216:219], v[64:67], v[48:51], v[216:219]
  ds_read_b64_tr_b16 v[60:61], v9 offset:40960
  v_mfma_f32_16x16x32_bf16 v[112:115], v[40:43], v[64:67], v[112:115]
  s_waitcnt lgkmcnt(5)
  v_mfma_f32_16x16x32_bf16 v[168:171], v[44:47], v[68:71], v[168:171]
  ds_read_b128 v[80:83], v7 offset:14336
  v_mfma_f32_16x16x32_bf16 v[220:223], v[68:71], v[48:51], v[220:223]
  ds_read_b64_tr_b16 v[62:63], v9 offset:44032
  v_mfma_f32_16x16x32_bf16 v[116:119], v[40:43], v[68:71], v[116:119]
  s_waitcnt lgkmcnt(5)
  v_mfma_f32_16x16x32_bf16 v[172:175], v[44:47], v[72:75], v[172:175]
  ds_read_b128 v[64:67], v7 offset:16384
  v_mfma_f32_16x16x32_bf16 v[224:227], v[72:75], v[48:51], v[224:227]
  ds_read_b64_tr_b16 v[52:53], v9 offset:38912
  v_mfma_f32_16x16x32_bf16 v[120:123], v[40:43], v[72:75], v[120:123]
  s_waitcnt lgkmcnt(5)
  v_mfma_f32_16x16x32_bf16 v[176:179], v[44:47], v[76:79], v[176:179]
  ds_read_b128 v[68:71], v7 offset:18432
  v_mfma_f32_16x16x32_bf16 v[228:231], v[76:79], v[48:51], v[228:231]
  ds_read_b64_tr_b16 v[54:55], v9 offset:41984
  v_mfma_f32_16x16x32_bf16 v[124:127], v[40:43], v[76:79], v[124:127]
  s_waitcnt lgkmcnt(5)
  v_mfma_f32_16x16x32_bf16 v[180:183], v[44:47], v[80:83], v[180:183]
  ds_read_b128 v[72:75], v7 offset:20480
  v_mfma_f32_16x16x32_bf16 v[232:235], v[80:83], v[48:51], v[232:235]
  v_mfma_f32_16x16x32_bf16 v[128:131], v[40:43], v[80:83], v[128:131]
  s_waitcnt lgkmcnt(4)
  v_mfma_f32_16x16x32_bf16 v[184:187], v[44:47], v[64:67], v[184:187]
  ds_read_b128 v[76:79], v7 offset:22528
  v_mfma_f32_16x16x32_bf16 v[236:239], v[64:67], v[48:51], v[236:239]
  v_mfma_f32_16x16x32_bf16 v[132:135], v[40:43], v[64:67], v[132:135]
  s_waitcnt lgkmcnt(3)
  v_mfma_f32_16x16x32_bf16 v[188:191], v[44:47], v[68:71], v[188:191]
  ds_read_b128 v[80:83], v7 offset:24576
  v_mfma_f32_16x16x32_bf16 v[240:243], v[68:71], v[48:51], v[240:243]
  v_mfma_f32_16x16x32_bf16 v[136:139], v[40:43], v[68:71], v[136:139]
  s_waitcnt lgkmcnt(2)
  v_mfma_f32_16x16x32_bf16 v[192:195], v[44:47], v[72:75], v[192:195]
  ds_read_b128 v[64:67], v8 offset:0
  v_mfma_f32_16x16x32_bf16 v[244:247], v[72:75], v[48:51], v[244:247]
  v_mfma_f32_16x16x32_bf16 v[140:143], v[40:43], v[72:75], v[140:143]
  s_waitcnt lgkmcnt(2)
  v_mfma_f32_16x16x32_bf16 v[196:199], v[44:47], v[76:79], v[196:199]
  ds_read_b128 v[68:71], v8 offset:2048
  v_mfma_f32_16x16x32_bf16 v[248:251], v[76:79], v[48:51], v[248:251]
  v_mfma_f32_16x16x32_bf16 v[144:147], v[40:43], v[76:79], v[144:147]
  s_waitcnt lgkmcnt(2)
  v_mfma_f32_16x16x32_bf16 v[200:203], v[44:47], v[80:83], v[200:203]
  ds_read_b128 v[72:75], v8 offset:4096
  s_waitcnt lgkmcnt(2)
  v_cndmask_b32 v64, v64, v16, s[72:73]
  v_mfma_f32_16x16x32_bf16 v[252:255], v[80:83], v[48:51], v[252:255]
  v_cndmask_b32 v65, v65, v17, s[72:73]
  v_cndmask_b32 v66, v66, v18, s[72:73]
  v_cndmask_b32 v67, v67, v19, s[72:73]
  v_mfma_f32_16x16x32_bf16 v[148:151], v[40:43], v[80:83], v[148:151]
  s_nop 0
  v_mfma_f32_16x16x32_bf16 v[152:155], v[56:59], v[64:67], v[152:155]
  ds_read_b128 v[76:79], v8 offset:6144
  v_mfma_f32_16x16x32_bf16 v[204:207], v[64:67], v[60:63], v[204:207]
  v_mfma_f32_16x16x32_bf16 v[20:23], v[52:55], v[64:67], v[20:23]
  s_waitcnt lgkmcnt(2)
  v_mfma_f32_16x16x32_bf16 v[156:159], v[56:59], v[68:71], v[156:159]
  ds_read_b128 v[80:83], v8 offset:8192
  v_mfma_f32_16x16x32_bf16 v[208:211], v[68:71], v[60:63], v[208:211]
  v_mfma_f32_16x16x32_bf16 v[104:107], v[52:55], v[68:71], v[104:107]
  s_waitcnt lgkmcnt(2)
  v_mfma_f32_16x16x32_bf16 v[160:163], v[56:59], v[72:75], v[160:163]
  ds_read_b128 v[64:67], v8 offset:10240
  v_mfma_f32_16x16x32_bf16 v[212:215], v[72:75], v[60:63], v[212:215]
  v_mfma_f32_16x16x32_bf16 v[108:111], v[52:55], v[72:75], v[108:111]
  s_waitcnt lgkmcnt(2)
  v_mfma_f32_16x16x32_bf16 v[164:167], v[56:59], v[76:79], v[164:167]
  ds_read_b128 v[68:71], v8 offset:12288
  v_mfma_f32_16x16x32_bf16 v[216:219], v[76:79], v[60:63], v[216:219]
  v_mfma_f32_16x16x32_bf16 v[112:115], v[52:55], v[76:79], v[112:115]
  s_waitcnt lgkmcnt(2)
  v_mfma_f32_16x16x32_bf16 v[168:171], v[56:59], v[80:83], v[168:171]
  ds_read_b128 v[72:75], v8 offset:14336
  v_mfma_f32_16x16x32_bf16 v[220:223], v[80:83], v[60:63], v[220:223]
  v_mfma_f32_16x16x32_bf16 v[116:119], v[52:55], v[80:83], v[116:119]
  s_waitcnt lgkmcnt(2)
  v_mfma_f32_16x16x32_bf16 v[172:175], v[56:59], v[64:67], v[172:175]
  ds_read_b128 v[76:79], v8 offset:16384
  v_mfma_f32_16x16x32_bf16 v[224:227], v[64:67], v[60:63], v[224:227]
  v_mfma_f32_16x16x32_bf16 v[120:123], v[52:55], v[64:67], v[120:123]
  s_waitcnt lgkmcnt(2)
  v_mfma_f32_16x16x32_bf16 v[176:179], v[56:59], v[68:71], v[176:179]
  ds_read_b128 v[80:83], v8 offset:18432
  v_mfma_f32_16x16x32_bf16 v[228:231], v[68:71], v[60:63], v[228:231]
  v_mfma_f32_16x16x32_bf16 v[124:127], v[52:55], v[68:71], v[124:127]
  s_waitcnt lgkmcnt(2)
  v_mfma_f32_16x16x32_bf16 v[180:183], v[56:59], v[72:75], v[180:183]
  ds_read_b128 v[64:67], v8 offset:20480
  v_mfma_f32_16x16x32_bf16 v[232:235], v[72:75], v[60:63], v[232:235]
  v_mfma_f32_16x16x32_bf16 v[128:131], v[52:55], v[72:75], v[128:131]
  s_waitcnt lgkmcnt(2)
  v_mfma_f32_16x16x32_bf16 v[184:187], v[56:59], v[76:79], v[184:187]
  ds_read_b128 v[68:71], v8 offset:22528
  v_mfma_f32_16x16x32_bf16 v[236:239], v[76:79], v[60:63], v[236:239]
  v_mfma_f32_16x16x32_bf16 v[132:135], v[52:55], v[76:79], v[132:135]
  s_waitcnt lgkmcnt(2)
  v_mfma_f32_16x16x32_bf16 v[188:191], v[56:59], v[80:83], v[188:191]
  ds_read_b128 v[72:75], v8 offset:24576
  v_mfma_f32_16x16x32_bf16 v[240:243], v[80:83], v[60:63], v[240:243]
  v_add_u32 v7, -102400, v7
  v_add_u32 v8, -102400, v8
  v_mfma_f32_16x16x32_bf16 v[136:139], v[52:55], v[80:83], v[136:139]
  v_add_u32 v9, -102400, v9
  s_waitcnt lgkmcnt(0)
  s_barrier
  v_mfma_f32_16x16x32_bf16 v[192:195], v[56:59], v[64:67], v[192:195]
  ds_read_b128 v[76:79], v7 offset:0
  v_mfma_f32_16x16x32_bf16 v[244:247], v[64:67], v[60:63], v[244:247]
  ds_read_b64_tr_b16 v[44:45], v9 offset:27648
  v_mfma_f32_16x16x32_bf16 v[140:143], v[52:55], v[64:67], v[140:143]
  ds_read_b64_tr_b16 v[46:47], v9 offset:30720
  v_mfma_f32_16x16x32_bf16 v[196:199], v[56:59], v[68:71], v[196:199]
  ds_read_b128 v[80:83], v7 offset:2048
  v_mfma_f32_16x16x32_bf16 v[248:251], v[68:71], v[60:63], v[248:251]
  ds_read_b64_tr_b16 v[48:49], v9 offset:28672
  v_mfma_f32_16x16x32_bf16 v[144:147], v[52:55], v[68:71], v[144:147]
  ds_read_b64_tr_b16 v[50:51], v9 offset:31744
  v_mfma_f32_16x16x32_bf16 v[200:203], v[56:59], v[72:75], v[200:203]
  ds_read_b128 v[64:67], v7 offset:4096
  s_waitcnt lgkmcnt(6)
  v_cndmask_b32 v76, v76, v16, s[72:73]
  v_mfma_f32_16x16x32_bf16 v[252:255], v[72:75], v[60:63], v[252:255]
  v_cndmask_b32 v77, v77, v17, s[72:73]
  v_cndmask_b32 v78, v78, v18, s[72:73]
  v_cndmask_b32 v79, v79, v19, s[72:73]
  ds_read_b64_tr_b16 v[40:41], v9 offset:26624
  v_mfma_f32_16x16x32_bf16 v[148:151], v[52:55], v[72:75], v[148:151]
  ds_read_b64_tr_b16 v[42:43], v9 offset:29696
  s_waitcnt lgkmcnt(6)
  v_mfma_f32_16x16x32_bf16 v[152:155], v[44:47], v[76:79], v[152:155]
  ds_read_b128 v[68:71], v7 offset:6144
  s_waitcnt lgkmcnt(4)
  v_mfma_f32_16x16x32_bf16 v[204:207], v[76:79], v[48:51], v[204:207]
  s_waitcnt lgkmcnt(1)
  v_mfma_f32_16x16x32_bf16 v[20:23], v[40:43], v[76:79], v[20:23]
  v_mfma_f32_16x16x32_bf16 v[156:159], v[44:47], v[80:83], v[156:159]
  ds_read_b128 v[72:75], v7 offset:8192
  v_mfma_f32_16x16x32_bf16 v[208:211], v[80:83], v[48:51], v[208:211]
  ds_read_b64_tr_b16 v[56:57], v9 offset:39936
  v_mfma_f32_16x16x32_bf16 v[104:107], v[40:43], v[80:83], v[104:107]
  v_mfma_f32_16x16x32_bf16 v[160:163], v[44:47], v[64:67], v[160:163]
  ds_read_b128 v[76:79], v7 offset:10240
  v_mfma_f32_16x16x32_bf16 v[212:215], v[64:67], v[48:51], v[212:215]
  ds_read_b64_tr_b16 v[58:59], v9 offset:43008
  v_mfma_f32_16x16x32_bf16 v[108:111], v[40:43], v[64:67], v[108:111]
  s_waitcnt lgkmcnt(4)
  v_mfma_f32_16x16x32_bf16 v[164:167], v[44:47], v[68:71], v[164:167]
  ds_read_b128 v[80:83], v7 offset:12288
  v_mfma_f32_16x16x32_bf16 v[216:219], v[68:71], v[48:51], v[216:219]
  ds_read_b64_tr_b16 v[60:61], v9 offset:40960
  v_mfma_f32_16x16x32_bf16 v[112:115], v[40:43], v[68:71], v[112:115]
  s_waitcnt lgkmcnt(5)
  v_mfma_f32_16x16x32_bf16 v[168:171], v[44:47], v[72:75], v[168:171]
  ds_read_b128 v[64:67], v7 offset:14336
  v_mfma_f32_16x16x32_bf16 v[220:223], v[72:75], v[48:51], v[220:223]
  ds_read_b64_tr_b16 v[62:63], v9 offset:44032
  v_mfma_f32_16x16x32_bf16 v[116:119], v[40:43], v[72:75], v[116:119]
  s_waitcnt lgkmcnt(5)
  v_mfma_f32_16x16x32_bf16 v[172:175], v[44:47], v[76:79], v[172:175]
  ds_read_b128 v[68:71], v7 offset:16384
  v_mfma_f32_16x16x32_bf16 v[224:227], v[76:79], v[48:51], v[224:227]
  ds_read_b64_tr_b16 v[52:53], v9 offset:38912
  v_mfma_f32_16x16x32_bf16 v[120:123], v[40:43], v[76:79], v[120:123]
  s_waitcnt lgkmcnt(5)
  v_mfma_f32_16x16x32_bf16 v[176:179], v[44:47], v[80:83], v[176:179]
  ds_read_b128 v[72:75], v7 offset:18432
  v_mfma_f32_16x16x32_bf16 v[228:231], v[80:83], v[48:51], v[228:231]
  ds_read_b64_tr_b16 v[54:55], v9 offset:41984
  v_mfma_f32_16x16x32_bf16 v[124:127], v[40:43], v[80:83], v[124:127]
  s_waitcnt lgkmcnt(5)
  v_mfma_f32_16x16x32_bf16 v[180:183], v[44:47], v[64:67], v[180:183]
  ds_read_b128 v[76:79], v7 offset:20480
  v_mfma_f32_16x16x32_bf16 v[232:235], v[64:67], v[48:51], v[232:235]
  v_mfma_f32_16x16x32_bf16 v[128:131], v[40:43], v[64:67], v[128:131]
  s_waitcnt lgkmcnt(4)
  v_mfma_f32_16x16x32_bf16 v[184:187], v[44:47], v[68:71], v[184:187]
  ds_read_b128 v[80:83], v7 offset:22528
  v_mfma_f32_16x16x32_bf16 v[236:239], v[68:71], v[48:51], v[236:239]
  v_mfma_f32_16x16x32_bf16 v[132:135], v[40:43], v[68:71], v[132:135]
  s_waitcnt lgkmcnt(3)
  v_mfma_f32_16x16x32_bf16 v[188:191], v[44:47], v[72:75], v[188:191]
  ds_read_b128 v[64:67], v7 offset:24576
  v_mfma_f32_16x16x32_bf16 v[240:243], v[72:75], v[48:51], v[240:243]
  v_mfma_f32_16x16x32_bf16 v[136:139], v[40:43], v[72:75], v[136:139]
  s_waitcnt lgkmcnt(2)
  v_mfma_f32_16x16x32_bf16 v[192:195], v[44:47], v[76:79], v[192:195]
  ds_read_b128 v[68:71], v8 offset:0
  v_mfma_f32_16x16x32_bf16 v[244:247], v[76:79], v[48:51], v[244:247]
  v_mfma_f32_16x16x32_bf16 v[140:143], v[40:43], v[76:79], v[140:143]
  s_waitcnt lgkmcnt(2)
  v_mfma_f32_16x16x32_bf16 v[196:199], v[44:47], v[80:83], v[196:199]
  ds_read_b128 v[72:75], v8 offset:2048
  v_mfma_f32_16x16x32_bf16 v[248:251], v[80:83], v[48:51], v[248:251]
  v_mfma_f32_16x16x32_bf16 v[144:147], v[40:43], v[80:83], v[144:147]
  s_waitcnt lgkmcnt(2)
  v_mfma_f32_16x16x32_bf16 v[200:203], v[44:47], v[64:67], v[200:203]
  ds_read_b128 v[76:79], v8 offset:4096
  s_waitcnt lgkmcnt(2)
  v_cndmask_b32 v68, v68, v16, s[72:73]
  v_mfma_f32_16x16x32_bf16 v[252:255], v[64:67], v[48:51], v[252:255]
  v_cndmask_b32 v69, v69, v17, s[72:73]
  v_cndmask_b32 v70, v70, v18, s[72:73]
  v_cndmask_b32 v71, v71, v19, s[72:73]
  v_mfma_f32_16x16x32_bf16 v[148:151], v[40:43], v[64:67], v[148:151]
  s_nop 0
  v_mfma_f32_16x16x32_bf16 v[152:155], v[56:59], v[68:71], v[152:155]
  ds_read_b128 v[80:83], v8 offset:6144
  v_mfma_f32_16x16x32_bf16 v[204:207], v[68:71], v[60:63], v[204:207]
  v_mfma_f32_16x16x32_bf16 v[20:23], v[52:55], v[68:71], v[20:23]
  s_waitcnt lgkmcnt(2)
  v_mfma_f32_16x16x32_bf16 v[156:159], v[56:59], v[72:75], v[156:159]
  ds_read_b128 v[64:67], v8 offset:8192
  v_mfma_f32_16x16x32_bf16 v[208:211], v[72:75], v[60:63], v[208:211]
  v_mfma_f32_16x16x32_bf16 v[104:107], v[52:55], v[72:75], v[104:107]
  s_waitcnt lgkmcnt(2)
  v_mfma_f32_16x16x32_bf16 v[160:163], v[56:59], v[76:79], v[160:163]
  ds_read_b128 v[68:71], v8 offset:10240
  v_mfma_f32_16x16x32_bf16 v[212:215], v[76:79], v[60:63], v[212:215]
  v_mfma_f32_16x16x32_bf16 v[108:111], v[52:55], v[76:79], v[108:111]
  s_waitcnt lgkmcnt(2)
  v_mfma_f32_16x16x32_bf16 v[164:167], v[56:59], v[80:83], v[164:167]
  ds_read_b128 v[72:75], v8 offset:12288
  v_mfma_f32_16x16x32_bf16 v[216:219], v[80:83], v[60:63], v[216:219]
  v_mfma_f32_16x16x32_bf16 v[112:115], v[52:55], v[80:83], v[112:115]
  s_waitcnt lgkmcnt(2)
  v_mfma_f32_16x16x32_bf16 v[168:171], v[56:59], v[64:67], v[168:171]
  ds_read_b128 v[76:79], v8 offset:14336
  v_mfma_f32_16x16x32_bf16 v[220:223], v[64:67], v[60:63], v[220:223]
  v_mfma_f32_16x16x32_bf16 v[116:119], v[52:55], v[64:67], v[116:119]
  s_waitcnt lgkmcnt(2)
  v_mfma_f32_16x16x32_bf16 v[172:175], v[56:59], v[68:71], v[172:175]
  ds_read_b128 v[80:83], v8 offset:16384
  v_mfma_f32_16x16x32_bf16 v[224:227], v[68:71], v[60:63], v[224:227]
  v_mfma_f32_16x16x32_bf16 v[120:123], v[52:55], v[68:71], v[120:123]
  s_waitcnt lgkmcnt(2)
  v_mfma_f32_16x16x32_bf16 v[176:179], v[56:59], v[72:75], v[176:179]
  ds_read_b128 v[64:67], v8 offset:18432
  v_mfma_f32_16x16x32_bf16 v[228:231], v[72:75], v[60:63], v[228:231]
  v_mfma_f32_16x16x32_bf16 v[124:127], v[52:55], v[72:75], v[124:127]
  s_waitcnt lgkmcnt(2)
  v_mfma_f32_16x16x32_bf16 v[180:183], v[56:59], v[76:79], v[180:183]
  ds_read_b128 v[68:71], v8 offset:20480
  v_mfma_f32_16x16x32_bf16 v[232:235], v[76:79], v[60:63], v[232:235]
  v_mfma_f32_16x16x32_bf16 v[128:131], v[52:55], v[76:79], v[128:131]
  s_waitcnt lgkmcnt(2)
  v_mfma_f32_16x16x32_bf16 v[184:187], v[56:59], v[80:83], v[184:187]
  ds_read_b128 v[72:75], v8 offset:22528
  v_mfma_f32_16x16x32_bf16 v[236:239], v[80:83], v[60:63], v[236:239]
  v_mfma_f32_16x16x32_bf16 v[132:135], v[52:55], v[80:83], v[132:135]
  s_waitcnt lgkmcnt(2)
  v_mfma_f32_16x16x32_bf16 v[188:191], v[56:59], v[64:67], v[188:191]
  ds_read_b128 v[76:79], v8 offset:24576
  v_mfma_f32_16x16x32_bf16 v[240:243], v[64:67], v[60:63], v[240:243]
  v_add_u32 v7, 51200, v7
  v_add_u32 v8, 51200, v8
  v_mfma_f32_16x16x32_bf16 v[136:139], v[52:55], v[64:67], v[136:139]
  v_add_u32 v9, 51200, v9
  s_waitcnt lgkmcnt(0)
  s_barrier
  v_mfma_f32_16x16x32_bf16 v[192:195], v[56:59], v[68:71], v[192:195]
  ds_read_b128 v[80:83], v7 offset:0
  v_mfma_f32_16x16x32_bf16 v[244:247], v[68:71], v[60:63], v[244:247]
  ds_read_b64_tr_b16 v[44:45], v9 offset:27648
  v_mfma_f32_16x16x32_bf16 v[140:143], v[52:55], v[68:71], v[140:143]
  ds_read_b64_tr_b16 v[46:47], v9 offset:30720
  v_mfma_f32_16x16x32_bf16 v[196:199], v[56:59], v[72:75], v[196:199]
  ds_read_b128 v[64:67], v7 offset:2048
  v_mfma_f32_16x16x32_bf16 v[248:251], v[72:75], v[60:63], v[248:251]
  ds_read_b64_tr_b16 v[48:49], v9 offset:28672
  v_mfma_f32_16x16x32_bf16 v[144:147], v[52:55], v[72:75], v[144:147]
  ds_read_b64_tr_b16 v[50:51], v9 offset:31744
  v_mfma_f32_16x16x32_bf16 v[200:203], v[56:59], v[76:79], v[200:203]
  ds_read_b128 v[68:71], v7 offset:4096
  s_waitcnt lgkmcnt(6)
  v_cndmask_b32 v80, v80, v16, s[72:73]
  v_mfma_f32_16x16x32_bf16 v[252:255], v[76:79], v[60:63], v[252:255]
  v_cndmask_b32 v81, v81, v17, s[72:73]
  v_cndmask_b32 v82, v82, v18, s[72:73]
  v_cndmask_b32 v83, v83, v19, s[72:73]
  ds_read_b64_tr_b16 v[40:41], v9 offset:26624
  v_mfma_f32_16x16x32_bf16 v[148:151], v[52:55], v[76:79], v[148:151]
  ds_read_b64_tr_b16 v[42:43], v9 offset:29696
  s_waitcnt lgkmcnt(6)
  v_mfma_f32_16x16x32_bf16 v[152:155], v[44:47], v[80:83], v[152:155]
  ds_read_b128 v[72:75], v7 offset:6144
  s_waitcnt lgkmcnt(4)
  v_mfma_f32_16x16x32_bf16 v[204:207], v[80:83], v[48:51], v[204:207]
  s_waitcnt lgkmcnt(1)
  v_mfma_f32_16x16x32_bf16 v[20:23], v[40:43], v[80:83], v[20:23]
  v_mfma_f32_16x16x32_bf16 v[156:159], v[44:47], v[64:67], v[156:159]
  ds_read_b128 v[76:79], v7 offset:8192
  v_mfma_f32_16x16x32_bf16 v[208:211], v[64:67], v[48:51], v[208:211]
  ds_read_b64_tr_b16 v[56:57], v9 offset:39936
  v_mfma_f32_16x16x32_bf16 v[104:107], v[40:43], v[64:67], v[104:107]
  v_mfma_f32_16x16x32_bf16 v[160:163], v[44:47], v[68:71], v[160:163]
  ds_read_b128 v[80:83], v7 offset:10240
  v_mfma_f32_16x16x32_bf16 v[212:215], v[68:71], v[48:51], v[212:215]
  ds_read_b64_tr_b16 v[58:59], v9 offset:43008
  v_mfma_f32_16x16x32_bf16 v[108:111], v[40:43], v[68:71], v[108:111]
  s_waitcnt lgkmcnt(4)
  v_mfma_f32_16x16x32_bf16 v[164:167], v[44:47], v[72:75], v[164:167]
  ds_read_b128 v[64:67], v7 offset:12288
  v_mfma_f32_16x16x32_bf16 v[216:219], v[72:75], v[48:51], v[216:219]
  ds_read_b64_tr_b16 v[60:61], v9 offset:40960
  v_mfma_f32_16x16x32_bf16 v[112:115], v[40:43], v[72:75], v[112:115]
  s_waitcnt lgkmcnt(5)
  v_mfma_f32_16x16x32_bf16 v[168:171], v[44:47], v[76:79], v[168:171]
  ds_read_b128 v[68:71], v7 offset:14336
  v_mfma_f32_16x16x32_bf16 v[220:223], v[76:79], v[48:51], v[220:223]
  ds_read_b64_tr_b16 v[62:63], v9 offset:44032
  v_mfma_f32_16x16x32_bf16 v[116:119], v[40:43], v[76:79], v[116:119]
  s_waitcnt lgkmcnt(5)
  v_mfma_f32_16x16x32_bf16 v[172:175], v[44:47], v[80:83], v[172:175]
  ds_read_b128 v[72:75], v7 offset:16384
  v_mfma_f32_16x16x32_bf16 v[224:227], v[80:83], v[48:51], v[224:227]
  ds_read_b64_tr_b16 v[52:53], v9 offset:38912
  v_mfma_f32_16x16x32_bf16 v[120:123], v[40:43], v[80:83], v[120:123]
  s_waitcnt lgkmcnt(5)
  v_mfma_f32_16x16x32_bf16 v[176:179], v[44:47], v[64:67], v[176:179]
  ds_read_b128 v[76:79], v7 offset:18432
  v_mfma_f32_16x16x32_bf16 v[228:231], v[64:67], v[48:51], v[228:231]
  ds_read_b64_tr_b16 v[54:55], v9 offset:41984
  v_mfma_f32_16x16x32_bf16 v[124:127], v[40:43], v[64:67], v[124:127]
  s_waitcnt lgkmcnt(5)
  v_mfma_f32_16x16x32_bf16 v[180:183], v[44:47], v[68:71], v[180:183]
  ds_read_b128 v[80:83], v7 offset:20480
  v_mfma_f32_16x16x32_bf16 v[232:235], v[68:71], v[48:51], v[232:235]
  v_mfma_f32_16x16x32_bf16 v[128:131], v[40:43], v[68:71], v[128:131]
  s_waitcnt lgkmcnt(4)
  v_mfma_f32_16x16x32_bf16 v[184:187], v[44:47], v[72:75], v[184:187]
  ds_read_b128 v[64:67], v7 offset:22528
  v_mfma_f32_16x16x32_bf16 v[236:239], v[72:75], v[48:51], v[236:239]
  v_mfma_f32_16x16x32_bf16 v[132:135], v[40:43], v[72:75], v[132:135]
  s_waitcnt lgkmcnt(3)
  v_mfma_f32_16x16x32_bf16 v[188:191], v[44:47], v[76:79], v[188:191]
  ds_read_b128 v[68:71], v7 offset:24576
  v_mfma_f32_16x16x32_bf16 v[240:243], v[76:79], v[48:51], v[240:243]
  v_mfma_f32_16x16x32_bf16 v[136:139], v[40:43], v[76:79], v[136:139]
  s_waitcnt lgkmcnt(2)
  v_mfma_f32_16x16x32_bf16 v[192:195], v[44:47], v[80:83], v[192:195]
  ds_read_b128 v[72:75], v8 offset:0
  v_mfma_f32_16x16x32_bf16 v[244:247], v[80:83], v[48:51], v[244:247]
  v_mfma_f32_16x16x32_bf16 v[140:143], v[40:43], v[80:83], v[140:143]
  s_waitcnt lgkmcnt(2)
  v_mfma_f32_16x16x32_bf16 v[196:199], v[44:47], v[64:67], v[196:199]
  ds_read_b128 v[76:79], v8 offset:2048
  v_mfma_f32_16x16x32_bf16 v[248:251], v[64:67], v[48:51], v[248:251]
  v_mfma_f32_16x16x32_bf16 v[144:147], v[40:43], v[64:67], v[144:147]
  s_waitcnt lgkmcnt(2)
  v_mfma_f32_16x16x32_bf16 v[200:203], v[44:47], v[68:71], v[200:203]
  ds_read_b128 v[80:83], v8 offset:4096
  s_waitcnt lgkmcnt(2)
  v_cndmask_b32 v72, v72, v16, s[72:73]
  v_mfma_f32_16x16x32_bf16 v[252:255], v[68:71], v[48:51], v[252:255]
  v_cndmask_b32 v73, v73, v17, s[72:73]
  v_cndmask_b32 v74, v74, v18, s[72:73]
  v_cndmask_b32 v75, v75, v19, s[72:73]
  v_mfma_f32_16x16x32_bf16 v[148:151], v[40:43], v[68:71], v[148:151]
  s_nop 0
  v_mfma_f32_16x16x32_bf16 v[152:155], v[56:59], v[72:75], v[152:155]
  ds_read_b128 v[64:67], v8 offset:6144
  v_mfma_f32_16x16x32_bf16 v[204:207], v[72:75], v[60:63], v[204:207]
  v_mfma_f32_16x16x32_bf16 v[20:23], v[52:55], v[72:75], v[20:23]
  s_waitcnt lgkmcnt(2)
  v_mfma_f32_16x16x32_bf16 v[156:159], v[56:59], v[76:79], v[156:159]
  ds_read_b128 v[68:71], v8 offset:8192
  v_mfma_f32_16x16x32_bf16 v[208:211], v[76:79], v[60:63], v[208:211]
  v_mfma_f32_16x16x32_bf16 v[104:107], v[52:55], v[76:79], v[104:107]
  s_waitcnt lgkmcnt(2)
  v_mfma_f32_16x16x32_bf16 v[160:163], v[56:59], v[80:83], v[160:163]
  ds_read_b128 v[72:75], v8 offset:10240
  v_mfma_f32_16x16x32_bf16 v[212:215], v[80:83], v[60:63], v[212:215]
  v_mfma_f32_16x16x32_bf16 v[108:111], v[52:55], v[80:83], v[108:111]
  s_waitcnt lgkmcnt(2)
  v_mfma_f32_16x16x32_bf16 v[164:167], v[56:59], v[64:67], v[164:167]
  ds_read_b128 v[76:79], v8 offset:12288
  v_mfma_f32_16x16x32_bf16 v[216:219], v[64:67], v[60:63], v[216:219]
  v_mfma_f32_16x16x32_bf16 v[112:115], v[52:55], v[64:67], v[112:115]
  s_waitcnt lgkmcnt(2)
  v_mfma_f32_16x16x32_bf16 v[168:171], v[56:59], v[68:71], v[168:171]
  ds_read_b128 v[80:83], v8 offset:14336
  v_mfma_f32_16x16x32_bf16 v[220:223], v[68:71], v[60:63], v[220:223]
  v_mfma_f32_16x16x32_bf16 v[116:119], v[52:55], v[68:71], v[116:119]
  s_waitcnt lgkmcnt(2)
  v_mfma_f32_16x16x32_bf16 v[172:175], v[56:59], v[72:75], v[172:175]
  ds_read_b128 v[64:67], v8 offset:16384
  v_mfma_f32_16x16x32_bf16 v[224:227], v[72:75], v[60:63], v[224:227]
  v_mfma_f32_16x16x32_bf16 v[120:123], v[52:55], v[72:75], v[120:123]
  s_waitcnt lgkmcnt(2)
  v_mfma_f32_16x16x32_bf16 v[176:179], v[56:59], v[76:79], v[176:179]
  ds_read_b128 v[68:71], v8 offset:18432
  v_mfma_f32_16x16x32_bf16 v[228:231], v[76:79], v[60:63], v[228:231]
  v_mfma_f32_16x16x32_bf16 v[124:127], v[52:55], v[76:79], v[124:127]
  s_waitcnt lgkmcnt(2)
  v_mfma_f32_16x16x32_bf16 v[180:183], v[56:59], v[80:83], v[180:183]
  ds_read_b128 v[72:75], v8 offset:20480
  v_mfma_f32_16x16x32_bf16 v[232:235], v[80:83], v[60:63], v[232:235]
  v_mfma_f32_16x16x32_bf16 v[128:131], v[52:55], v[80:83], v[128:131]
  s_waitcnt lgkmcnt(2)
  v_mfma_f32_16x16x32_bf16 v[184:187], v[56:59], v[64:67], v[184:187]
  ds_read_b128 v[76:79], v8 offset:22528
  v_mfma_f32_16x16x32_bf16 v[236:239], v[64:67], v[60:63], v[236:239]
  v_mfma_f32_16x16x32_bf16 v[132:135], v[52:55], v[64:67], v[132:135]
  s_waitcnt lgkmcnt(2)
  v_mfma_f32_16x16x32_bf16 v[188:191], v[56:59], v[68:71], v[188:191]
  ds_read_b128 v[80:83], v8 offset:24576
  v_mfma_f32_16x16x32_bf16 v[240:243], v[68:71], v[60:63], v[240:243]
  v_add_u32 v7, 51200, v7
  v_add_u32 v8, 51200, v8
  v_mfma_f32_16x16x32_bf16 v[136:139], v[52:55], v[68:71], v[136:139]
  v_add_u32 v9, 51200, v9
  s_waitcnt lgkmcnt(0)
  s_barrier
  v_mfma_f32_16x16x32_bf16 v[192:195], v[56:59], v[72:75], v[192:195]
  ds_read_b128 v[64:67], v7 offset:0
  v_mfma_f32_16x16x32_bf16 v[244:247], v[72:75], v[60:63], v[244:247]
  ds_read_b64_tr_b16 v[44:45], v9 offset:27648
  v_mfma_f32_16x16x32_bf16 v[140:143], v[52:55], v[72:75], v[140:143]
  ds_read_b64_tr_b16 v[46:47], v9 offset:30720
  v_mfma_f32_16x16x32_bf16 v[196:199], v[56:59], v[76:79], v[196:199]
  ds_read_b128 v[68:71], v7 offset:2048
  v_mfma_f32_16x16x32_bf16 v[248:251], v[76:79], v[60:63], v[248:251]
  ds_read_b64_tr_b16 v[48:49], v9 offset:28672
  v_mfma_f32_16x16x32_bf16 v[144:147], v[52:55], v[76:79], v[144:147]
  ds_read_b64_tr_b16 v[50:51], v9 offset:31744
  v_mfma_f32_16x16x32_bf16 v[200:203], v[56:59], v[80:83], v[200:203]
  ds_read_b128 v[72:75], v7 offset:4096
  s_waitcnt lgkmcnt(6)
  v_cndmask_b32 v64, v64, v16, s[72:73]
  v_mfma_f32_16x16x32_bf16 v[252:255], v[80:83], v[60:63], v[252:255]
  v_cndmask_b32 v65, v65, v17, s[72:73]
  v_cndmask_b32 v66, v66, v18, s[72:73]
  v_cndmask_b32 v67, v67, v19, s[72:73]
  ds_read_b64_tr_b16 v[40:41], v9 offset:26624
  v_mfma_f32_16x16x32_bf16 v[148:151], v[52:55], v[80:83], v[148:151]
  ds_read_b64_tr_b16 v[42:43], v9 offset:29696
  s_waitcnt lgkmcnt(6)
  v_mfma_f32_16x16x32_bf16 v[152:155], v[44:47], v[64:67], v[152:155]
  ds_read_b128 v[76:79], v7 offset:6144
  s_waitcnt lgkmcnt(4)
  v_mfma_f32_16x16x32_bf16 v[204:207], v[64:67], v[48:51], v[204:207]
  s_waitcnt lgkmcnt(1)
  v_mfma_f32_16x16x32_bf16 v[20:23], v[40:43], v[64:67], v[20:23]
  v_mfma_f32_16x16x32_bf16 v[156:159], v[44:47], v[68:71], v[156:159]
  ds_read_b128 v[80:83], v7 offset:8192
  v_mfma_f32_16x16x32_bf16 v[208:211], v[68:71], v[48:51], v[208:211]
  ds_read_b64_tr_b16 v[56:57], v9 offset:39936
  v_mfma_f32_16x16x32_bf16 v[104:107], v[40:43], v[68:71], v[104:107]
  v_mfma_f32_16x16x32_bf16 v[160:163], v[44:47], v[72:75], v[160:163]
  ds_read_b128 v[64:67], v7 offset:10240
  v_mfma_f32_16x16x32_bf16 v[212:215], v[72:75], v[48:51], v[212:215]
  ds_read_b64_tr_b16 v[58:59], v9 offset:43008
  v_mfma_f32_16x16x32_bf16 v[108:111], v[40:43], v[72:75], v[108:111]
  s_waitcnt lgkmcnt(4)
  v_mfma_f32_16x16x32_bf16 v[164:167], v[44:47], v[76:79], v[164:167]
  ds_read_b128 v[68:71], v7 offset:12288
  v_mfma_f32_16x16x32_bf16 v[216:219], v[76:79], v[48:51], v[216:219]
  ds_read_b64_tr_b16 v[60:61], v9 offset:40960
  v_mfma_f32_16x16x32_bf16 v[112:115], v[40:43], v[76:79], v[112:115]
  s_waitcnt lgkmcnt(5)
  v_mfma_f32_16x16x32_bf16 v[168:171], v[44:47], v[80:83], v[168:171]
  ds_read_b128 v[72:75], v7 offset:14336
  v_mfma_f32_16x16x32_bf16 v[220:223], v[80:83], v[48:51], v[220:223]
  ds_read_b64_tr_b16 v[62:63], v9 offset:44032
  v_mfma_f32_16x16x32_bf16 v[116:119], v[40:43], v[80:83], v[116:119]
  s_waitcnt lgkmcnt(5)
  v_mfma_f32_16x16x32_bf16 v[172:175], v[44:47], v[64:67], v[172:175]
  ds_read_b128 v[76:79], v7 offset:16384
  v_mfma_f32_16x16x32_bf16 v[224:227], v[64:67], v[48:51], v[224:227]
  ds_read_b64_tr_b16 v[52:53], v9 offset:38912
  v_mfma_f32_16x16x32_bf16 v[120:123], v[40:43], v[64:67], v[120:123]
  s_waitcnt lgkmcnt(5)
  v_mfma_f32_16x16x32_bf16 v[176:179], v[44:47], v[68:71], v[176:179]
  ds_read_b128 v[80:83], v7 offset:18432
  v_mfma_f32_16x16x32_bf16 v[228:231], v[68:71], v[48:51], v[228:231]
  ds_read_b64_tr_b16 v[54:55], v9 offset:41984
  v_mfma_f32_16x16x32_bf16 v[124:127], v[40:43], v[68:71], v[124:127]
  s_waitcnt lgkmcnt(5)
  v_mfma_f32_16x16x32_bf16 v[180:183], v[44:47], v[72:75], v[180:183]
  ds_read_b128 v[64:67], v7 offset:20480
  v_mfma_f32_16x16x32_bf16 v[232:235], v[72:75], v[48:51], v[232:235]
  v_mfma_f32_16x16x32_bf16 v[128:131], v[40:43], v[72:75], v[128:131]
  s_waitcnt lgkmcnt(4)
  v_mfma_f32_16x16x32_bf16 v[184:187], v[44:47], v[76:79], v[184:187]
  ds_read_b128 v[68:71], v7 offset:22528
  v_mfma_f32_16x16x32_bf16 v[236:239], v[76:79], v[48:51], v[236:239]
  v_mfma_f32_16x16x32_bf16 v[132:135], v[40:43], v[76:79], v[132:135]
  s_waitcnt lgkmcnt(3)
  v_mfma_f32_16x16x32_bf16 v[188:191], v[44:47], v[80:83], v[188:191]
  ds_read_b128 v[72:75], v7 offset:24576
  v_mfma_f32_16x16x32_bf16 v[240:243], v[80:83], v[48:51], v[240:243]
  v_mfma_f32_16x16x32_bf16 v[136:139], v[40:43], v[80:83], v[136:139]
  s_waitcnt lgkmcnt(2)
  v_mfma_f32_16x16x32_bf16 v[192:195], v[44:47], v[64:67], v[192:195]
  ds_read_b128 v[76:79], v8 offset:0
  v_mfma_f32_16x16x32_bf16 v[244:247], v[64:67], v[48:51], v[244:247]
  v_mfma_f32_16x16x32_bf16 v[140:143], v[40:43], v[64:67], v[140:143]
  s_waitcnt lgkmcnt(2)
  v_mfma_f32_16x16x32_bf16 v[196:199], v[44:47], v[68:71], v[196:199]
  ds_read_b128 v[80:83], v8 offset:2048
  v_mfma_f32_16x16x32_bf16 v[248:251], v[68:71], v[48:51], v[248:251]
  v_mfma_f32_16x16x32_bf16 v[144:147], v[40:43], v[68:71], v[144:147]
  s_waitcnt lgkmcnt(2)
  v_mfma_f32_16x16x32_bf16 v[200:203], v[44:47], v[72:75], v[200:203]
  ds_read_b128 v[64:67], v8 offset:4096
  s_waitcnt lgkmcnt(2)
  v_cndmask_b32 v76, v76, v16, s[72:73]
  v_mfma_f32_16x16x32_bf16 v[252:255], v[72:75], v[48:51], v[252:255]
  v_cndmask_b32 v77, v77, v17, s[72:73]
  v_cndmask_b32 v78, v78, v18, s[72:73]
  v_cndmask_b32 v79, v79, v19, s[72:73]
  v_mfma_f32_16x16x32_bf16 v[148:151], v[40:43], v[72:75], v[148:151]
  s_nop 0
  v_mfma_f32_16x16x32_bf16 v[152:155], v[56:59], v[76:79], v[152:155]
  ds_read_b128 v[68:71], v8 offset:6144
  v_mfma_f32_16x16x32_bf16 v[204:207], v[76:79], v[60:63], v[204:207]
  v_mfma_f32_16x16x32_bf16 v[20:23], v[52:55], v[76:79], v[20:23]
  s_waitcnt lgkmcnt(2)
  v_mfma_f32_16x16x32_bf16 v[156:159], v[56:59], v[80:83], v[156:159]
  ds_read_b128 v[72:75], v8 offset:8192
  v_mfma_f32_16x16x32_bf16 v[208:211], v[80:83], v[60:63], v[208:211]
  v_mfma_f32_16x16x32_bf16 v[104:107], v[52:55], v[80:83], v[104:107]
  s_waitcnt lgkmcnt(2)
  v_mfma_f32_16x16x32_bf16 v[160:163], v[56:59], v[64:67], v[160:163]
  ds_read_b128 v[76:79], v8 offset:10240
  v_mfma_f32_16x16x32_bf16 v[212:215], v[64:67], v[60:63], v[212:215]
  v_mfma_f32_16x16x32_bf16 v[108:111], v[52:55], v[64:67], v[108:111]
  s_waitcnt lgkmcnt(2)
  v_mfma_f32_16x16x32_bf16 v[164:167], v[56:59], v[68:71], v[164:167]
  ds_read_b128 v[80:83], v8 offset:12288
  v_mfma_f32_16x16x32_bf16 v[216:219], v[68:71], v[60:63], v[216:219]
  v_mfma_f32_16x16x32_bf16 v[112:115], v[52:55], v[68:71], v[112:115]
  s_waitcnt lgkmcnt(2)
  v_mfma_f32_16x16x32_bf16 v[168:171], v[56:59], v[72:75], v[168:171]
  ds_read_b128 v[64:67], v8 offset:14336
  v_mfma_f32_16x16x32_bf16 v[220:223], v[72:75], v[60:63], v[220:223]
  v_mfma_f32_16x16x32_bf16 v[116:119], v[52:55], v[72:75], v[116:119]
  s_waitcnt lgkmcnt(2)
  v_mfma_f32_16x16x32_bf16 v[172:175], v[56:59], v[76:79], v[172:175]
  ds_read_b128 v[68:71], v8 offset:16384
  v_mfma_f32_16x16x32_bf16 v[224:227], v[76:79], v[60:63], v[224:227]
  v_mfma_f32_16x16x32_bf16 v[120:123], v[52:55], v[76:79], v[120:123]
  s_waitcnt lgkmcnt(2)
  v_mfma_f32_16x16x32_bf16 v[176:179], v[56:59], v[80:83], v[176:179]
  ds_read_b128 v[72:75], v8 offset:18432
  v_mfma_f32_16x16x32_bf16 v[228:231], v[80:83], v[60:63], v[228:231]
  v_mfma_f32_16x16x32_bf16 v[124:127], v[52:55], v[80:83], v[124:127]
  s_waitcnt lgkmcnt(2)
  v_mfma_f32_16x16x32_bf16 v[180:183], v[56:59], v[64:67], v[180:183]
  ds_read_b128 v[76:79], v8 offset:20480
  v_mfma_f32_16x16x32_bf16 v[232:235], v[64:67], v[60:63], v[232:235]
  v_mfma_f32_16x16x32_bf16 v[128:131], v[52:55], v[64:67], v[128:131]
  s_waitcnt lgkmcnt(2)
  v_mfma_f32_16x16x32_bf16 v[184:187], v[56:59], v[68:71], v[184:187]
  ds_read_b128 v[80:83], v8 offset:22528
  v_mfma_f32_16x16x32_bf16 v[236:239], v[68:71], v[60:63], v[236:239]
  v_mfma_f32_16x16x32_bf16 v[132:135], v[52:55], v[68:71], v[132:135]
  s_waitcnt lgkmcnt(2)
  v_mfma_f32_16x16x32_bf16 v[188:191], v[56:59], v[72:75], v[188:191]
  ds_read_b128 v[64:67], v8 offset:24576
  v_mfma_f32_16x16x32_bf16 v[240:243], v[72:75], v[60:63], v[240:243]
  v_add_u32 v7, -102400, v7
  v_add_u32 v8, -102400, v8
  v_mfma_f32_16x16x32_bf16 v[136:139], v[52:55], v[72:75], v[136:139]
  v_add_u32 v9, -102400, v9
  s_waitcnt lgkmcnt(0)
  s_barrier
  v_mfma_f32_16x16x32_bf16 v[192:195], v[56:59], v[76:79], v[192:195]
  ds_read_b128 v[68:71], v7 offset:0
  v_mfma_f32_16x16x32_bf16 v[244:247], v[76:79], v[60:63], v[244:247]
  ds_read_b64_tr_b16 v[44:45], v9 offset:27648
  v_mfma_f32_16x16x32_bf16 v[140:143], v[52:55], v[76:79], v[140:143]
  ds_read_b64_tr_b16 v[46:47], v9 offset:30720
  v_mfma_f32_16x16x32_bf16 v[196:199], v[56:59], v[80:83], v[196:199]
  ds_read_b128 v[72:75], v7 offset:2048
  v_mfma_f32_16x16x32_bf16 v[248:251], v[80:83], v[60:63], v[248:251]
  ds_read_b64_tr_b16 v[48:49], v9 offset:28672
  v_mfma_f32_16x16x32_bf16 v[144:147], v[52:55], v[80:83], v[144:147]
  ds_read_b64_tr_b16 v[50:51], v9 offset:31744
  v_mfma_f32_16x16x32_bf16 v[200:203], v[56:59], v[64:67], v[200:203]
  ds_read_b128 v[76:79], v7 offset:4096
  s_waitcnt lgkmcnt(6)
  v_cndmask_b32 v68, v68, v16, s[72:73]
  v_mfma_f32_16x16x32_bf16 v[252:255], v[64:67], v[60:63], v[252:255]
  v_cndmask_b32 v69, v69, v17, s[72:73]
  v_cndmask_b32 v70, v70, v18, s[72:73]
  v_cndmask_b32 v71, v71, v19, s[72:73]
  ds_read_b64_tr_b16 v[40:41], v9 offset:26624
  v_mfma_f32_16x16x32_bf16 v[148:151], v[52:55], v[64:67], v[148:151]
  ds_read_b64_tr_b16 v[42:43], v9 offset:29696
  s_waitcnt lgkmcnt(6)
  v_mfma_f32_16x16x32_bf16 v[152:155], v[44:47], v[68:71], v[152:155]
  ds_read_b128 v[80:83], v7 offset:6144
  s_waitcnt lgkmcnt(4)
  v_mfma_f32_16x16x32_bf16 v[204:207], v[68:71], v[48:51], v[204:207]
  s_waitcnt lgkmcnt(1)
  v_mfma_f32_16x16x32_bf16 v[20:23], v[40:43], v[68:71], v[20:23]
  v_mfma_f32_16x16x32_bf16 v[156:159], v[44:47], v[72:75], v[156:159]
  ds_read_b128 v[64:67], v7 offset:8192
  v_mfma_f32_16x16x32_bf16 v[208:211], v[72:75], v[48:51], v[208:211]
  ds_read_b64_tr_b16 v[56:57], v9 offset:39936
  v_mfma_f32_16x16x32_bf16 v[104:107], v[40:43], v[72:75], v[104:107]
  v_mfma_f32_16x16x32_bf16 v[160:163], v[44:47], v[76:79], v[160:163]
  ds_read_b128 v[68:71], v7 offset:10240
  v_mfma_f32_16x16x32_bf16 v[212:215], v[76:79], v[48:51], v[212:215]
  ds_read_b64_tr_b16 v[58:59], v9 offset:43008
  v_mfma_f32_16x16x32_bf16 v[108:111], v[40:43], v[76:79], v[108:111]
  s_waitcnt lgkmcnt(4)
  v_mfma_f32_16x16x32_bf16 v[164:167], v[44:47], v[80:83], v[164:167]
  ds_read_b128 v[72:75], v7 offset:12288
  v_mfma_f32_16x16x32_bf16 v[216:219], v[80:83], v[48:51], v[216:219]
  ds_read_b64_tr_b16 v[60:61], v9 offset:40960
  v_mfma_f32_16x16x32_bf16 v[112:115], v[40:43], v[80:83], v[112:115]
  s_waitcnt lgkmcnt(5)
  v_mfma_f32_16x16x32_bf16 v[168:171], v[44:47], v[64:67], v[168:171]
  ds_read_b128 v[76:79], v7 offset:14336
  v_mfma_f32_16x16x32_bf16 v[220:223], v[64:67], v[48:51], v[220:223]
  ds_read_b64_tr_b16 v[62:63], v9 offset:44032
  v_mfma_f32_16x16x32_bf16 v[116:119], v[40:43], v[64:67], v[116:119]
  s_waitcnt lgkmcnt(5)
  v_mfma_f32_16x16x32_bf16 v[172:175], v[44:47], v[68:71], v[172:175]
  ds_read_b128 v[80:83], v7 offset:16384
  v_mfma_f32_16x16x32_bf16 v[224:227], v[68:71], v[48:51], v[224:227]
  ds_read_b64_tr_b16 v[52:53], v9 offset:38912
  v_mfma_f32_16x16x32_bf16 v[120:123], v[40:43], v[68:71], v[120:123]
  s_waitcnt lgkmcnt(5)
  v_mfma_f32_16x16x32_bf16 v[176:179], v[44:47], v[72:75], v[176:179]
  ds_read_b128 v[64:67], v7 offset:18432
  v_mfma_f32_16x16x32_bf16 v[228:231], v[72:75], v[48:51], v[228:231]
  ds_read_b64_tr_b16 v[54:55], v9 offset:41984
  v_mfma_f32_16x16x32_bf16 v[124:127], v[40:43], v[72:75], v[124:127]
  s_waitcnt lgkmcnt(5)
  v_mfma_f32_16x16x32_bf16 v[180:183], v[44:47], v[76:79], v[180:183]
  ds_read_b128 v[68:71], v7 offset:20480
  v_mfma_f32_16x16x32_bf16 v[232:235], v[76:79], v[48:51], v[232:235]
  v_mfma_f32_16x16x32_bf16 v[128:131], v[40:43], v[76:79], v[128:131]
  s_waitcnt lgkmcnt(4)
  v_mfma_f32_16x16x32_bf16 v[184:187], v[44:47], v[80:83], v[184:187]
  ds_read_b128 v[72:75], v7 offset:22528
  v_mfma_f32_16x16x32_bf16 v[236:239], v[80:83], v[48:51], v[236:239]
  v_mfma_f32_16x16x32_bf16 v[132:135], v[40:43], v[80:83], v[132:135]
  s_waitcnt lgkmcnt(3)
  v_mfma_f32_16x16x32_bf16 v[188:191], v[44:47], v[64:67], v[188:191]
  ds_read_b128 v[76:79], v7 offset:24576
  v_mfma_f32_16x16x32_bf16 v[240:243], v[64:67], v[48:51], v[240:243]
  v_mfma_f32_16x16x32_bf16 v[136:139], v[40:43], v[64:67], v[136:139]
  s_waitcnt lgkmcnt(2)
  v_mfma_f32_16x16x32_bf16 v[192:195], v[44:47], v[68:71], v[192:195]
  ds_read_b128 v[80:83], v8 offset:0
  v_mfma_f32_16x16x32_bf16 v[244:247], v[68:71], v[48:51], v[244:247]
  v_mfma_f32_16x16x32_bf16 v[140:143], v[40:43], v[68:71], v[140:143]
  s_waitcnt lgkmcnt(2)
  v_mfma_f32_16x16x32_bf16 v[196:199], v[44:47], v[72:75], v[196:199]
  ds_read_b128 v[64:67], v8 offset:2048
  v_mfma_f32_16x16x32_bf16 v[248:251], v[72:75], v[48:51], v[248:251]
  v_mfma_f32_16x16x32_bf16 v[144:147], v[40:43], v[72:75], v[144:147]
  s_waitcnt lgkmcnt(2)
  v_mfma_f32_16x16x32_bf16 v[200:203], v[44:47], v[76:79], v[200:203]
  ds_read_b128 v[68:71], v8 offset:4096
  s_waitcnt lgkmcnt(2)
  v_cndmask_b32 v80, v80, v16, s[72:73]
  v_mfma_f32_16x16x32_bf16 v[252:255], v[76:79], v[48:51], v[252:255]
  v_cndmask_b32 v81, v81, v17, s[72:73]
  v_cndmask_b32 v82, v82, v18, s[72:73]
  v_cndmask_b32 v83, v83, v19, s[72:73]
  v_mfma_f32_16x16x32_bf16 v[148:151], v[40:43], v[76:79], v[148:151]
  s_nop 0
  v_mfma_f32_16x16x32_bf16 v[152:155], v[56:59], v[80:83], v[152:155]
  ds_read_b128 v[72:75], v8 offset:6144
  v_mfma_f32_16x16x32_bf16 v[204:207], v[80:83], v[60:63], v[204:207]
  v_mfma_f32_16x16x32_bf16 v[20:23], v[52:55], v[80:83], v[20:23]
  s_waitcnt lgkmcnt(2)
  v_mfma_f32_16x16x32_bf16 v[156:159], v[56:59], v[64:67], v[156:159]
  ds_read_b128 v[76:79], v8 offset:8192
  v_mfma_f32_16x16x32_bf16 v[208:211], v[64:67], v[60:63], v[208:211]
  v_mfma_f32_16x16x32_bf16 v[104:107], v[52:55], v[64:67], v[104:107]
  s_waitcnt lgkmcnt(2)
  v_mfma_f32_16x16x32_bf16 v[160:163], v[56:59], v[68:71], v[160:163]
  ds_read_b128 v[80:83], v8 offset:10240
  v_mfma_f32_16x16x32_bf16 v[212:215], v[68:71], v[60:63], v[212:215]
  v_mfma_f32_16x16x32_bf16 v[108:111], v[52:55], v[68:71], v[108:111]
  s_waitcnt lgkmcnt(2)
  v_mfma_f32_16x16x32_bf16 v[164:167], v[56:59], v[72:75], v[164:167]
  ds_read_b128 v[64:67], v8 offset:12288
  v_mfma_f32_16x16x32_bf16 v[216:219], v[72:75], v[60:63], v[216:219]
  v_mfma_f32_16x16x32_bf16 v[112:115], v[52:55], v[72:75], v[112:115]
  s_waitcnt lgkmcnt(2)
  v_mfma_f32_16x16x32_bf16 v[168:171], v[56:59], v[76:79], v[168:171]
  ds_read_b128 v[68:71], v8 offset:14336
  v_mfma_f32_16x16x32_bf16 v[220:223], v[76:79], v[60:63], v[220:223]
  v_mfma_f32_16x16x32_bf16 v[116:119], v[52:55], v[76:79], v[116:119]
  s_waitcnt lgkmcnt(2)
  v_mfma_f32_16x16x32_bf16 v[172:175], v[56:59], v[80:83], v[172:175]
  ds_read_b128 v[72:75], v8 offset:16384
  v_mfma_f32_16x16x32_bf16 v[224:227], v[80:83], v[60:63], v[224:227]
  v_mfma_f32_16x16x32_bf16 v[120:123], v[52:55], v[80:83], v[120:123]
  s_waitcnt lgkmcnt(2)
  v_mfma_f32_16x16x32_bf16 v[176:179], v[56:59], v[64:67], v[176:179]
  ds_read_b128 v[76:79], v8 offset:18432
  v_mfma_f32_16x16x32_bf16 v[228:231], v[64:67], v[60:63], v[228:231]
  v_mfma_f32_16x16x32_bf16 v[124:127], v[52:55], v[64:67], v[124:127]
  s_waitcnt lgkmcnt(2)
  v_mfma_f32_16x16x32_bf16 v[180:183], v[56:59], v[68:71], v[180:183]
  ds_read_b128 v[80:83], v8 offset:20480
  v_mfma_f32_16x16x32_bf16 v[232:235], v[68:71], v[60:63], v[232:235]
  v_mfma_f32_16x16x32_bf16 v[128:131], v[52:55], v[68:71], v[128:131]
  s_waitcnt lgkmcnt(2)
  v_mfma_f32_16x16x32_bf16 v[184:187], v[56:59], v[72:75], v[184:187]
  ds_read_b128 v[64:67], v8 offset:22528
  v_mfma_f32_16x16x32_bf16 v[236:239], v[72:75], v[60:63], v[236:239]
  v_mfma_f32_16x16x32_bf16 v[132:135], v[52:55], v[72:75], v[132:135]
  s_waitcnt lgkmcnt(2)
  v_mfma_f32_16x16x32_bf16 v[188:191], v[56:59], v[76:79], v[188:191]
  ds_read_b128 v[68:71], v8 offset:24576
  v_mfma_f32_16x16x32_bf16 v[240:243], v[76:79], v[60:63], v[240:243]
  v_add_u32 v7, 51200, v7
  v_add_u32 v8, 51200, v8
  v_mfma_f32_16x16x32_bf16 v[136:139], v[52:55], v[76:79], v[136:139]
  v_add_u32 v9, 51200, v9
  s_waitcnt lgkmcnt(0)
  s_barrier
  v_mfma_f32_16x16x32_bf16 v[192:195], v[56:59], v[80:83], v[192:195]
  ds_read_b128 v[72:75], v7 offset:0
  v_mfma_f32_16x16x32_bf16 v[244:247], v[80:83], v[60:63], v[244:247]
  ds_read_b64_tr_b16 v[44:45], v9 offset:27648
  v_mfma_f32_16x16x32_bf16 v[140:143], v[52:55], v[80:83], v[140:143]
  ds_read_b64_tr_b16 v[46:47], v9 offset:30720
  v_mfma_f32_16x16x32_bf16 v[196:199], v[56:59], v[64:67], v[196:199]
  ds_read_b128 v[76:79], v7 offset:2048
  v_mfma_f32_16x16x32_bf16 v[248:251], v[64:67], v[60:63], v[248:251]
  ds_read_b64_tr_b16 v[48:49], v9 offset:28672
  v_mfma_f32_16x16x32_bf16 v[144:147], v[52:55], v[64:67], v[144:147]
  ds_read_b64_tr_b16 v[50:51], v9 offset:31744
  v_mfma_f32_16x16x32_bf16 v[200:203], v[56:59], v[68:71], v[200:203]
  ds_read_b128 v[80:83], v7 offset:4096
  s_waitcnt lgkmcnt(6)
  v_cndmask_b32 v72, v72, v16, s[72:73]
  v_mfma_f32_16x16x32_bf16 v[252:255], v[68:71], v[60:63], v[252:255]
  v_cndmask_b32 v73, v73, v17, s[72:73]
  v_cndmask_b32 v74, v74, v18, s[72:73]
  v_cndmask_b32 v75, v75, v19, s[72:73]
  ds_read_b64_tr_b16 v[40:41], v9 offset:26624
  v_mfma_f32_16x16x32_bf16 v[148:151], v[52:55], v[68:71], v[148:151]
  ds_read_b64_tr_b16 v[42:43], v9 offset:29696
  s_waitcnt lgkmcnt(6)
  v_mfma_f32_16x16x32_bf16 v[152:155], v[44:47], v[72:75], v[152:155]
  ds_read_b128 v[64:67], v7 offset:6144
  s_waitcnt lgkmcnt(4)
  v_mfma_f32_16x16x32_bf16 v[204:207], v[72:75], v[48:51], v[204:207]
  s_waitcnt lgkmcnt(1)
  v_mfma_f32_16x16x32_bf16 v[20:23], v[40:43], v[72:75], v[20:23]
  v_mfma_f32_16x16x32_bf16 v[156:159], v[44:47], v[76:79], v[156:159]
  ds_read_b128 v[68:71], v7 offset:8192
  v_mfma_f32_16x16x32_bf16 v[208:211], v[76:79], v[48:51], v[208:211]
  ds_read_b64_tr_b16 v[56:57], v9 offset:39936
  v_mfma_f32_16x16x32_bf16 v[104:107], v[40:43], v[76:79], v[104:107]
  v_mfma_f32_16x16x32_bf16 v[160:163], v[44:47], v[80:83], v[160:163]
  ds_read_b128 v[72:75], v7 offset:10240
  v_mfma_f32_16x16x32_bf16 v[212:215], v[80:83], v[48:51], v[212:215]
  ds_read_b64_tr_b16 v[58:59], v9 offset:43008
  v_mfma_f32_16x16x32_bf16 v[108:111], v[40:43], v[80:83], v[108:111]
  s_waitcnt lgkmcnt(4)
  v_mfma_f32_16x16x32_bf16 v[164:167], v[44:47], v[64:67], v[164:167]
  ds_read_b128 v[76:79], v7 offset:12288
  v_mfma_f32_16x16x32_bf16 v[216:219], v[64:67], v[48:51], v[216:219]
  ds_read_b64_tr_b16 v[60:61], v9 offset:40960
  v_mfma_f32_16x16x32_bf16 v[112:115], v[40:43], v[64:67], v[112:115]
  s_waitcnt lgkmcnt(5)
  v_mfma_f32_16x16x32_bf16 v[168:171], v[44:47], v[68:71], v[168:171]
  ds_read_b128 v[80:83], v7 offset:14336
  v_mfma_f32_16x16x32_bf16 v[220:223], v[68:71], v[48:51], v[220:223]
  ds_read_b64_tr_b16 v[62:63], v9 offset:44032
  v_mfma_f32_16x16x32_bf16 v[116:119], v[40:43], v[68:71], v[116:119]
  s_waitcnt lgkmcnt(5)
  v_mfma_f32_16x16x32_bf16 v[172:175], v[44:47], v[72:75], v[172:175]
  ds_read_b128 v[64:67], v7 offset:16384
  v_mfma_f32_16x16x32_bf16 v[224:227], v[72:75], v[48:51], v[224:227]
  ds_read_b64_tr_b16 v[52:53], v9 offset:38912
  v_mfma_f32_16x16x32_bf16 v[120:123], v[40:43], v[72:75], v[120:123]
  s_waitcnt lgkmcnt(5)
  v_mfma_f32_16x16x32_bf16 v[176:179], v[44:47], v[76:79], v[176:179]
  ds_read_b128 v[68:71], v7 offset:18432
  v_mfma_f32_16x16x32_bf16 v[228:231], v[76:79], v[48:51], v[228:231]
  ds_read_b64_tr_b16 v[54:55], v9 offset:41984
  v_mfma_f32_16x16x32_bf16 v[124:127], v[40:43], v[76:79], v[124:127]
  s_waitcnt lgkmcnt(5)
  v_mfma_f32_16x16x32_bf16 v[180:183], v[44:47], v[80:83], v[180:183]
  ds_read_b128 v[72:75], v7 offset:20480
  v_mfma_f32_16x16x32_bf16 v[232:235], v[80:83], v[48:51], v[232:235]
  v_mfma_f32_16x16x32_bf16 v[128:131], v[40:43], v[80:83], v[128:131]
  s_waitcnt lgkmcnt(4)
  v_mfma_f32_16x16x32_bf16 v[184:187], v[44:47], v[64:67], v[184:187]
  ds_read_b128 v[76:79], v7 offset:22528
  v_mfma_f32_16x16x32_bf16 v[236:239], v[64:67], v[48:51], v[236:239]
  v_mfma_f32_16x16x32_bf16 v[132:135], v[40:43], v[64:67], v[132:135]
  s_waitcnt lgkmcnt(3)
  v_mfma_f32_16x16x32_bf16 v[188:191], v[44:47], v[68:71], v[188:191]
  ds_read_b128 v[80:83], v7 offset:24576
  v_mfma_f32_16x16x32_bf16 v[240:243], v[68:71], v[48:51], v[240:243]
  v_mfma_f32_16x16x32_bf16 v[136:139], v[40:43], v[68:71], v[136:139]
  s_waitcnt lgkmcnt(2)
  v_mfma_f32_16x16x32_bf16 v[192:195], v[44:47], v[72:75], v[192:195]
  ds_read_b128 v[64:67], v8 offset:0
  v_mfma_f32_16x16x32_bf16 v[244:247], v[72:75], v[48:51], v[244:247]
  v_mfma_f32_16x16x32_bf16 v[140:143], v[40:43], v[72:75], v[140:143]
  s_waitcnt lgkmcnt(2)
  v_mfma_f32_16x16x32_bf16 v[196:199], v[44:47], v[76:79], v[196:199]
  ds_read_b128 v[68:71], v8 offset:2048
  v_mfma_f32_16x16x32_bf16 v[248:251], v[76:79], v[48:51], v[248:251]
  v_mfma_f32_16x16x32_bf16 v[144:147], v[40:43], v[76:79], v[144:147]
  s_waitcnt lgkmcnt(2)
  v_mfma_f32_16x16x32_bf16 v[200:203], v[44:47], v[80:83], v[200:203]
  ds_read_b128 v[72:75], v8 offset:4096
  s_waitcnt lgkmcnt(2)
  v_cndmask_b32 v64, v64, v16, s[72:73]
  v_mfma_f32_16x16x32_bf16 v[252:255], v[80:83], v[48:51], v[252:255]
  v_cndmask_b32 v65, v65, v17, s[72:73]
  v_cndmask_b32 v66, v66, v18, s[72:73]
  v_cndmask_b32 v67, v67, v19, s[72:73]
  v_mfma_f32_16x16x32_bf16 v[148:151], v[40:43], v[80:83], v[148:151]
  s_nop 0
  v_mfma_f32_16x16x32_bf16 v[152:155], v[56:59], v[64:67], v[152:155]
  ds_read_b128 v[76:79], v8 offset:6144
  v_mfma_f32_16x16x32_bf16 v[204:207], v[64:67], v[60:63], v[204:207]
  v_mfma_f32_16x16x32_bf16 v[20:23], v[52:55], v[64:67], v[20:23]
  s_waitcnt lgkmcnt(2)
  v_mfma_f32_16x16x32_bf16 v[156:159], v[56:59], v[68:71], v[156:159]
  ds_read_b128 v[80:83], v8 offset:8192
  v_and_b32 v4, 15, v1
  v_mfma_f32_16x16x32_bf16 v[208:211], v[68:71], v[60:63], v[208:211]
  v_lshrrev_b32 v5, 4, v1
  v_lshlrev_b32 v6, 3, v4
  v_mfma_f32_16x16x32_bf16 v[104:107], v[52:55], v[68:71], v[104:107]
  v_add_u32 v6, 159872, v6
  v_lshlrev_b32 v15, 4, v5
  s_waitcnt lgkmcnt(2)
  v_mfma_f32_16x16x32_bf16 v[160:163], v[56:59], v[72:75], v[160:163]
  ds_read_b128 v[64:67], v8 offset:10240
  v_add_u32 v15, 153600, v15
  v_mfma_f32_16x16x32_bf16 v[212:215], v[72:75], v[60:63], v[212:215]
  ds_read_b64 v[2:3], v6 offset:0
  ds_read_b128 v[32:35], v15 offset:0
  v_mfma_f32_16x16x32_bf16 v[108:111], v[52:55], v[72:75], v[108:111]
  ds_read_b128 v[36:39], v15 offset:1024
  v_lshlrev_b32 v12, 4, v4
  s_waitcnt lgkmcnt(5)
  v_mfma_f32_16x16x32_bf16 v[164:167], v[56:59], v[76:79], v[164:167]
  ds_read_b128 v[68:71], v8 offset:12288
  v_and_b32 v13, 1, v5
  v_mfma_f32_16x16x32_bf16 v[216:219], v[76:79], v[60:63], v[216:219]
  v_mul_u32_u24 v13, 60416, v13
  v_lshrrev_b32 v14, 5, v1
  v_mfma_f32_16x16x32_bf16 v[112:115], v[52:55], v[76:79], v[112:115]
  v_lshl_add_u32 v12, v14, 8, v12
  v_add_u32 v11, v12, v13
  s_waitcnt lgkmcnt(5)
  v_mfma_f32_16x16x32_bf16 v[168:171], v[56:59], v[80:83], v[168:171]
  ds_read_b128 v[72:75], v8 offset:14336
  v_and_b32 v12, 1, v1
  v_mfma_f32_16x16x32_bf16 v[220:223], v[80:83], v[60:63], v[220:223]
  v_lshl_add_u32 v5, v5, 2, v12
  v_add_u32 v13, 2, v5
  v_mfma_f32_16x16x32_bf16 v[116:119], v[52:55], v[80:83], v[116:119]
  v_cmp_eq_u32 s[64:65], 1, v12
  v_cmp_le_u32 s[66:67], v5, v4
  s_waitcnt lgkmcnt(5)
  v_mfma_f32_16x16x32_bf16 v[172:175], v[56:59], v[64:67], v[172:175]
  ds_read_b128 v[76:79], v8 offset:16384
  v_cmp_le_u32 s[68:69], v13, v4
  v_mfma_f32_16x16x32_bf16 v[224:227], v[64:67], v[60:63], v[224:227]
  v_mov_b32 v12, 0x0c0c0100
  v_mov_b32 v13, 0x01000c0c
  v_mfma_f32_16x16x32_bf16 v[120:123], v[52:55], v[64:67], v[120:123]
  v_mov_b32 v14, 0x0c0c0c0c
  v_cndmask_b32 v12, v12, v13, s[64:65]
  s_waitcnt lgkmcnt(2)
  v_mfma_f32_16x16x32_bf16 v[176:179], v[56:59], v[68:71], v[176:179]
  ds_read_b128 v[80:83], v8 offset:18432
  v_cndmask_b32 v96, v12, v14, s[66:67]
  v_mfma_f32_16x16x32_bf16 v[228:231], v[68:71], v[60:63], v[228:231]
  v_cndmask_b32 v98, v14, v12, s[66:67]
  v_mov_b32 v12, 0x0c0c0302
  v_mfma_f32_16x16x32_bf16 v[124:127], v[52:55], v[68:71], v[124:127]
  v_mov_b32 v13, 0x03020c0c
  v_cndmask_b32 v12, v12, v13, s[64:65]
  s_waitcnt lgkmcnt(2)
  v_mfma_f32_16x16x32_bf16 v[180:183], v[56:59], v[72:75], v[180:183]
  ds_read_b128 v[64:67], v8 offset:20480
  v_cndmask_b32 v97, v12, v14, s[68:69]
  v_mfma_f32_16x16x32_bf16 v[232:235], v[72:75], v[60:63], v[232:235]
  v_cndmask_b32 v99, v14, v12, s[68:69]
  v_mov_b32 v12, 0x3eb8aa3b
  v_mfma_f32_16x16x32_bf16 v[128:131], v[52:55], v[72:75], v[128:131]
  v_mov_b32 v13, 0x3eb8aa3b
  v_mov_b32 v14, 0xcf6e6b28
  s_waitcnt lgkmcnt(2)
  v_mfma_f32_16x16x32_bf16 v[184:187], v[56:59], v[76:79], v[184:187]
  ds_read_b128 v[68:71], v8 offset:22528
  s_cmp_eq_u32 s57, 0
  v_mfma_f32_16x16x32_bf16 v[236:239], v[76:79], v[60:63], v[236:239]
  s_cselect_b64 s[70:71], -1, 0
  s_mul_i32 s60, s57, 724992
  v_mfma_f32_16x16x32_bf16 v[132:135], v[52:55], v[76:79], v[132:135]
  s_lshl_b32 s61, s58, 2
  s_add_u32 s61, s61, s56
  s_lshl_b32 s61, s61, 9
  s_add_u32 s77, s60, s61
  s_waitcnt lgkmcnt(2)
  v_mfma_f32_16x16x32_bf16 v[188:191], v[56:59], v[80:83], v[188:191]
  ds_read_b128 v[72:75], v8 offset:24576
  v_mfma_f32_16x16x32_bf16 v[240:243], v[80:83], v[60:63], v[240:243]
  v_mov_b32_dpp v20, v20 row_newbcast:0 row_mask:0xf bank_mask:0xf
  v_mov_b32_dpp v21, v21 row_newbcast:0 row_mask:0xf bank_mask:0xf
  v_mfma_f32_16x16x32_bf16 v[136:139], v[52:55], v[80:83], v[136:139]
  s_waitcnt lgkmcnt(0)
  s_barrier
  v_mfma_f32_16x16x32_bf16 v[192:195], v[56:59], v[64:67], v[192:195]
  v_mov_b32_dpp v22, v22 row_newbcast:0 row_mask:0xf bank_mask:0xf
  v_mov_b32_dpp v23, v23 row_newbcast:0 row_mask:0xf bank_mask:0xf
  v_mfma_f32_16x16x32_bf16 v[244:247], v[64:67], v[60:63], v[244:247]
  v_mov_b32_dpp v24, v152 row_newbcast:0 row_mask:0xf bank_mask:0xf
  v_mov_b32_dpp v25, v153 row_newbcast:0 row_mask:0xf bank_mask:0xf
  v_mfma_f32_16x16x32_bf16 v[140:143], v[52:55], v[64:67], v[140:143]
  v_mov_b32_dpp v26, v154 row_newbcast:0 row_mask:0xf bank_mask:0xf
  v_mov_b32_dpp v27, v155 row_newbcast:0 row_mask:0xf bank_mask:0xf
  v_mfma_f32_16x16x32_bf16 v[196:199], v[56:59], v[68:71], v[196:199]
  v_mov_b32 v28, v204
  v_mov_b32 v29, v204
  v_mfma_f32_16x16x32_bf16 v[248:251], v[68:71], v[60:63], v[248:251]
  s_nop 0
  v_permlane16_swap_b32 v28, v29
  v_mfma_f32_16x16x32_bf16 v[144:147], v[52:55], v[68:71], v[144:147]
  v_mov_b32 v29, v28
  s_nop 0
  v_mfma_f32_16x16x32_bf16 v[200:203], v[56:59], v[72:75], v[200:203]
  s_nop 0
  v_permlane32_swap_b32 v28, v29
  v_mfma_f32_16x16x32_bf16 v[252:255], v[72:75], v[60:63], v[252:255]
  v_mfma_f32_16x16x32_bf16 v[148:151], v[52:55], v[72:75], v[148:151]
  ds_read_b64 v[40:41], v6 offset:128
  ds_read_b128 v[92:95], v15 offset:64
  ds_read_b128 v[100:103], v15 offset:1088
  s_waitcnt lgkmcnt(3)
  v_pk_fma_f32 v[152:153], v[24:25], v[2:3], v[152:153] op_sel_hi:[1,0,1]
  v_pk_fma_f32 v[154:155], v[26:27], v[2:3], v[154:155] op_sel_hi:[1,0,1]
  v_pk_fma_f32 v[204:205], v[32:33], v[28:29], v[204:205] op_sel_hi:[1,0,1]
  v_pk_fma_f32 v[206:207], v[34:35], v[28:29], v[206:207] op_sel_hi:[1,0,1]
  v_pk_mul_f32 v[152:153], v[152:153], v[2:3] op_sel:[0,1]
  v_pk_mul_f32 v[154:155], v[154:155], v[2:3] op_sel:[0,1]
  v_pk_mul_f32 v[204:205], v[204:205], v[36:37]
  v_pk_mul_f32 v[206:207], v[206:207], v[38:39]
  v_cvt_pk_bf16_f32 v152, v152, v153
  v_cvt_pk_bf16_f32 v153, v154, v155
  v_cvt_pk_bf16_f32 v66, v204, v205
  v_cvt_pk_bf16_f32 v67, v206, v207
  ds_read_b64 v[2:3], v6 offset:256
  ds_read_b128 v[32:35], v15 offset:128
  ds_read_b128 v[36:39], v15 offset:1152
  s_waitcnt lgkmcnt(3)
  v_pk_fma_f32 v[156:157], v[24:25], v[40:41], v[156:157] op_sel_hi:[1,0,1]
  v_pk_fma_f32 v[158:159], v[26:27], v[40:41], v[158:159] op_sel_hi:[1,0,1]
  v_pk_fma_f32 v[104:105], v[20:21], v[40:41], v[104:105] op_sel_hi:[1,0,1]
  v_pk_fma_f32 v[106:107], v[22:23], v[40:41], v[106:107] op_sel_hi:[1,0,1]
  v_pk_fma_f32 v[208:209], v[92:93], v[28:29], v[208:209] op_sel_hi:[1,0,1]
  v_pk_fma_f32 v[210:211], v[94:95], v[28:29], v[210:211] op_sel_hi:[1,0,1]
  v_pk_mul_f32 v[156:157], v[156:157], v[40:41] op_sel:[0,1]
  v_pk_mul_f32 v[158:159], v[158:159], v[40:41] op_sel:[0,1]
  v_pk_mul_f32 v[104:105], v[104:105], v[40:41] op_sel:[0,1]
  v_pk_mul_f32 v[106:107], v[106:107], v[40:41] op_sel:[0,1]
  v_pk_mul_f32 v[208:209], v[208:209], v[100:101]
  v_pk_mul_f32 v[210:211], v[210:211], v[102:103]
  v_cvt_pk_bf16_f32 v156, v156, v157
  v_cvt_pk_bf16_f32 v157, v158, v159
  v_cvt_pk_bf16_f32 v104, v104, v105
  v_cvt_pk_bf16_f32 v105, v106, v107
  v_cvt_pk_bf16_f32 v68, v208, v209
  v_cvt_pk_bf16_f32 v69, v210, v211
  ds_read_b64 v[40:41], v6 offset:384
  ds_read_b128 v[92:95], v15 offset:192
  ds_read_b128 v[100:103], v15 offset:1216
  s_waitcnt lgkmcnt(3)
  v_pk_fma_f32 v[160:161], v[24:25], v[2:3], v[160:161] op_sel_hi:[1,0,1]
  v_pk_fma_f32 v[162:163], v[26:27], v[2:3], v[162:163] op_sel_hi:[1,0,1]
  v_pk_fma_f32 v[108:109], v[20:21], v[2:3], v[108:109] op_sel_hi:[1,0,1]
  v_pk_fma_f32 v[110:111], v[22:23], v[2:3], v[110:111] op_sel_hi:[1,0,1]
  v_pk_fma_f32 v[212:213], v[32:33], v[28:29], v[212:213] op_sel_hi:[1,0,1]
  v_pk_fma_f32 v[214:215], v[34:35], v[28:29], v[214:215] op_sel_hi:[1,0,1]
  v_pk_mul_f32 v[160:161], v[160:161], v[2:3] op_sel:[0,1]
  v_pk_mul_f32 v[162:163], v[162:163], v[2:3] op_sel:[0,1]
  v_pk_mul_f32 v[108:109], v[108:109], v[2:3] op_sel:[0,1]
  v_pk_mul_f32 v[110:111], v[110:111], v[2:3] op_sel:[0,1]
  v_pk_mul_f32 v[212:213], v[212:213], v[36:37]
  v_pk_mul_f32 v[214:215], v[214:215], v[38:39]
  v_cvt_pk_bf16_f32 v160, v160, v161
  v_cvt_pk_bf16_f32 v161, v162, v163
  v_cvt_pk_bf16_f32 v108, v108, v109
  v_cvt_pk_bf16_f32 v109, v110, v111
  v_cvt_pk_bf16_f32 v70, v212, v213
  v_cvt_pk_bf16_f32 v71, v214, v215
  ds_read_b64 v[2:3], v6 offset:512
  ds_read_b128 v[32:35], v15 offset:256
  ds_read_b128 v[36:39], v15 offset:1280
  s_waitcnt lgkmcnt(3)
  v_pk_fma_f32 v[164:165], v[24:25], v[40:41], v[164:165] op_sel_hi:[1,0,1]
  v_pk_fma_f32 v[166:167], v[26:27], v[40:41], v[166:167] op_sel_hi:[1,0,1]
  v_pk_fma_f32 v[112:113], v[20:21], v[40:41], v[112:113] op_sel_hi:[1,0,1]
  v_pk_fma_f32 v[114:115], v[22:23], v[40:41], v[114:115] op_sel_hi:[1,0,1]
  v_pk_fma_f32 v[216:217], v[92:93], v[28:29], v[216:217] op_sel_hi:[1,0,1]
  v_pk_fma_f32 v[218:219], v[94:95], v[28:29], v[218:219] op_sel_hi:[1,0,1]
  v_pk_mul_f32 v[164:165], v[164:165], v[40:41] op_sel:[0,1]
  v_pk_mul_f32 v[166:167], v[166:167], v[40:41] op_sel:[0,1]
  v_pk_mul_f32 v[112:113], v[112:113], v[40:41] op_sel:[0,1]
  v_pk_mul_f32 v[114:115], v[114:115], v[40:41] op_sel:[0,1]
  v_pk_mul_f32 v[216:217], v[216:217], v[100:101]
  v_pk_mul_f32 v[218:219], v[218:219], v[102:103]
  v_cvt_pk_bf16_f32 v164, v164, v165
  v_cvt_pk_bf16_f32 v165, v166, v167
  v_cvt_pk_bf16_f32 v112, v112, v113
  v_cvt_pk_bf16_f32 v113, v114, v115
  v_cvt_pk_bf16_f32 v72, v216, v217
  v_cvt_pk_bf16_f32 v73, v218, v219
  ds_read_b64 v[40:41], v6 offset:640
  ds_read_b128 v[92:95], v15 offset:320
  ds_read_b128 v[100:103], v15 offset:1344
  s_waitcnt lgkmcnt(3)
  v_pk_fma_f32 v[168:169], v[24:25], v[2:3], v[168:169] op_sel_hi:[1,0,1]
  v_pk_fma_f32 v[170:171], v[26:27], v[2:3], v[170:171] op_sel_hi:[1,0,1]
  v_pk_fma_f32 v[116:117], v[20:21], v[2:3], v[116:117] op_sel_hi:[1,0,1]
  v_pk_fma_f32 v[118:119], v[22:23], v[2:3], v[118:119] op_sel_hi:[1,0,1]
  v_pk_fma_f32 v[220:221], v[32:33], v[28:29], v[220:221] op_sel_hi:[1,0,1]
  v_pk_fma_f32 v[222:223], v[34:35], v[28:29], v[222:223] op_sel_hi:[1,0,1]
  v_pk_mul_f32 v[168:169], v[168:169], v[2:3] op_sel:[0,1]
  v_pk_mul_f32 v[170:171], v[170:171], v[2:3] op_sel:[0,1]
  v_pk_mul_f32 v[116:117], v[116:117], v[2:3] op_sel:[0,1]
  v_pk_mul_f32 v[118:119], v[118:119], v[2:3] op_sel:[0,1]
  v_pk_mul_f32 v[220:221], v[220:221], v[36:37]
  v_pk_mul_f32 v[222:223], v[222:223], v[38:39]
  v_cvt_pk_bf16_f32 v168, v168, v169
  v_cvt_pk_bf16_f32 v169, v170, v171
  v_cvt_pk_bf16_f32 v116, v116, v117
  v_cvt_pk_bf16_f32 v117, v118, v119
  v_cvt_pk_bf16_f32 v74, v220, v221
  v_cvt_pk_bf16_f32 v75, v222, v223
  ds_read_b64 v[2:3], v6 offset:768
  ds_read_b128 v[32:35], v15 offset:384
  ds_read_b128 v[36:39], v15 offset:1408
  s_waitcnt lgkmcnt(3)
  v_pk_fma_f32 v[172:173], v[24:25], v[40:41], v[172:173] op_sel_hi:[1,0,1]
  v_pk_fma_f32 v[174:175], v[26:27], v[40:41], v[174:175] op_sel_hi:[1,0,1]
  v_pk_fma_f32 v[120:121], v[20:21], v[40:41], v[120:121] op_sel_hi:[1,0,1]
  v_pk_fma_f32 v[122:123], v[22:23], v[40:41], v[122:123] op_sel_hi:[1,0,1]
  v_pk_fma_f32 v[224:225], v[92:93], v[28:29], v[224:225] op_sel_hi:[1,0,1]
  v_pk_fma_f32 v[226:227], v[94:95], v[28:29], v[226:227] op_sel_hi:[1,0,1]
  v_pk_mul_f32 v[172:173], v[172:173], v[40:41] op_sel:[0,1]
  v_pk_mul_f32 v[174:175], v[174:175], v[40:41] op_sel:[0,1]
  v_pk_mul_f32 v[120:121], v[120:121], v[40:41] op_sel:[0,1]
  v_pk_mul_f32 v[122:123], v[122:123], v[40:41] op_sel:[0,1]
  v_pk_mul_f32 v[224:225], v[224:225], v[100:101]
  v_pk_mul_f32 v[226:227], v[226:227], v[102:103]
  v_cvt_pk_bf16_f32 v172, v172, v173
  v_cvt_pk_bf16_f32 v173, v174, v175
  v_cvt_pk_bf16_f32 v120, v120, v121
  v_cvt_pk_bf16_f32 v121, v122, v123
  v_cvt_pk_bf16_f32 v76, v224, v225
  v_cvt_pk_bf16_f32 v77, v226, v227
  ds_read_b64 v[40:41], v6 offset:896
  ds_read_b128 v[92:95], v15 offset:448
  ds_read_b128 v[100:103], v15 offset:1472
  s_waitcnt lgkmcnt(3)
  v_pk_fma_f32 v[176:177], v[24:25], v[2:3], v[176:177] op_sel_hi:[1,0,1]
  v_pk_fma_f32 v[178:179], v[26:27], v[2:3], v[178:179] op_sel_hi:[1,0,1]
  v_pk_fma_f32 v[124:125], v[20:21], v[2:3], v[124:125] op_sel_hi:[1,0,1]
  v_pk_fma_f32 v[126:127], v[22:23], v[2:3], v[126:127] op_sel_hi:[1,0,1]
  v_pk_fma_f32 v[228:229], v[32:33], v[28:29], v[228:229] op_sel_hi:[1,0,1]
  v_pk_fma_f32 v[230:231], v[34:35], v[28:29], v[230:231] op_sel_hi:[1,0,1]
  v_pk_mul_f32 v[176:177], v[176:177], v[2:3] op_sel:[0,1]
  v_pk_mul_f32 v[178:179], v[178:179], v[2:3] op_sel:[0,1]
  v_pk_mul_f32 v[124:125], v[124:125], v[2:3] op_sel:[0,1]
  v_pk_mul_f32 v[126:127], v[126:127], v[2:3] op_sel:[0,1]
  v_pk_mul_f32 v[228:229], v[228:229], v[36:37]
  v_pk_mul_f32 v[230:231], v[230:231], v[38:39]
  v_cvt_pk_bf16_f32 v176, v176, v177
  v_cvt_pk_bf16_f32 v177, v178, v179
  v_cvt_pk_bf16_f32 v124, v124, v125
  v_cvt_pk_bf16_f32 v125, v126, v127
  v_cvt_pk_bf16_f32 v78, v228, v229
  v_cvt_pk_bf16_f32 v79, v230, v231
  ds_read_b64 v[2:3], v6 offset:1024
  ds_read_b128 v[32:35], v15 offset:512
  ds_read_b128 v[36:39], v15 offset:1536
  s_waitcnt lgkmcnt(3)
  v_pk_fma_f32 v[180:181], v[24:25], v[40:41], v[180:181] op_sel_hi:[1,0,1]
  v_pk_fma_f32 v[182:183], v[26:27], v[40:41], v[182:183] op_sel_hi:[1,0,1]
  v_pk_fma_f32 v[128:129], v[20:21], v[40:41], v[128:129] op_sel_hi:[1,0,1]
  v_pk_fma_f32 v[130:131], v[22:23], v[40:41], v[130:131] op_sel_hi:[1,0,1]
  v_pk_fma_f32 v[232:233], v[92:93], v[28:29], v[232:233] op_sel_hi:[1,0,1]
  v_pk_fma_f32 v[234:235], v[94:95], v[28:29], v[234:235] op_sel_hi:[1,0,1]
  v_pk_mul_f32 v[180:181], v[180:181], v[40:41] op_sel:[0,1]
  v_pk_mul_f32 v[182:183], v[182:183], v[40:41] op_sel:[0,1]
  v_pk_mul_f32 v[128:129], v[128:129], v[40:41] op_sel:[0,1]
  v_pk_mul_f32 v[130:131], v[130:131], v[40:41] op_sel:[0,1]
  v_pk_mul_f32 v[232:233], v[232:233], v[100:101]
  v_pk_mul_f32 v[234:235], v[234:235], v[102:103]
  v_cvt_pk_bf16_f32 v180, v180, v181
  v_cvt_pk_bf16_f32 v181, v182, v183
  v_cvt_pk_bf16_f32 v128, v128, v129
  v_cvt_pk_bf16_f32 v129, v130, v131
  v_cvt_pk_bf16_f32 v80, v232, v233
  v_cvt_pk_bf16_f32 v81, v234, v235
  ds_read_b64 v[40:41], v6 offset:1152
  ds_read_b128 v[92:95], v15 offset:576
  ds_read_b128 v[100:103], v15 offset:1600
  s_waitcnt lgkmcnt(3)
  v_pk_fma_f32 v[184:185], v[24:25], v[2:3], v[184:185] op_sel_hi:[1,0,1]
  v_pk_fma_f32 v[186:187], v[26:27], v[2:3], v[186:187] op_sel_hi:[1,0,1]
  v_pk_fma_f32 v[132:133], v[20:21], v[2:3], v[132:133] op_sel_hi:[1,0,1]
  v_pk_fma_f32 v[134:135], v[22:23], v[2:3], v[134:135] op_sel_hi:[1,0,1]
  v_pk_fma_f32 v[236:237], v[32:33], v[28:29], v[236:237] op_sel_hi:[1,0,1]
  v_pk_fma_f32 v[238:239], v[34:35], v[28:29], v[238:239] op_sel_hi:[1,0,1]
  v_pk_mul_f32 v[184:185], v[184:185], v[2:3] op_sel:[0,1]
  v_pk_mul_f32 v[186:187], v[186:187], v[2:3] op_sel:[0,1]
  v_pk_mul_f32 v[132:133], v[132:133], v[2:3] op_sel:[0,1]
  v_pk_mul_f32 v[134:135], v[134:135], v[2:3] op_sel:[0,1]
  v_pk_mul_f32 v[236:237], v[236:237], v[36:37]
  v_pk_mul_f32 v[238:239], v[238:239], v[38:39]
  v_cvt_pk_bf16_f32 v184, v184, v185
  v_cvt_pk_bf16_f32 v185, v186, v187
  v_cvt_pk_bf16_f32 v132, v132, v133
  v_cvt_pk_bf16_f32 v133, v134, v135
  v_cvt_pk_bf16_f32 v82, v236, v237
  v_cvt_pk_bf16_f32 v83, v238, v239
  ds_read_b64 v[2:3], v6 offset:1280
  ds_read_b128 v[32:35], v15 offset:640
  ds_read_b128 v[36:39], v15 offset:1664
  s_waitcnt lgkmcnt(3)
  v_pk_fma_f32 v[188:189], v[24:25], v[40:41], v[188:189] op_sel_hi:[1,0,1]
  v_pk_fma_f32 v[190:191], v[26:27], v[40:41], v[190:191] op_sel_hi:[1,0,1]
  v_pk_fma_f32 v[136:137], v[20:21], v[40:41], v[136:137] op_sel_hi:[1,0,1]
  v_pk_fma_f32 v[138:139], v[22:23], v[40:41], v[138:139] op_sel_hi:[1,0,1]
  v_pk_fma_f32 v[240:241], v[92:93], v[28:29], v[240:241] op_sel_hi:[1,0,1]
  v_pk_fma_f32 v[242:243], v[94:95], v[28:29], v[242:243] op_sel_hi:[1,0,1]
  v_pk_mul_f32 v[188:189], v[188:189], v[40:41] op_sel:[0,1]
  v_pk_mul_f32 v[190:191], v[190:191], v[40:41] op_sel:[0,1]
  v_pk_mul_f32 v[136:137], v[136:137], v[40:41] op_sel:[0,1]
  v_pk_mul_f32 v[138:139], v[138:139], v[40:41] op_sel:[0,1]
  v_pk_mul_f32 v[240:241], v[240:241], v[100:101]
  v_pk_mul_f32 v[242:243], v[242:243], v[102:103]
  v_cvt_pk_bf16_f32 v188, v188, v189
  v_cvt_pk_bf16_f32 v189, v190, v191
  v_cvt_pk_bf16_f32 v136, v136, v137
  v_cvt_pk_bf16_f32 v137, v138, v139
  v_cvt_pk_bf16_f32 v84, v240, v241
  v_cvt_pk_bf16_f32 v85, v242, v243
  ds_read_b64 v[40:41], v6 offset:1408
  ds_read_b128 v[92:95], v15 offset:704
  ds_read_b128 v[100:103], v15 offset:1728
  s_waitcnt lgkmcnt(3)
  v_pk_fma_f32 v[192:193], v[24:25], v[2:3], v[192:193] op_sel_hi:[1,0,1]
  v_pk_fma_f32 v[194:195], v[26:27], v[2:3], v[194:195] op_sel_hi:[1,0,1]
  v_pk_fma_f32 v[140:141], v[20:21], v[2:3], v[140:141] op_sel_hi:[1,0,1]
  v_pk_fma_f32 v[142:143], v[22:23], v[2:3], v[142:143] op_sel_hi:[1,0,1]
  v_pk_fma_f32 v[244:245], v[32:33], v[28:29], v[244:245] op_sel_hi:[1,0,1]
  v_pk_fma_f32 v[246:247], v[34:35], v[28:29], v[246:247] op_sel_hi:[1,0,1]
  v_pk_mul_f32 v[192:193], v[192:193], v[2:3] op_sel:[0,1]
  v_pk_mul_f32 v[194:195], v[194:195], v[2:3] op_sel:[0,1]
  v_pk_mul_f32 v[140:141], v[140:141], v[2:3] op_sel:[0,1]
  v_pk_mul_f32 v[142:143], v[142:143], v[2:3] op_sel:[0,1]
  v_pk_mul_f32 v[244:245], v[244:245], v[36:37]
  v_pk_mul_f32 v[246:247], v[246:247], v[38:39]
  v_cvt_pk_bf16_f32 v192, v192, v193
  v_cvt_pk_bf16_f32 v193, v194, v195
  v_cvt_pk_bf16_f32 v140, v140, v141
  v_cvt_pk_bf16_f32 v141, v142, v143
  v_cvt_pk_bf16_f32 v86, v244, v245
  v_cvt_pk_bf16_f32 v87, v246, v247
  ds_read_b64 v[2:3], v6 offset:1536
  ds_read_b128 v[32:35], v15 offset:768
  ds_read_b128 v[36:39], v15 offset:1792
  s_waitcnt lgkmcnt(3)
  v_pk_fma_f32 v[196:197], v[24:25], v[40:41], v[196:197] op_sel_hi:[1,0,1]
  v_pk_fma_f32 v[198:199], v[26:27], v[40:41], v[198:199] op_sel_hi:[1,0,1]
  v_pk_fma_f32 v[144:145], v[20:21], v[40:41], v[144:145] op_sel_hi:[1,0,1]
  v_pk_fma_f32 v[146:147], v[22:23], v[40:41], v[146:147] op_sel_hi:[1,0,1]
  v_pk_fma_f32 v[248:249], v[92:93], v[28:29], v[248:249] op_sel_hi:[1,0,1]
  v_pk_fma_f32 v[250:251], v[94:95], v[28:29], v[250:251] op_sel_hi:[1,0,1]
  v_pk_mul_f32 v[196:197], v[196:197], v[40:41] op_sel:[0,1]
  v_pk_mul_f32 v[198:199], v[198:199], v[40:41] op_sel:[0,1]
  v_pk_mul_f32 v[144:145], v[144:145], v[40:41] op_sel:[0,1]
  v_pk_mul_f32 v[146:147], v[146:147], v[40:41] op_sel:[0,1]
  v_pk_mul_f32 v[248:249], v[248:249], v[100:101]
  v_pk_mul_f32 v[250:251], v[250:251], v[102:103]
  v_cvt_pk_bf16_f32 v196, v196, v197
  v_cvt_pk_bf16_f32 v197, v198, v199
  v_cvt_pk_bf16_f32 v144, v144, v145
  v_cvt_pk_bf16_f32 v145, v146, v147
  v_cvt_pk_bf16_f32 v88, v248, v249
  v_cvt_pk_bf16_f32 v89, v250, v251
  s_waitcnt lgkmcnt(2)
  v_pk_fma_f32 v[200:201], v[24:25], v[2:3], v[200:201] op_sel_hi:[1,0,1]
  v_pk_fma_f32 v[202:203], v[26:27], v[2:3], v[202:203] op_sel_hi:[1,0,1]
  v_pk_fma_f32 v[148:149], v[20:21], v[2:3], v[148:149] op_sel_hi:[1,0,1]
  v_pk_fma_f32 v[150:151], v[22:23], v[2:3], v[150:151] op_sel_hi:[1,0,1]
  s_waitcnt lgkmcnt(1)
  v_pk_fma_f32 v[252:253], v[32:33], v[28:29], v[252:253] op_sel_hi:[1,0,1]
  v_pk_fma_f32 v[254:255], v[34:35], v[28:29], v[254:255] op_sel_hi:[1,0,1]
  v_pk_mul_f32 v[200:201], v[200:201], v[2:3] op_sel:[0,1]
  v_pk_mul_f32 v[202:203], v[202:203], v[2:3] op_sel:[0,1]
  v_pk_mul_f32 v[148:149], v[148:149], v[2:3] op_sel:[0,1]
  v_pk_mul_f32 v[150:151], v[150:151], v[2:3] op_sel:[0,1]
  s_waitcnt lgkmcnt(0)
  v_pk_mul_f32 v[252:253], v[252:253], v[36:37]
  v_pk_mul_f32 v[254:255], v[254:255], v[38:39]
  v_cvt_pk_bf16_f32 v200, v200, v201
  v_cvt_pk_bf16_f32 v201, v202, v203
  v_cvt_pk_bf16_f32 v148, v148, v149
  v_cvt_pk_bf16_f32 v149, v150, v151
  v_cvt_pk_bf16_f32 v90, v252, v253
  v_cvt_pk_bf16_f32 v91, v254, v255
  v_mfma_f32_16x16x16bf16_1k v[204:207], v[152:153], v[104:105], 0
  v_mfma_f32_16x16x16bf16_1k v[208:211], v[156:157], v[104:105], 0
  v_mfma_f32_16x16x16bf16_1k v[212:215], v[156:157], v[108:109], 0
  v_mfma_f32_16x16x16bf16_1k v[216:219], v[160:161], v[108:109], 0
  v_mfma_f32_16x16x16bf16_1k v[220:223], v[160:161], v[112:113], 0
  v_mfma_f32_16x16x16bf16_1k v[224:227], v[164:165], v[112:113], 0
  v_mfma_f32_16x16x16bf16_1k v[228:231], v[164:165], v[116:117], 0
  v_mfma_f32_16x16x16bf16_1k v[232:235], v[168:169], v[116:117], 0
  s_nop 0
  v_cndmask_b32 v204, v204, v205, s[64:65]
  v_cndmask_b32 v206, v206, v207, s[64:65]
  v_mfma_f32_16x16x16bf16_1k v[236:239], v[168:169], v[120:121], 0
  v_cndmask_b32 v208, v208, v209, s[64:65]
  v_cndmask_b32 v210, v210, v211, s[64:65]
  v_mfma_f32_16x16x16bf16_1k v[240:243], v[172:173], v[120:121], 0
  v_cndmask_b32 v204, v204, v14, s[70:71]
  v_cndmask_b32 v206, v206, v14, s[70:71]
  v_mfma_f32_16x16x16bf16_1k v[244:247], v[172:173], v[124:125], 0
  v_cndmask_b32 v212, v212, v213, s[64:65]
  v_cndmask_b32 v214, v214, v215, s[64:65]
  v_mfma_f32_16x16x16bf16_1k v[248:251], v[176:177], v[124:125], 0
  v_cndmask_b32 v216, v216, v217, s[64:65]
  v_cndmask_b32 v218, v218, v219, s[64:65]
  v_mfma_f32_16x16x16bf16_1k v[252:255], v[176:177], v[128:129], 0
  v_cndmask_b32 v220, v220, v221, s[64:65]
  v_cndmask_b32 v222, v222, v223, s[64:65]
  v_mfma_f32_16x16x16bf16_1k v[40:43], v[180:181], v[128:129], 0
  v_cndmask_b32 v224, v224, v225, s[64:65]
  v_cndmask_b32 v226, v226, v227, s[64:65]
  v_mfma_f32_16x16x16bf16_1k v[44:47], v[180:181], v[132:133], 0
  v_cndmask_b32 v228, v228, v229, s[64:65]
  v_cndmask_b32 v230, v230, v231, s[64:65]
  v_mfma_f32_16x16x16bf16_1k v[48:51], v[184:185], v[132:133], 0
  v_cndmask_b32 v232, v232, v233, s[64:65]
  v_cndmask_b32 v234, v234, v235, s[64:65]
  v_cndmask_b32 v20, v204, v208, s[66:67]
  v_cndmask_b32 v21, v206, v210, s[68:69]
  v_cndmask_b32 v24, v212, v216, s[66:67]
  v_cndmask_b32 v25, v214, v218, s[68:69]
  v_cndmask_b32 v28, v220, v224, s[66:67]
  v_cndmask_b32 v29, v222, v226, s[68:69]
  v_cndmask_b32 v32, v228, v232, s[66:67]
  v_cndmask_b32 v33, v230, v234, s[68:69]
  v_max_f32 v22, v20, v21
  v_max_f32 v26, v24, v25
  v_max_f32 v30, v28, v29
  v_max_f32 v34, v32, v33
  v_permlane16_swap_b32 v22, v26
  s_nop 0
  v_permlane16_swap_b32 v30, v34
  v_max_f32 v22, v22, v26
  v_max_f32 v30, v30, v34
  s_nop 1
  v_permlane32_swap_b32 v22, v30
  v_max_f32 v22, v22, v30
  v_mov_b32 v30, v22
  s_nop 1
  v_permlane32_swap_b32 v22, v30
  v_mov_b32 v26, v22
  v_mov_b32 v34, v30
  s_nop 0
  v_permlane16_swap_b32 v22, v26
  v_permlane16_swap_b32 v30, v34
  v_pk_add_f32 v[20:21], v[20:21], v[22:23] op_sel_hi:[1,0] neg_lo:[0,1] neg_hi:[0,1]
  v_pk_add_f32 v[24:25], v[24:25], v[26:27] op_sel_hi:[1,0] neg_lo:[0,1] neg_hi:[0,1]
  v_pk_add_f32 v[28:29], v[28:29], v[30:31] op_sel_hi:[1,0] neg_lo:[0,1] neg_hi:[0,1]
  v_pk_add_f32 v[32:33], v[32:33], v[34:35] op_sel_hi:[1,0] neg_lo:[0,1] neg_hi:[0,1]
  v_pk_mul_f32 v[20:21], v[20:21], v[12:13]
  v_pk_mul_f32 v[24:25], v[24:25], v[12:13]
  v_pk_mul_f32 v[28:29], v[28:29], v[12:13]
  v_pk_mul_f32 v[32:33], v[32:33], v[12:13]
  v_exp_f32 v20, v20
  v_exp_f32 v21, v21
  v_exp_f32 v24, v24
  v_exp_f32 v25, v25
  v_exp_f32 v28, v28
  v_exp_f32 v29, v29
  v_exp_f32 v32, v32
  v_exp_f32 v33, v33
  v_cvt_pk_bf16_f32 v20, v20, v21
  v_cvt_pk_bf16_f32 v24, v24, v25
  v_cvt_pk_bf16_f32 v28, v28, v29
  v_cvt_pk_bf16_f32 v32, v32, v33
  v_perm_b32 v104, v20, v20, v96
  v_perm_b32 v105, v20, v20, v97
  v_perm_b32 v106, v20, v20, v98
  v_perm_b32 v107, v20, v20, v99
  v_perm_b32 v108, v24, v24, v96
  v_perm_b32 v109, v24, v24, v97
  v_perm_b32 v110, v24, v24, v98
  v_perm_b32 v111, v24, v24, v99
  v_perm_b32 v112, v28, v28, v96
  v_perm_b32 v113, v28, v28, v97
  v_perm_b32 v114, v28, v28, v98
  v_perm_b32 v115, v28, v28, v99
  v_perm_b32 v116, v32, v32, v96
  v_perm_b32 v117, v32, v32, v97
  v_perm_b32 v118, v32, v32, v98
  v_perm_b32 v119, v32, v32, v99
  v_cndmask_b32 v236, v236, v237, s[64:65]
  v_cndmask_b32 v238, v238, v239, s[64:65]
  v_mfma_f32_16x16x32_bf16 v[208:211], v[16:19], v[104:107], 0
  v_cndmask_b32 v240, v240, v241, s[64:65]
  v_cndmask_b32 v242, v242, v243, s[64:65]
  v_mfma_f32_16x16x32_bf16 v[204:207], v[66:69], v[104:107], 0
  v_cndmask_b32 v244, v244, v245, s[64:65]
  v_cndmask_b32 v246, v246, v247, s[64:65]
  v_mfma_f32_16x16x32_bf16 v[216:219], v[16:19], v[108:111], 0
  v_cndmask_b32 v248, v248, v249, s[64:65]
  v_cndmask_b32 v250, v250, v251, s[64:65]
  v_mfma_f32_16x16x32_bf16 v[212:215], v[68:71], v[108:111], 0
  v_cndmask_b32 v252, v252, v253, s[64:65]
  v_cndmask_b32 v254, v254, v255, s[64:65]
  v_mfma_f32_16x16x32_bf16 v[224:227], v[16:19], v[112:115], 0
  v_cndmask_b32 v40, v40, v41, s[64:65]
  v_cndmask_b32 v42, v42, v43, s[64:65]
  v_mfma_f32_16x16x32_bf16 v[220:223], v[70:73], v[112:115], 0
  v_cndmask_b32 v44, v44, v45, s[64:65]
  v_cndmask_b32 v46, v46, v47, s[64:65]
  v_mfma_f32_16x16x32_bf16 v[232:235], v[16:19], v[116:119], 0
  v_cndmask_b32 v48, v48, v49, s[64:65]
  v_cndmask_b32 v50, v50, v51, s[64:65]
  v_mfma_f32_16x16x32_bf16 v[228:231], v[72:75], v[116:119], 0
  v_cndmask_b32 v20, v236, v240, s[66:67]
  v_cndmask_b32 v21, v238, v242, s[68:69]
  v_cndmask_b32 v24, v244, v248, s[66:67]
  v_cndmask_b32 v25, v246, v250, s[68:69]
  v_cndmask_b32 v28, v252, v40, s[66:67]
  v_cndmask_b32 v29, v254, v42, s[68:69]
  v_cndmask_b32 v32, v44, v48, s[66:67]
  v_cndmask_b32 v33, v46, v50, s[68:69]
  v_rcp_f32 v208, v208
  v_rcp_f32 v216, v216
  v_rcp_f32 v224, v224
  v_rcp_f32 v232, v232
  v_pk_mul_f32 v[204:205], v[204:205], v[208:209] op_sel_hi:[1,0]
  v_pk_mul_f32 v[206:207], v[206:207], v[208:209] op_sel_hi:[1,0]
  v_pk_mul_f32 v[212:213], v[212:213], v[216:217] op_sel_hi:[1,0]
  v_pk_mul_f32 v[214:215], v[214:215], v[216:217] op_sel_hi:[1,0]
  v_pk_mul_f32 v[220:221], v[220:221], v[224:225] op_sel_hi:[1,0]
  v_pk_mul_f32 v[222:223], v[222:223], v[224:225] op_sel_hi:[1,0]
  v_pk_mul_f32 v[228:229], v[228:229], v[232:233] op_sel_hi:[1,0]
  v_pk_mul_f32 v[230:231], v[230:231], v[232:233] op_sel_hi:[1,0]
  v_cvt_pk_bf16_f32 v104, v204, v205
  v_cvt_pk_bf16_f32 v105, v206, v207
  v_cvt_pk_bf16_f32 v106, v212, v213
  v_cvt_pk_bf16_f32 v107, v214, v215
  v_cvt_pk_bf16_f32 v112, v220, v221
  v_cvt_pk_bf16_f32 v113, v222, v223
  v_cvt_pk_bf16_f32 v114, v228, v229
  v_cvt_pk_bf16_f32 v115, v230, v231
  s_add_u32 s60, s77, 0
  v_permlane16_swap_b32 v104, v106
  v_permlane16_swap_b32 v105, v107
  buffer_store_dwordx4 v[104:107], v11, s[16:19], s60 offen sc0 sc1
  s_add_u32 s60, s77, 120832
  v_permlane16_swap_b32 v112, v114
  v_permlane16_swap_b32 v113, v115
  buffer_store_dwordx4 v[112:115], v11, s[16:19], s60 offen sc0 sc1
  v_max_f32 v22, v20, v21
  v_max_f32 v26, v24, v25
  v_mfma_f32_16x16x16bf16_1k v[204:207], v[184:185], v[136:137], 0
  v_max_f32 v30, v28, v29
  v_max_f32 v34, v32, v33
  v_mfma_f32_16x16x16bf16_1k v[208:211], v[188:189], v[136:137], 0
  v_permlane16_swap_b32 v22, v26
  v_permlane16_swap_b32 v30, v34
  v_mfma_f32_16x16x16bf16_1k v[212:215], v[188:189], v[140:141], 0
  v_max_f32 v22, v22, v26
  v_max_f32 v30, v30, v34
  v_mfma_f32_16x16x16bf16_1k v[216:219], v[192:193], v[140:141], 0
  s_nop 0
  v_permlane32_swap_b32 v22, v30
  v_max_f32 v22, v22, v30
  v_mfma_f32_16x16x16bf16_1k v[220:223], v[192:193], v[144:145], 0
  v_mov_b32 v30, v22
  s_nop 1
  v_permlane32_swap_b32 v22, v30
  v_mfma_f32_16x16x16bf16_1k v[224:227], v[196:197], v[144:145], 0
  v_mov_b32 v26, v22
  v_mov_b32 v34, v30
  v_mfma_f32_16x16x16bf16_1k v[228:231], v[196:197], v[148:149], 0
  v_permlane16_swap_b32 v22, v26
  v_permlane16_swap_b32 v30, v34
  v_pk_add_f32 v[20:21], v[20:21], v[22:23] op_sel_hi:[1,0] neg_lo:[0,1] neg_hi:[0,1]
  v_pk_add_f32 v[24:25], v[24:25], v[26:27] op_sel_hi:[1,0] neg_lo:[0,1] neg_hi:[0,1]
  v_pk_add_f32 v[28:29], v[28:29], v[30:31] op_sel_hi:[1,0] neg_lo:[0,1] neg_hi:[0,1]
  v_pk_add_f32 v[32:33], v[32:33], v[34:35] op_sel_hi:[1,0] neg_lo:[0,1] neg_hi:[0,1]
  v_pk_mul_f32 v[20:21], v[20:21], v[12:13]
  v_pk_mul_f32 v[24:25], v[24:25], v[12:13]
  v_pk_mul_f32 v[28:29], v[28:29], v[12:13]
  v_pk_mul_f32 v[32:33], v[32:33], v[12:13]
  v_mfma_f32_16x16x16bf16_1k v[232:235], v[200:201], v[148:149], 0
  v_exp_f32 v20, v20
  v_exp_f32 v21, v21
  v_exp_f32 v24, v24
  v_exp_f32 v25, v25
  v_exp_f32 v28, v28
  v_exp_f32 v29, v29
  v_exp_f32 v32, v32
  v_exp_f32 v33, v33
  v_cvt_pk_bf16_f32 v20, v20, v21
  v_cvt_pk_bf16_f32 v24, v24, v25
  v_cvt_pk_bf16_f32 v28, v28, v29
  v_cvt_pk_bf16_f32 v32, v32, v33
  v_perm_b32 v120, v20, v20, v96
  v_perm_b32 v121, v20, v20, v97
  v_perm_b32 v122, v20, v20, v98
  v_perm_b32 v123, v20, v20, v99
  v_perm_b32 v124, v24, v24, v96
  v_perm_b32 v125, v24, v24, v97
  v_perm_b32 v126, v24, v24, v98
  v_perm_b32 v127, v24, v24, v99
  v_perm_b32 v128, v28, v28, v96
  v_perm_b32 v129, v28, v28, v97
  v_perm_b32 v130, v28, v28, v98
  v_perm_b32 v131, v28, v28, v99
  v_perm_b32 v132, v32, v32, v96
  v_perm_b32 v133, v32, v32, v97
  v_perm_b32 v134, v32, v32, v98
  v_perm_b32 v135, v32, v32, v99
  v_cndmask_b32 v204, v204, v205, s[64:65]
  v_cndmask_b32 v206, v206, v207, s[64:65]
  v_mfma_f32_16x16x32_bf16 v[240:243], v[16:19], v[120:123], 0
  v_cndmask_b32 v208, v208, v209, s[64:65]
  v_cndmask_b32 v210, v210, v211, s[64:65]
  v_mfma_f32_16x16x32_bf16 v[236:239], v[74:77], v[120:123], 0
  v_cndmask_b32 v212, v212, v213, s[64:65]
  v_cndmask_b32 v214, v214, v215, s[64:65]
  v_mfma_f32_16x16x32_bf16 v[248:251], v[16:19], v[124:127], 0
  v_cndmask_b32 v216, v216, v217, s[64:65]
  v_cndmask_b32 v218, v218, v219, s[64:65]
  v_mfma_f32_16x16x32_bf16 v[244:247], v[76:79], v[124:127], 0
  v_cndmask_b32 v220, v220, v221, s[64:65]
  v_cndmask_b32 v222, v222, v223, s[64:65]
  v_mfma_f32_16x16x32_bf16 v[40:43], v[16:19], v[128:131], 0
  v_cndmask_b32 v224, v224, v225, s[64:65]
  v_cndmask_b32 v226, v226, v227, s[64:65]
  v_mfma_f32_16x16x32_bf16 v[252:255], v[78:81], v[128:131], 0
  v_cndmask_b32 v228, v228, v229, s[64:65]
  v_cndmask_b32 v230, v230, v231, s[64:65]
  v_mfma_f32_16x16x32_bf16 v[48:51], v[16:19], v[132:135], 0
  v_cndmask_b32 v232, v232, v233, s[64:65]
  v_cndmask_b32 v234, v234, v235, s[64:65]
  v_mfma_f32_16x16x32_bf16 v[44:47], v[80:83], v[132:135], 0
  v_cndmask_b32 v20, v204, v208, s[66:67]
  v_cndmask_b32 v21, v206, v210, s[68:69]
  v_cndmask_b32 v24, v212, v216, s[66:67]
  v_cndmask_b32 v25, v214, v218, s[68:69]
  v_cndmask_b32 v28, v220, v224, s[66:67]
  v_cndmask_b32 v29, v222, v226, s[68:69]
  v_cndmask_b32 v32, v228, v232, s[66:67]
  v_cndmask_b32 v33, v230, v234, s[68:69]
  v_rcp_f32 v240, v240
  v_rcp_f32 v248, v248
  v_rcp_f32 v40, v40
  v_rcp_f32 v48, v48
  v_pk_mul_f32 v[236:237], v[236:237], v[240:241] op_sel_hi:[1,0]
  v_pk_mul_f32 v[238:239], v[238:239], v[240:241] op_sel_hi:[1,0]
  v_pk_mul_f32 v[244:245], v[244:245], v[248:249] op_sel_hi:[1,0]
  v_pk_mul_f32 v[246:247], v[246:247], v[248:249] op_sel_hi:[1,0]
  v_pk_mul_f32 v[252:253], v[252:253], v[40:41] op_sel_hi:[1,0]
  v_pk_mul_f32 v[254:255], v[254:255], v[40:41] op_sel_hi:[1,0]
  v_pk_mul_f32 v[44:45], v[44:45], v[48:49] op_sel_hi:[1,0]
  v_pk_mul_f32 v[46:47], v[46:47], v[48:49] op_sel_hi:[1,0]
  v_cvt_pk_bf16_f32 v120, v236, v237
  v_cvt_pk_bf16_f32 v121, v238, v239
  v_cvt_pk_bf16_f32 v122, v244, v245
  v_cvt_pk_bf16_f32 v123, v246, v247
  v_cvt_pk_bf16_f32 v128, v252, v253
  v_cvt_pk_bf16_f32 v129, v254, v255
  v_cvt_pk_bf16_f32 v130, v44, v45
  v_cvt_pk_bf16_f32 v131, v46, v47
  s_add_u32 s60, s77, 241664
  v_permlane16_swap_b32 v120, v122
  v_permlane16_swap_b32 v121, v123
  buffer_store_dwordx4 v[120:123], v11, s[16:19], s60 offen sc0 sc1
  s_add_u32 s60, s77, 362496
  v_permlane16_swap_b32 v128, v130
  v_permlane16_swap_b32 v129, v131
  buffer_store_dwordx4 v[128:131], v11, s[16:19], s60 offen sc0 sc1
  v_max_f32 v22, v20, v21
  v_max_f32 v26, v24, v25
  v_max_f32 v30, v28, v29
  v_max_f32 v34, v32, v33
  v_permlane16_swap_b32 v22, v26
  s_nop 0
  v_permlane16_swap_b32 v30, v34
  v_max_f32 v22, v22, v26
  v_max_f32 v30, v30, v34
  s_nop 1
  v_permlane32_swap_b32 v22, v30
  v_max_f32 v22, v22, v30
  v_mov_b32 v30, v22
  s_nop 1
  v_permlane32_swap_b32 v22, v30
  v_mov_b32 v26, v22
  v_mov_b32 v34, v30
  s_nop 0
  v_permlane16_swap_b32 v22, v26
  v_permlane16_swap_b32 v30, v34
  v_pk_add_f32 v[20:21], v[20:21], v[22:23] op_sel_hi:[1,0] neg_lo:[0,1] neg_hi:[0,1]
  v_pk_add_f32 v[24:25], v[24:25], v[26:27] op_sel_hi:[1,0] neg_lo:[0,1] neg_hi:[0,1]
  v_pk_add_f32 v[28:29], v[28:29], v[30:31] op_sel_hi:[1,0] neg_lo:[0,1] neg_hi:[0,1]
  v_pk_add_f32 v[32:33], v[32:33], v[34:35] op_sel_hi:[1,0] neg_lo:[0,1] neg_hi:[0,1]
  v_pk_mul_f32 v[20:21], v[20:21], v[12:13]
  v_pk_mul_f32 v[24:25], v[24:25], v[12:13]
  v_pk_mul_f32 v[28:29], v[28:29], v[12:13]
  v_pk_mul_f32 v[32:33], v[32:33], v[12:13]
  v_exp_f32 v20, v20
  v_exp_f32 v21, v21
  v_exp_f32 v24, v24
  v_exp_f32 v25, v25
  v_exp_f32 v28, v28
  v_exp_f32 v29, v29
  v_exp_f32 v32, v32
  v_exp_f32 v33, v33
  v_cvt_pk_bf16_f32 v20, v20, v21
  v_cvt_pk_bf16_f32 v24, v24, v25
  v_cvt_pk_bf16_f32 v28, v28, v29
  v_cvt_pk_bf16_f32 v32, v32, v33
  v_perm_b32 v136, v20, v20, v96
  v_perm_b32 v137, v20, v20, v97
  v_perm_b32 v138, v20, v20, v98
  v_perm_b32 v139, v20, v20, v99
  v_perm_b32 v140, v24, v24, v96
  v_perm_b32 v141, v24, v24, v97
  v_perm_b32 v142, v24, v24, v98
  v_perm_b32 v143, v24, v24, v99
  v_perm_b32 v144, v28, v28, v96
  v_perm_b32 v145, v28, v28, v97
  v_perm_b32 v146, v28, v28, v98
  v_perm_b32 v147, v28, v28, v99
  v_perm_b32 v148, v32, v32, v96
  v_perm_b32 v149, v32, v32, v97
  v_perm_b32 v150, v32, v32, v98
  v_perm_b32 v151, v32, v32, v99
  v_mfma_f32_16x16x32_bf16 v[208:211], v[16:19], v[136:139], 0
  v_mfma_f32_16x16x32_bf16 v[204:207], v[82:85], v[136:139], 0
  v_mfma_f32_16x16x32_bf16 v[216:219], v[16:19], v[140:143], 0
  v_mfma_f32_16x16x32_bf16 v[212:215], v[84:87], v[140:143], 0
  v_mfma_f32_16x16x32_bf16 v[224:227], v[16:19], v[144:147], 0
  v_mfma_f32_16x16x32_bf16 v[220:223], v[86:89], v[144:147], 0
  v_mfma_f32_16x16x32_bf16 v[232:235], v[16:19], v[148:151], 0
  v_mfma_f32_16x16x32_bf16 v[228:231], v[88:91], v[148:151], 0
  s_nop 0
  v_rcp_f32 v208, v208
  s_nop 0
  v_rcp_f32 v216, v216
  s_nop 0
  v_rcp_f32 v224, v224
  s_nop 0
  v_rcp_f32 v232, v232
  v_pk_mul_f32 v[204:205], v[204:205], v[208:209] op_sel_hi:[1,0]
  v_pk_mul_f32 v[206:207], v[206:207], v[208:209] op_sel_hi:[1,0]
  v_pk_mul_f32 v[212:213], v[212:213], v[216:217] op_sel_hi:[1,0]
  v_pk_mul_f32 v[214:215], v[214:215], v[216:217] op_sel_hi:[1,0]
  v_pk_mul_f32 v[220:221], v[220:221], v[224:225] op_sel_hi:[1,0]
  v_pk_mul_f32 v[222:223], v[222:223], v[224:225] op_sel_hi:[1,0]
  v_pk_mul_f32 v[228:229], v[228:229], v[232:233] op_sel_hi:[1,0]
  v_pk_mul_f32 v[230:231], v[230:231], v[232:233] op_sel_hi:[1,0]
  v_cvt_pk_bf16_f32 v136, v204, v205
  v_cvt_pk_bf16_f32 v137, v206, v207
  v_cvt_pk_bf16_f32 v138, v212, v213
  v_cvt_pk_bf16_f32 v139, v214, v215
  v_cvt_pk_bf16_f32 v144, v220, v221
  v_cvt_pk_bf16_f32 v145, v222, v223
  v_cvt_pk_bf16_f32 v146, v228, v229
  v_cvt_pk_bf16_f32 v147, v230, v231
  s_add_u32 s60, s77, 483328
  v_permlane16_swap_b32 v136, v138
  v_permlane16_swap_b32 v137, v139
  buffer_store_dwordx4 v[136:139], v11, s[16:19], s60 offen sc0 sc1
  s_add_u32 s60, s77, 604160
  v_permlane16_swap_b32 v144, v146
  v_permlane16_swap_b32 v145, v147
  buffer_store_dwordx4 v[144:147], v11, s[16:19], s60 offen sc0 sc1
L_cflag:
  s_mul_i32 s62, s57, 23
  s_add_u32 s62, s62, s58
  s_lshl_b32 s62, s62, 7
  s_lshl_b32 s63, s56, 2
  s_add_u32 s62, s62, s63
  s_add_u32 s62, s62, 0x100000
  s_mov_b32 s71, s62
L_cp2:
  s_and_b32 s60, s2, 6
  s_lshl_b32 s60, s60, 2
  s_lshr_b32 s61, s2, 5
  s_add_u32 s57, s60, s61
  s_and_b32 s60, s2, 1
  s_lshl_b32 s60, s60, 2
  s_bfe_u32 s61, s2, 0x20003
  s_add_u32 s58, s60, s61
  v_and_b32 v11, 15, v1
  v_lshrrev_b32 v12, 4, v1
  v_lshlrev_b32 v11, 10, v11
  v_lshl_add_u32 v9, v12, 3, v11
  s_lshl_b32 s60, s57, 2
  s_add_u32 s60, s60, s56
  s_lshl_b32 s60, s60, 14
  s_lshl_b32 s61, s58, 7
  s_add_u32 s69, s60, s61
  v_and_b32 v13, 1, v12
  v_lshl_add_u32 v13, v13, 5, v11
  v_lshrrev_b32 v12, 1, v12
  v_lshl_add_u32 v8, v12, 4, v13
  buffer_load_dwordx2 v[80:81], v9, s[4:7], s69 offen offset:0
  buffer_load_dwordx2 v[82:83], v9, s[4:7], s69 offen offset:32
  buffer_load_dwordx2 v[84:85], v9, s[4:7], s69 offen offset:64
  buffer_load_dwordx2 v[86:87], v9, s[4:7], s69 offen offset:96
  s_and_b32 s75, s58, 1
  s_mul_i32 s76, s56, 15
  s_lshl_b32 s77, s58, 7
  s_lshl_b32 s78, s75, 1
  s_add_u32 s61, s76, s78
  s_cmp_lt_u32 s61, 16
  s_cselect_b32 s20, s40, s48
  s_cselect_b32 s21, s41, s49
  s_mov_b32 s60, 0x80000
  s_cselect_b32 s22, s60, 0x158000
  s_mov_b32 s23, 0x20000
  s_cselect_b32 s60, 0, 16
  s_sub_u32 s61, s61, s60
  s_lshl_b32 s61, s61, 15
  s_add_u32 s64, s61, s77
  s_add_u32 s61, s76, 2
  s_sub_u32 s61, s61, s78
  s_cmp_lt_u32 s61, 16
  s_cselect_b32 s12, s40, s48
  s_cselect_b32 s13, s41, s49
  s_mov_b32 s60, 0x80000
  s_cselect_b32 s14, s60, 0x158000
  s_mov_b32 s15, 0x20000
  s_cselect_b32 s60, 0, 16
  s_sub_u32 s61, s61, s60
  s_lshl_b32 s61, s61, 15
  s_add_u32 s65, s61, s77
  s_add_u32 s61, s76, 1
  s_cmp_lt_u32 s61, 16
  s_cselect_b32 s24, s40, s48
  s_cselect_b32 s25, s41, s49
  s_mov_b32 s60, 0x80000
  s_cselect_b32 s26, s60, 0x158000
  s_mov_b32 s27, 0x20000
  s_cselect_b32 s60, 0, 16
  s_sub_u32 s61, s61, s60
  s_lshl_b32 s61, s61, 15
  s_add_u32 s72, s61, s77
  s_sub_u32 s72, s72, 0x8000
  s_lshl_b32 s60, s75, 16
  s_sub_u32 s73, s72, s60
  s_add_u32 s72, s72, s60
  s_sub_u32 s84, s72, s60
  s_mul_i32 s66, s56, 12288
  v_lshrrev_b32 v11, 3, v1
  v_lshrrev_b32 v12, 2, v11
  v_and_b32 v11, 3, v11
  v_lshl_add_u32 v11, v12, 3, v11
  v_lshrrev_b32 v12, 4, v1
  v_lshlrev_b32 v13, 1, v12
  v_and_b32 v14, 7, v1
  v_xor_b32 v14, v14, v13
  v_lshlrev_b32 v14, 4, v14
  v_lshl_add_u32 v2, v11, 10, v14
  v_lshrrev_b32 v12, 4, v1
  v_bfe_u32 v13, v1, 2, 2
  v_and_b32 v14, 3, v1
  v_and_b32 v15, 1, v12
  v_lshrrev_b32 v12, 1, v12
  v_lshl_add_u32 v15, v15, 2, v13
  v_lshrrev_b32 v13, 1, v15
  v_lshlrev_b32 v13, 5, v13
  v_lshl_add_u32 v13, v15, 7, v13
  v_lshl_add_u32 v13, v14, 3, v13
  v_lshl_add_u32 v13, v12, 11, v13
  v_add_u32 v3, s66, v13
  v_xor_b32 v10, 32, v3
  v_xor_b32 v14, 64, v3
  v_xor_b32 v15, 0x60, v3
  v_mov_b32 v12, 155664
  ds_read_b32 v12, v12
  v_lshlrev_b32 v11, 4, v1
  s_add_u32 s60, s56, 0
  s_and_b32 s60, s60, 3
  s_mul_i32 s60, s60, 60416
  v_add_u32 v4, s60, v11
  s_add_u32 s60, s56, 1
  s_and_b32 s60, s60, 3
  s_mul_i32 s60, s60, 60416
  v_add_u32 v5, s60, v11
  s_add_u32 s60, s56, 2
  s_and_b32 s60, s60, 3
  s_mul_i32 s60, s60, 60416
  v_add_u32 v6, s60, v11
  s_add_u32 s60, s56, 3
  s_and_b32 s60, s60, 3
  s_mul_i32 s60, s60, 60416
  v_add_u32 v7, s60, v11
  s_mul_i32 s60, s57, 241664
  s_mul_i32 s61, s56, 15360
  s_add_u32 s67, s60, s61
  s_add_u32 s60, s67, 14336
  s_cmp_eq_u32 s56, 3
  s_cselect_b32 s68, 0x7f000000, s60
  s_mov_b32 s70, s67
  s_lshl_b32 s60, s75, 11
  s_sub_u32 s74, s70, s60
  s_add_u32 s67, s70, s60
  s_mov_b32 s8, s50
  s_mov_b32 s9, s51
  s_mov_b32 s10, 0x200000
  s_mov_b32 s11, 0x20000
  s_waitcnt lgkmcnt(0)
  v_readfirstlane_b32 s3, v12
  s_waitcnt vmcnt(4)
  s_nop 0
  v_mov_b32 v11, s3
  v_mov_b32 v12, 0
  s_mov_b64 exec, 1
  buffer_store_dword v11, v12, s[28:31], s71 offen sc0 sc1
  s_mov_b64 exec, -1
  s_barrier
  v_add_u32 v3, 102400, v3
  v_add_u32 v10, 102400, v10
  v_add_u32 v14, 102400, v14
  v_add_u32 v15, 102400, v15
  ds_read_b64_tr_b16 v[96:97], v3 offset:0
  ds_read_b64_tr_b16 v[98:99], v3 offset:1024
  ds_read_b64_tr_b16 v[100:101], v10 offset:0
  ds_read_b64_tr_b16 v[102:103], v10 offset:1024
  ds_read_b64_tr_b16 v[104:105], v14 offset:0
  ds_read_b64_tr_b16 v[106:107], v14 offset:1024
  ds_read_b64_tr_b16 v[108:109], v15 offset:0
  ds_read_b64_tr_b16 v[110:111], v15 offset:1024
  ds_read_b64_tr_b16 v[112:113], v3 offset:4096
  ds_read_b64_tr_b16 v[114:115], v3 offset:5120
  ds_read_b64_tr_b16 v[116:117], v10 offset:4096
  ds_read_b64_tr_b16 v[118:119], v10 offset:5120
  ds_read_b64_tr_b16 v[120:121], v14 offset:4096
  ds_read_b64_tr_b16 v[122:123], v14 offset:5120
  ds_read_b64_tr_b16 v[124:125], v15 offset:4096
  ds_read_b64_tr_b16 v[126:127], v15 offset:5120
  ds_read_b64_tr_b16 v[192:193], v3 offset:8192
  ds_read_b64_tr_b16 v[194:195], v3 offset:9216
  ds_read_b64_tr_b16 v[196:197], v10 offset:8192
  ds_read_b64_tr_b16 v[198:199], v10 offset:9216
  ds_read_b64_tr_b16 v[200:201], v14 offset:8192
  ds_read_b64_tr_b16 v[202:203], v14 offset:9216
  ds_read_b64_tr_b16 v[204:205], v15 offset:8192
  ds_read_b64_tr_b16 v[206:207], v15 offset:9216
  s_waitcnt lgkmcnt(0)
  s_add_u32 m0, s66, 102400
  s_add_u32 s60, s72, 294912
  buffer_load_dwordx4 v2, s[24:27], s60 offen offset:0 lds
  s_add_u32 s60, s72, 297984
  buffer_load_dwordx4 v2, s[24:27], s60 offen offset:1024 lds
  s_add_u32 s60, s72, 309248
  buffer_load_dwordx4 v2, s[24:27], s60 offen offset:2048 lds
  s_add_u32 s60, s72, 312320
  buffer_load_dwordx4 v2, s[24:27], s60 offen offset:3072 lds
  s_add_u32 m0, s66, 106496
  s_add_u32 s60, s73, 327680
  buffer_load_dwordx4 v2, s[24:27], s60 offen offset:0 lds
  s_add_u32 s60, s73, 330752
  buffer_load_dwordx4 v2, s[24:27], s60 offen offset:1024 lds
  s_add_u32 s60, s73, 342016
  buffer_load_dwordx4 v2, s[24:27], s60 offen offset:2048 lds
  s_add_u32 s60, s73, 345088
  buffer_load_dwordx4 v2, s[24:27], s60 offen offset:3072 lds
  s_add_u32 m0, s66, 110592
  s_add_u32 s60, s73, 360448
  buffer_load_dwordx4 v2, s[24:27], s60 offen offset:0 lds
  s_add_u32 s60, s73, 363520
  buffer_load_dwordx4 v2, s[24:27], s60 offen offset:1024 lds
  s_add_u32 s60, s73, 374784
  buffer_load_dwordx4 v2, s[24:27], s60 offen offset:2048 lds
  s_add_u32 s60, s73, 377856
  buffer_load_dwordx4 v2, s[24:27], s60 offen offset:3072 lds
  v_subrev_u32 v3, 102400, v3
  v_subrev_u32 v10, 102400, v10
  v_subrev_u32 v14, 102400, v14
  v_subrev_u32 v15, 102400, v15
  ds_read_b64_tr_b16 v[208:209], v3 offset:0
  ds_read_b64_tr_b16 v[210:211], v3 offset:1024
  ds_read_b64_tr_b16 v[212:213], v10 offset:0
  ds_read_b64_tr_b16 v[214:215], v10 offset:1024
  ds_read_b64_tr_b16 v[216:217], v14 offset:0
  ds_read_b64_tr_b16 v[218:219], v14 offset:1024
  ds_read_b64_tr_b16 v[220:221], v15 offset:0
  ds_read_b64_tr_b16 v[222:223], v15 offset:1024
  ds_read_b64_tr_b16 v[224:225], v3 offset:4096
  ds_read_b64_tr_b16 v[226:227], v3 offset:5120
  ds_read_b64_tr_b16 v[228:229], v10 offset:4096
  ds_read_b64_tr_b16 v[230:231], v10 offset:5120
  ds_read_b64_tr_b16 v[232:233], v14 offset:4096
  ds_read_b64_tr_b16 v[234:235], v14 offset:5120
  ds_read_b64_tr_b16 v[236:237], v15 offset:4096
  ds_read_b64_tr_b16 v[238:239], v15 offset:5120
  ds_read_b64_tr_b16 v[240:241], v3 offset:8192
  ds_read_b64_tr_b16 v[242:243], v3 offset:9216
  ds_read_b64_tr_b16 v[244:245], v10 offset:8192
  ds_read_b64_tr_b16 v[246:247], v10 offset:9216
  ds_read_b64_tr_b16 v[248:249], v14 offset:8192
  ds_read_b64_tr_b16 v[250:251], v14 offset:9216
  ds_read_b64_tr_b16 v[252:253], v15 offset:8192
  ds_read_b64_tr_b16 v[254:255], v15 offset:9216
  s_waitcnt lgkmcnt(0)
  s_add_u32 m0, s66, 0
  s_add_u32 s60, s84, 393216
  buffer_load_dwordx4 v2, s[24:27], s60 offen offset:0 lds
  s_add_u32 s60, s84, 396288
  buffer_load_dwordx4 v2, s[24:27], s60 offen offset:1024 lds
  s_add_u32 s60, s84, 407552
  buffer_load_dwordx4 v2, s[24:27], s60 offen offset:2048 lds
  s_add_u32 s60, s84, 410624
  buffer_load_dwordx4 v2, s[24:27], s60 offen offset:3072 lds
  s_add_u32 m0, s66, 4096
  s_add_u32 s60, s84, 425984
  buffer_load_dwordx4 v2, s[24:27], s60 offen offset:0 lds
  s_add_u32 s60, s84, 429056
  buffer_load_dwordx4 v2, s[24:27], s60 offen offset:1024 lds
  s_add_u32 s60, s84, 440320
  buffer_load_dwordx4 v2, s[24:27], s60 offen offset:2048 lds
  s_add_u32 s60, s84, 443392
  buffer_load_dwordx4 v2, s[24:27], s60 offen offset:3072 lds
  s_add_u32 m0, s66, 8192
  s_add_u32 s60, s84, 458752
  buffer_load_dwordx4 v2, s[24:27], s60 offen offset:0 lds
  s_add_u32 s60, s84, 461824
  buffer_load_dwordx4 v2, s[24:27], s60 offen offset:1024 lds
  s_add_u32 s60, s84, 473088
  buffer_load_dwordx4 v2, s[24:27], s60 offen offset:2048 lds
  s_add_u32 s60, s84, 476160
  buffer_load_dwordx4 v2, s[24:27], s60 offen offset:3072 lds
  s_mul_i32 s60, s57, 21846
  s_lshr_b32 s60, s60, 16
  s_mul_i32 s60, s60, 23
  s_mul_i32 s61, s56, 5
  s_add_u32 s61, s61, 2
  s_cmp_eq_u32 s56, 0
  s_cselect_b32 s61, 0, s61
  s_cselect_b32 s62, 7, 5
  s_add_u32 s60, s60, s61
  s_lshl_b32 s60, s60, 7
  s_add_u32 s63, s60, 0x100000
  v_min_u32 v11, s62, v1
  v_lshlrev_b32 v11, 7, v11
  s_mov_b32 s61, 0
L_fspin:
  buffer_load_dwordx4 v[48:51], v11, s[28:31], s63 offen sc1
  s_add_u32 s61, s61, 1
  s_waitcnt vmcnt(0)
  v_xor_b32 v48, s3, v48
  v_xor_b32 v49, s3, v49
  v_xor_b32 v50, s3, v50
  v_xor_b32 v51, s3, v51
  v_or_b32 v48, v48, v49
  v_or3_b32 v48, v48, v50, v51
  v_cmp_ne_u32 vcc, 0, v48
  s_cmp_ge_u32 s61, 40000
  s_cbranch_scc1 L_fok
  s_nop 2
  s_cbranch_vccz L_fok
  s_branch L_fspin
L_fok:
  s_add_u32 s61, s67, 0
  buffer_load_dwordx4 v[16:19], v4, s[16:19], s61 offen sc1
  buffer_load_dwordx4 v[20:23], v5, s[16:19], s61 offen sc1
  buffer_load_dwordx4 v[24:27], v6, s[16:19], s61 offen sc1
  buffer_load_dwordx4 v[28:31], v7, s[16:19], s61 offen sc1
  s_add_u32 s61, s67, 1024
  buffer_load_dwordx4 v[32:35], v4, s[16:19], s61 offen sc1
  buffer_load_dwordx4 v[36:39], v5, s[16:19], s61 offen sc1
  buffer_load_dwordx4 v[40:43], v6, s[16:19], s61 offen sc1
  buffer_load_dwordx4 v[44:47], v7, s[16:19], s61 offen sc1
  s_add_u32 s61, s74, 2048
  buffer_load_dwordx4 v[48:51], v4, s[16:19], s61 offen sc1
  buffer_load_dwordx4 v[52:55], v5, s[16:19], s61 offen sc1
  buffer_load_dwordx4 v[56:59], v6, s[16:19], s61 offen sc1
  buffer_load_dwordx4 v[60:63], v7, s[16:19], s61 offen sc1
  s_waitcnt vmcnt(11)
  v_mfma_f32_16x16x32_bf16 v[128:131], v[96:99], v[16:19], 0
  s_add_u32 s61, s74, 3072
  buffer_load_dwordx4 v[64:67], v4, s[16:19], s61 offen sc1
  v_mfma_f32_16x16x32_bf16 v[132:135], v[100:103], v[16:19], 0
  v_mfma_f32_16x16x32_bf16 v[136:139], v[104:107], v[16:19], 0
  v_mfma_f32_16x16x32_bf16 v[140:143], v[108:111], v[16:19], 0
  s_waitcnt vmcnt(11)
  v_mfma_f32_16x16x32_bf16 v[144:147], v[96:99], v[20:23], 0
  buffer_load_dwordx4 v[68:71], v5, s[16:19], s61 offen sc1
  v_mfma_f32_16x16x32_bf16 v[148:151], v[100:103], v[20:23], 0
  v_mfma_f32_16x16x32_bf16 v[152:155], v[104:107], v[20:23], 0
  v_mfma_f32_16x16x32_bf16 v[156:159], v[108:111], v[20:23], 0
  s_waitcnt vmcnt(11)
  v_mfma_f32_16x16x32_bf16 v[160:163], v[96:99], v[24:27], 0
  buffer_load_dwordx4 v[72:75], v6, s[16:19], s61 offen sc1
  v_mfma_f32_16x16x32_bf16 v[164:167], v[100:103], v[24:27], 0
  v_mfma_f32_16x16x32_bf16 v[168:171], v[104:107], v[24:27], 0
  v_mfma_f32_16x16x32_bf16 v[172:175], v[108:111], v[24:27], 0
  s_waitcnt vmcnt(11)
  v_mfma_f32_16x16x32_bf16 v[176:179], v[96:99], v[28:31], 0
  buffer_load_dwordx4 v[76:79], v7, s[16:19], s61 offen sc1
  v_mfma_f32_16x16x32_bf16 v[180:183], v[100:103], v[28:31], 0
  v_mfma_f32_16x16x32_bf16 v[184:187], v[104:107], v[28:31], 0
  v_mfma_f32_16x16x32_bf16 v[188:191], v[108:111], v[28:31], 0
  s_waitcnt vmcnt(11)
  v_mfma_f32_16x16x32_bf16 v[128:131], v[112:115], v[32:35], v[128:131]
  s_add_u32 s61, s67, 4096
  buffer_load_dwordx4 v[16:19], v4, s[16:19], s61 offen sc1
  v_mfma_f32_16x16x32_bf16 v[132:135], v[116:119], v[32:35], v[132:135]
  v_mfma_f32_16x16x32_bf16 v[136:139], v[120:123], v[32:35], v[136:139]
  v_mfma_f32_16x16x32_bf16 v[140:143], v[124:127], v[32:35], v[140:143]
  s_waitcnt vmcnt(11)
  v_mfma_f32_16x16x32_bf16 v[144:147], v[112:115], v[36:39], v[144:147]
  buffer_load_dwordx4 v[20:23], v5, s[16:19], s61 offen sc1
  v_mfma_f32_16x16x32_bf16 v[148:151], v[116:119], v[36:39], v[148:151]
  v_mfma_f32_16x16x32_bf16 v[152:155], v[120:123], v[36:39], v[152:155]
  v_mfma_f32_16x16x32_bf16 v[156:159], v[124:127], v[36:39], v[156:159]
  s_waitcnt vmcnt(11)
  v_mfma_f32_16x16x32_bf16 v[160:163], v[112:115], v[40:43], v[160:163]
  buffer_load_dwordx4 v[24:27], v6, s[16:19], s61 offen sc1
  v_mfma_f32_16x16x32_bf16 v[164:167], v[116:119], v[40:43], v[164:167]
  v_mfma_f32_16x16x32_bf16 v[168:171], v[120:123], v[40:43], v[168:171]
  v_mfma_f32_16x16x32_bf16 v[172:175], v[124:127], v[40:43], v[172:175]
  s_waitcnt vmcnt(11)
  v_mfma_f32_16x16x32_bf16 v[176:179], v[112:115], v[44:47], v[176:179]
  buffer_load_dwordx4 v[28:31], v7, s[16:19], s61 offen sc1
  v_mfma_f32_16x16x32_bf16 v[180:183], v[116:119], v[44:47], v[180:183]
  v_mfma_f32_16x16x32_bf16 v[184:187], v[120:123], v[44:47], v[184:187]
  v_mfma_f32_16x16x32_bf16 v[188:191], v[124:127], v[44:47], v[188:191]
  s_waitcnt vmcnt(11)
  v_mfma_f32_16x16x32_bf16 v[128:131], v[192:195], v[48:51], v[128:131]
  s_add_u32 s61, s67, 5120
  buffer_load_dwordx4 v[32:35], v4, s[16:19], s61 offen sc1
  v_mfma_f32_16x16x32_bf16 v[132:135], v[196:199], v[48:51], v[132:135]
  v_mfma_f32_16x16x32_bf16 v[136:139], v[200:203], v[48:51], v[136:139]
  v_mfma_f32_16x16x32_bf16 v[140:143], v[204:207], v[48:51], v[140:143]
  s_waitcnt vmcnt(11)
  v_mfma_f32_16x16x32_bf16 v[144:147], v[192:195], v[52:55], v[144:147]
  buffer_load_dwordx4 v[36:39], v5, s[16:19], s61 offen sc1
  v_mfma_f32_16x16x32_bf16 v[148:151], v[196:199], v[52:55], v[148:151]
  v_mfma_f32_16x16x32_bf16 v[152:155], v[200:203], v[52:55], v[152:155]
  v_mfma_f32_16x16x32_bf16 v[156:159], v[204:207], v[52:55], v[156:159]
  s_waitcnt vmcnt(11)
  v_mfma_f32_16x16x32_bf16 v[160:163], v[192:195], v[56:59], v[160:163]
  buffer_load_dwordx4 v[40:43], v6, s[16:19], s61 offen sc1
  v_mfma_f32_16x16x32_bf16 v[164:167], v[196:199], v[56:59], v[164:167]
  v_mfma_f32_16x16x32_bf16 v[168:171], v[200:203], v[56:59], v[168:171]
  v_mfma_f32_16x16x32_bf16 v[172:175], v[204:207], v[56:59], v[172:175]
  s_waitcnt vmcnt(11)
  v_mfma_f32_16x16x32_bf16 v[176:179], v[192:195], v[60:63], v[176:179]
  buffer_load_dwordx4 v[44:47], v7, s[16:19], s61 offen sc1
  v_mfma_f32_16x16x32_bf16 v[180:183], v[196:199], v[60:63], v[180:183]
  v_mfma_f32_16x16x32_bf16 v[184:187], v[200:203], v[60:63], v[184:187]
  v_mfma_f32_16x16x32_bf16 v[188:191], v[204:207], v[60:63], v[188:191]
  s_waitcnt vmcnt(11)
  v_mfma_f32_16x16x32_bf16 v[128:131], v[208:211], v[64:67], v[128:131]
  s_add_u32 s61, s74, 6144
  buffer_load_dwordx4 v[96:99], v4, s[16:19], s61 offen sc1
  v_mfma_f32_16x16x32_bf16 v[132:135], v[212:215], v[64:67], v[132:135]
  v_mfma_f32_16x16x32_bf16 v[136:139], v[216:219], v[64:67], v[136:139]
  v_mfma_f32_16x16x32_bf16 v[140:143], v[220:223], v[64:67], v[140:143]
  s_waitcnt vmcnt(11)
  v_mfma_f32_16x16x32_bf16 v[144:147], v[208:211], v[68:71], v[144:147]
  buffer_load_dwordx4 v[100:103], v5, s[16:19], s61 offen sc1
  v_mfma_f32_16x16x32_bf16 v[148:151], v[212:215], v[68:71], v[148:151]
  v_mfma_f32_16x16x32_bf16 v[152:155], v[216:219], v[68:71], v[152:155]
  v_mfma_f32_16x16x32_bf16 v[156:159], v[220:223], v[68:71], v[156:159]
  s_waitcnt vmcnt(11)
  v_mfma_f32_16x16x32_bf16 v[160:163], v[208:211], v[72:75], v[160:163]
  buffer_load_dwordx4 v[104:107], v6, s[16:19], s61 offen sc1
  v_mfma_f32_16x16x32_bf16 v[164:167], v[212:215], v[72:75], v[164:167]
  v_mfma_f32_16x16x32_bf16 v[168:171], v[216:219], v[72:75], v[168:171]
  v_mfma_f32_16x16x32_bf16 v[172:175], v[220:223], v[72:75], v[172:175]
  s_waitcnt vmcnt(11)
  v_mfma_f32_16x16x32_bf16 v[176:179], v[208:211], v[76:79], v[176:179]
  buffer_load_dwordx4 v[108:111], v7, s[16:19], s61 offen sc1
  v_mfma_f32_16x16x32_bf16 v[180:183], v[212:215], v[76:79], v[180:183]
  v_mfma_f32_16x16x32_bf16 v[184:187], v[216:219], v[76:79], v[184:187]
  v_mfma_f32_16x16x32_bf16 v[188:191], v[220:223], v[76:79], v[188:191]
  s_waitcnt vmcnt(11)
  v_mfma_f32_16x16x32_bf16 v[128:131], v[224:227], v[16:19], v[128:131]
  s_add_u32 s61, s74, 7168
  buffer_load_dwordx4 v[112:115], v4, s[16:19], s61 offen sc1
  v_mfma_f32_16x16x32_bf16 v[132:135], v[228:231], v[16:19], v[132:135]
  v_mfma_f32_16x16x32_bf16 v[136:139], v[232:235], v[16:19], v[136:139]
  v_mfma_f32_16x16x32_bf16 v[140:143], v[236:239], v[16:19], v[140:143]
  s_waitcnt vmcnt(11)
  v_mfma_f32_16x16x32_bf16 v[144:147], v[224:227], v[20:23], v[144:147]
  buffer_load_dwordx4 v[116:119], v5, s[16:19], s61 offen sc1
  v_mfma_f32_16x16x32_bf16 v[148:151], v[228:231], v[20:23], v[148:151]
  v_mfma_f32_16x16x32_bf16 v[152:155], v[232:235], v[20:23], v[152:155]
  v_mfma_f32_16x16x32_bf16 v[156:159], v[236:239], v[20:23], v[156:159]
  s_waitcnt vmcnt(11)
  v_mfma_f32_16x16x32_bf16 v[160:163], v[224:227], v[24:27], v[160:163]
  buffer_load_dwordx4 v[120:123], v6, s[16:19], s61 offen sc1
  v_mfma_f32_16x16x32_bf16 v[164:167], v[228:231], v[24:27], v[164:167]
  v_mfma_f32_16x16x32_bf16 v[168:171], v[232:235], v[24:27], v[168:171]
  v_mfma_f32_16x16x32_bf16 v[172:175], v[236:239], v[24:27], v[172:175]
  s_waitcnt vmcnt(11)
  v_mfma_f32_16x16x32_bf16 v[176:179], v[224:227], v[28:31], v[176:179]
  buffer_load_dwordx4 v[124:127], v7, s[16:19], s61 offen sc1
  v_mfma_f32_16x16x32_bf16 v[180:183], v[228:231], v[28:31], v[180:183]
  v_mfma_f32_16x16x32_bf16 v[184:187], v[232:235], v[28:31], v[184:187]
  v_mfma_f32_16x16x32_bf16 v[188:191], v[236:239], v[28:31], v[188:191]
  s_waitcnt vmcnt(11)
  v_mfma_f32_16x16x32_bf16 v[128:131], v[240:243], v[32:35], v[128:131]
  s_add_u32 s61, s67, 8192
  buffer_load_dwordx4 v[48:51], v4, s[16:19], s61 offen sc1
  v_mfma_f32_16x16x32_bf16 v[132:135], v[244:247], v[32:35], v[132:135]
  ds_read_b64_tr_b16 v[16:17], v3 offset:51200
  v_mfma_f32_16x16x32_bf16 v[136:139], v[248:251], v[32:35], v[136:139]
  ds_read_b64_tr_b16 v[18:19], v3 offset:52224
  v_mfma_f32_16x16x32_bf16 v[140:143], v[252:255], v[32:35], v[140:143]
  ds_read_b64_tr_b16 v[20:21], v10 offset:51200
  s_waitcnt vmcnt(11)
  v_mfma_f32_16x16x32_bf16 v[144:147], v[240:243], v[36:39], v[144:147]
  buffer_load_dwordx4 v[52:55], v5, s[16:19], s61 offen sc1
  v_mfma_f32_16x16x32_bf16 v[148:151], v[244:247], v[36:39], v[148:151]
  ds_read_b64_tr_b16 v[22:23], v10 offset:52224
  v_mfma_f32_16x16x32_bf16 v[152:155], v[248:251], v[36:39], v[152:155]
  ds_read_b64_tr_b16 v[24:25], v14 offset:51200
  v_mfma_f32_16x16x32_bf16 v[156:159], v[252:255], v[36:39], v[156:159]
  ds_read_b64_tr_b16 v[26:27], v14 offset:52224
  s_waitcnt vmcnt(11)
  v_mfma_f32_16x16x32_bf16 v[160:163], v[240:243], v[40:43], v[160:163]
  buffer_load_dwordx4 v[56:59], v6, s[16:19], s61 offen sc1
  v_mfma_f32_16x16x32_bf16 v[164:167], v[244:247], v[40:43], v[164:167]
  ds_read_b64_tr_b16 v[28:29], v15 offset:51200
  v_mfma_f32_16x16x32_bf16 v[168:171], v[248:251], v[40:43], v[168:171]
  ds_read_b64_tr_b16 v[30:31], v15 offset:52224
  v_mfma_f32_16x16x32_bf16 v[172:175], v[252:255], v[40:43], v[172:175]
  s_waitcnt vmcnt(11)
  v_mfma_f32_16x16x32_bf16 v[176:179], v[240:243], v[44:47], v[176:179]
  buffer_load_dwordx4 v[60:63], v7, s[16:19], s61 offen sc1
  v_mfma_f32_16x16x32_bf16 v[180:183], v[244:247], v[44:47], v[180:183]
  v_mfma_f32_16x16x32_bf16 v[184:187], v[248:251], v[44:47], v[184:187]
  v_mfma_f32_16x16x32_bf16 v[188:191], v[252:255], v[44:47], v[188:191]
  s_waitcnt vmcnt(11) lgkmcnt(6)
  v_mfma_f32_16x16x32_bf16 v[128:131], v[16:19], v[96:99], v[128:131]
  s_add_u32 s61, s67, 9216
  buffer_load_dwordx4 v[192:195], v4, s[16:19], s61 offen sc1
  s_waitcnt lgkmcnt(4)
  v_mfma_f32_16x16x32_bf16 v[132:135], v[20:23], v[96:99], v[132:135]
  ds_read_b64_tr_b16 v[32:33], v3 offset:55296
  s_waitcnt lgkmcnt(3)
  v_mfma_f32_16x16x32_bf16 v[136:139], v[24:27], v[96:99], v[136:139]
  ds_read_b64_tr_b16 v[34:35], v3 offset:56320
  s_waitcnt lgkmcnt(2)
  v_mfma_f32_16x16x32_bf16 v[140:143], v[28:31], v[96:99], v[140:143]
  ds_read_b64_tr_b16 v[36:37], v10 offset:55296
  s_waitcnt vmcnt(11)
  v_mfma_f32_16x16x32_bf16 v[144:147], v[16:19], v[100:103], v[144:147]
  buffer_load_dwordx4 v[196:199], v5, s[16:19], s61 offen sc1
  v_mfma_f32_16x16x32_bf16 v[148:151], v[20:23], v[100:103], v[148:151]
  ds_read_b64_tr_b16 v[38:39], v10 offset:56320
  v_mfma_f32_16x16x32_bf16 v[152:155], v[24:27], v[100:103], v[152:155]
  ds_read_b64_tr_b16 v[40:41], v14 offset:55296
  v_mfma_f32_16x16x32_bf16 v[156:159], v[28:31], v[100:103], v[156:159]
  ds_read_b64_tr_b16 v[42:43], v14 offset:56320
  s_waitcnt vmcnt(11)
  v_mfma_f32_16x16x32_bf16 v[160:163], v[16:19], v[104:107], v[160:163]
  buffer_load_dwordx4 v[200:203], v6, s[16:19], s61 offen sc1
  v_mfma_f32_16x16x32_bf16 v[164:167], v[20:23], v[104:107], v[164:167]
  ds_read_b64_tr_b16 v[44:45], v15 offset:55296
  v_mfma_f32_16x16x32_bf16 v[168:171], v[24:27], v[104:107], v[168:171]
  ds_read_b64_tr_b16 v[46:47], v15 offset:56320
  v_mfma_f32_16x16x32_bf16 v[172:175], v[28:31], v[104:107], v[172:175]
  s_waitcnt vmcnt(11)
  v_mfma_f32_16x16x32_bf16 v[176:179], v[16:19], v[108:111], v[176:179]
  buffer_load_dwordx4 v[204:207], v7, s[16:19], s61 offen sc1
  v_mfma_f32_16x16x32_bf16 v[180:183], v[20:23], v[108:111], v[180:183]
  v_mfma_f32_16x16x32_bf16 v[184:187], v[24:27], v[108:111], v[184:187]
  v_mfma_f32_16x16x32_bf16 v[188:191], v[28:31], v[108:111], v[188:191]
  s_waitcnt vmcnt(11) lgkmcnt(6)
  v_mfma_f32_16x16x32_bf16 v[128:131], v[32:35], v[112:115], v[128:131]
  s_add_u32 s61, s74, 10240
  buffer_load_dwordx4 v[64:67], v4, s[16:19], s61 offen sc1
  s_waitcnt lgkmcnt(4)
  v_mfma_f32_16x16x32_bf16 v[132:135], v[36:39], v[112:115], v[132:135]
  ds_read_b64_tr_b16 v[16:17], v3 offset:59392
  s_waitcnt lgkmcnt(3)
  v_mfma_f32_16x16x32_bf16 v[136:139], v[40:43], v[112:115], v[136:139]
  ds_read_b64_tr_b16 v[18:19], v3 offset:60416
  s_waitcnt lgkmcnt(2)
  v_mfma_f32_16x16x32_bf16 v[140:143], v[44:47], v[112:115], v[140:143]
  ds_read_b64_tr_b16 v[20:21], v10 offset:59392
  s_waitcnt vmcnt(11)
  v_mfma_f32_16x16x32_bf16 v[144:147], v[32:35], v[116:119], v[144:147]
  buffer_load_dwordx4 v[68:71], v5, s[16:19], s61 offen sc1
  v_mfma_f32_16x16x32_bf16 v[148:151], v[36:39], v[116:119], v[148:151]
  ds_read_b64_tr_b16 v[22:23], v10 offset:60416
  v_mfma_f32_16x16x32_bf16 v[152:155], v[40:43], v[116:119], v[152:155]
  ds_read_b64_tr_b16 v[24:25], v14 offset:59392
  v_mfma_f32_16x16x32_bf16 v[156:159], v[44:47], v[116:119], v[156:159]
  ds_read_b64_tr_b16 v[26:27], v14 offset:60416
  s_waitcnt vmcnt(11)
  v_mfma_f32_16x16x32_bf16 v[160:163], v[32:35], v[120:123], v[160:163]
  buffer_load_dwordx4 v[72:75], v6, s[16:19], s61 offen sc1
  v_mfma_f32_16x16x32_bf16 v[164:167], v[36:39], v[120:123], v[164:167]
  ds_read_b64_tr_b16 v[28:29], v15 offset:59392
  v_mfma_f32_16x16x32_bf16 v[168:171], v[40:43], v[120:123], v[168:171]
  ds_read_b64_tr_b16 v[30:31], v15 offset:60416
  v_mfma_f32_16x16x32_bf16 v[172:175], v[44:47], v[120:123], v[172:175]
  s_waitcnt vmcnt(11)
  v_mfma_f32_16x16x32_bf16 v[176:179], v[32:35], v[124:127], v[176:179]
  buffer_load_dwordx4 v[76:79], v7, s[16:19], s61 offen sc1
  v_mfma_f32_16x16x32_bf16 v[180:183], v[36:39], v[124:127], v[180:183]
  v_mfma_f32_16x16x32_bf16 v[184:187], v[40:43], v[124:127], v[184:187]
  v_mfma_f32_16x16x32_bf16 v[188:191], v[44:47], v[124:127], v[188:191]
  s_waitcnt vmcnt(11) lgkmcnt(6)
  v_mfma_f32_16x16x32_bf16 v[128:131], v[16:19], v[48:51], v[128:131]
  s_add_u32 s61, s74, 11264
  buffer_load_dwordx4 v[208:211], v4, s[16:19], s61 offen sc1
  v_add_u32 v3, 102400, v3
  v_add_u32 v10, 102400, v10
  v_add_u32 v14, 102400, v14
  v_add_u32 v15, 102400, v15
  s_waitcnt lgkmcnt(4)
  v_mfma_f32_16x16x32_bf16 v[132:135], v[20:23], v[48:51], v[132:135]
  ds_read_b64_tr_b16 v[32:33], v3 offset:0
  s_waitcnt lgkmcnt(3)
  v_mfma_f32_16x16x32_bf16 v[136:139], v[24:27], v[48:51], v[136:139]
  ds_read_b64_tr_b16 v[34:35], v3 offset:1024
  s_waitcnt lgkmcnt(2)
  v_mfma_f32_16x16x32_bf16 v[140:143], v[28:31], v[48:51], v[140:143]
  ds_read_b64_tr_b16 v[36:37], v10 offset:0
  s_waitcnt vmcnt(11)
  v_mfma_f32_16x16x32_bf16 v[144:147], v[16:19], v[52:55], v[144:147]
  buffer_load_dwordx4 v[212:215], v5, s[16:19], s61 offen sc1
  v_mfma_f32_16x16x32_bf16 v[148:151], v[20:23], v[52:55], v[148:151]
  ds_read_b64_tr_b16 v[38:39], v10 offset:1024
  v_mfma_f32_16x16x32_bf16 v[152:155], v[24:27], v[52:55], v[152:155]
  ds_read_b64_tr_b16 v[40:41], v14 offset:0
  v_mfma_f32_16x16x32_bf16 v[156:159], v[28:31], v[52:55], v[156:159]
  ds_read_b64_tr_b16 v[42:43], v14 offset:1024
  s_waitcnt vmcnt(11)
  v_mfma_f32_16x16x32_bf16 v[160:163], v[16:19], v[56:59], v[160:163]
  buffer_load_dwordx4 v[216:219], v6, s[16:19], s61 offen sc1
  v_mfma_f32_16x16x32_bf16 v[164:167], v[20:23], v[56:59], v[164:167]
  ds_read_b64_tr_b16 v[44:45], v15 offset:0
  v_mfma_f32_16x16x32_bf16 v[168:171], v[24:27], v[56:59], v[168:171]
  ds_read_b64_tr_b16 v[46:47], v15 offset:1024
  v_mfma_f32_16x16x32_bf16 v[172:175], v[28:31], v[56:59], v[172:175]
  s_waitcnt vmcnt(11)
  v_mfma_f32_16x16x32_bf16 v[176:179], v[16:19], v[60:63], v[176:179]
  buffer_load_dwordx4 v[220:223], v7, s[16:19], s61 offen sc1
  v_mfma_f32_16x16x32_bf16 v[180:183], v[20:23], v[60:63], v[180:183]
  v_mfma_f32_16x16x32_bf16 v[184:187], v[24:27], v[60:63], v[184:187]
  v_mfma_f32_16x16x32_bf16 v[188:191], v[28:31], v[60:63], v[188:191]
  s_waitcnt vmcnt(11) lgkmcnt(6)
  v_mfma_f32_16x16x32_bf16 v[128:131], v[32:35], v[192:195], v[128:131]
  s_add_u32 s61, s70, 12288
  buffer_load_dwordx4 v[224:227], v4, s[16:19], s61 offen sc1
  s_waitcnt lgkmcnt(4)
  v_mfma_f32_16x16x32_bf16 v[132:135], v[36:39], v[192:195], v[132:135]
  ds_read_b64_tr_b16 v[16:17], v3 offset:4096
  s_waitcnt lgkmcnt(3)
  v_mfma_f32_16x16x32_bf16 v[136:139], v[40:43], v[192:195], v[136:139]
  ds_read_b64_tr_b16 v[18:19], v3 offset:5120
  s_waitcnt lgkmcnt(2)
  v_mfma_f32_16x16x32_bf16 v[140:143], v[44:47], v[192:195], v[140:143]
  ds_read_b64_tr_b16 v[20:21], v10 offset:4096
  s_waitcnt vmcnt(11)
  v_mfma_f32_16x16x32_bf16 v[144:147], v[32:35], v[196:199], v[144:147]
  buffer_load_dwordx4 v[228:231], v5, s[16:19], s61 offen sc1
  v_mfma_f32_16x16x32_bf16 v[148:151], v[36:39], v[196:199], v[148:151]
  ds_read_b64_tr_b16 v[22:23], v10 offset:5120
  v_mfma_f32_16x16x32_bf16 v[152:155], v[40:43], v[196:199], v[152:155]
  ds_read_b64_tr_b16 v[24:25], v14 offset:4096
  v_mfma_f32_16x16x32_bf16 v[156:159], v[44:47], v[196:199], v[156:159]
  ds_read_b64_tr_b16 v[26:27], v14 offset:5120
  s_waitcnt vmcnt(11)
  v_mfma_f32_16x16x32_bf16 v[160:163], v[32:35], v[200:203], v[160:163]
  buffer_load_dwordx4 v[232:235], v6, s[16:19], s61 offen sc1
  v_mfma_f32_16x16x32_bf16 v[164:167], v[36:39], v[200:203], v[164:167]
  ds_read_b64_tr_b16 v[28:29], v15 offset:4096
  v_mfma_f32_16x16x32_bf16 v[168:171], v[40:43], v[200:203], v[168:171]
  ds_read_b64_tr_b16 v[30:31], v15 offset:5120
  v_mfma_f32_16x16x32_bf16 v[172:175], v[44:47], v[200:203], v[172:175]
  s_waitcnt vmcnt(11)
  v_mfma_f32_16x16x32_bf16 v[176:179], v[32:35], v[204:207], v[176:179]
  buffer_load_dwordx4 v[236:239], v7, s[16:19], s61 offen sc1
  v_mfma_f32_16x16x32_bf16 v[180:183], v[36:39], v[204:207], v[180:183]
  v_mfma_f32_16x16x32_bf16 v[184:187], v[40:43], v[204:207], v[184:187]
  v_mfma_f32_16x16x32_bf16 v[188:191], v[44:47], v[204:207], v[188:191]
  s_waitcnt vmcnt(11) lgkmcnt(6)
  v_mfma_f32_16x16x32_bf16 v[128:131], v[16:19], v[64:67], v[128:131]
  s_add_u32 s61, s70, 13312
  buffer_load_dwordx4 v[240:243], v4, s[16:19], s61 offen sc1
  s_waitcnt lgkmcnt(4)
  v_mfma_f32_16x16x32_bf16 v[132:135], v[20:23], v[64:67], v[132:135]
  ds_read_b64_tr_b16 v[32:33], v3 offset:8192
  s_waitcnt lgkmcnt(3)
  v_mfma_f32_16x16x32_bf16 v[136:139], v[24:27], v[64:67], v[136:139]
  ds_read_b64_tr_b16 v[34:35], v3 offset:9216
  s_waitcnt lgkmcnt(2)
  v_mfma_f32_16x16x32_bf16 v[140:143], v[28:31], v[64:67], v[140:143]
  ds_read_b64_tr_b16 v[36:37], v10 offset:8192
  s_waitcnt vmcnt(11)
  v_mfma_f32_16x16x32_bf16 v[144:147], v[16:19], v[68:71], v[144:147]
  buffer_load_dwordx4 v[244:247], v5, s[16:19], s61 offen sc1
  v_mfma_f32_16x16x32_bf16 v[148:151], v[20:23], v[68:71], v[148:151]
  ds_read_b64_tr_b16 v[38:39], v10 offset:9216
  v_mfma_f32_16x16x32_bf16 v[152:155], v[24:27], v[68:71], v[152:155]
  ds_read_b64_tr_b16 v[40:41], v14 offset:8192
  v_mfma_f32_16x16x32_bf16 v[156:159], v[28:31], v[68:71], v[156:159]
  ds_read_b64_tr_b16 v[42:43], v14 offset:9216
  s_waitcnt vmcnt(11)
  v_mfma_f32_16x16x32_bf16 v[160:163], v[16:19], v[72:75], v[160:163]
  buffer_load_dwordx4 v[248:251], v6, s[16:19], s61 offen sc1
  v_mfma_f32_16x16x32_bf16 v[164:167], v[20:23], v[72:75], v[164:167]
  ds_read_b64_tr_b16 v[44:45], v15 offset:8192
  v_mfma_f32_16x16x32_bf16 v[168:171], v[24:27], v[72:75], v[168:171]
  ds_read_b64_tr_b16 v[46:47], v15 offset:9216
  v_mfma_f32_16x16x32_bf16 v[172:175], v[28:31], v[72:75], v[172:175]
  s_waitcnt vmcnt(11)
  v_mfma_f32_16x16x32_bf16 v[176:179], v[16:19], v[76:79], v[176:179]
  buffer_load_dwordx4 v[252:255], v7, s[16:19], s61 offen sc1
  v_mfma_f32_16x16x32_bf16 v[180:183], v[20:23], v[76:79], v[180:183]
  v_mfma_f32_16x16x32_bf16 v[184:187], v[24:27], v[76:79], v[184:187]
  v_mfma_f32_16x16x32_bf16 v[188:191], v[28:31], v[76:79], v[188:191]
  s_waitcnt vmcnt(11) lgkmcnt(6)
  v_mfma_f32_16x16x32_bf16 v[128:131], v[32:35], v[208:211], v[128:131]
  buffer_load_dwordx4 v[96:99], v4, s[16:19], s68 offen sc1
  v_subrev_u32 v3, 102400, v3
  v_subrev_u32 v10, 102400, v10
  v_subrev_u32 v14, 102400, v14
  v_subrev_u32 v15, 102400, v15
  s_waitcnt lgkmcnt(4)
  v_mfma_f32_16x16x32_bf16 v[132:135], v[36:39], v[208:211], v[132:135]
  ds_read_b64_tr_b16 v[16:17], v3 offset:0
  s_waitcnt lgkmcnt(3)
  v_mfma_f32_16x16x32_bf16 v[136:139], v[40:43], v[208:211], v[136:139]
  ds_read_b64_tr_b16 v[18:19], v3 offset:1024
  s_waitcnt lgkmcnt(2)
  v_mfma_f32_16x16x32_bf16 v[140:143], v[44:47], v[208:211], v[140:143]
  ds_read_b64_tr_b16 v[20:21], v10 offset:0
  s_waitcnt vmcnt(11)
  v_mfma_f32_16x16x32_bf16 v[144:147], v[32:35], v[212:215], v[144:147]
  buffer_load_dwordx4 v[100:103], v5, s[16:19], s68 offen sc1
  v_mfma_f32_16x16x32_bf16 v[148:151], v[36:39], v[212:215], v[148:151]
  ds_read_b64_tr_b16 v[22:23], v10 offset:1024
  v_mfma_f32_16x16x32_bf16 v[152:155], v[40:43], v[212:215], v[152:155]
  ds_read_b64_tr_b16 v[24:25], v14 offset:0
  v_mfma_f32_16x16x32_bf16 v[156:159], v[44:47], v[212:215], v[156:159]
  ds_read_b64_tr_b16 v[26:27], v14 offset:1024
  s_waitcnt vmcnt(11)
  v_mfma_f32_16x16x32_bf16 v[160:163], v[32:35], v[216:219], v[160:163]
  buffer_load_dwordx4 v[104:107], v6, s[16:19], s68 offen sc1
  v_mfma_f32_16x16x32_bf16 v[164:167], v[36:39], v[216:219], v[164:167]
  ds_read_b64_tr_b16 v[28:29], v15 offset:0
  v_mfma_f32_16x16x32_bf16 v[168:171], v[40:43], v[216:219], v[168:171]
  ds_read_b64_tr_b16 v[30:31], v15 offset:1024
  v_mfma_f32_16x16x32_bf16 v[172:175], v[44:47], v[216:219], v[172:175]
  s_waitcnt vmcnt(11)
  v_mfma_f32_16x16x32_bf16 v[176:179], v[32:35], v[220:223], v[176:179]
  buffer_load_dwordx4 v[108:111], v7, s[16:19], s68 offen sc1
  v_mfma_f32_16x16x32_bf16 v[180:183], v[36:39], v[220:223], v[180:183]
  v_mfma_f32_16x16x32_bf16 v[184:187], v[40:43], v[220:223], v[184:187]
  v_mfma_f32_16x16x32_bf16 v[188:191], v[44:47], v[220:223], v[188:191]
  s_waitcnt vmcnt(11) lgkmcnt(6)
  v_mfma_f32_16x16x32_bf16 v[128:131], v[16:19], v[224:227], v[128:131]
  s_waitcnt lgkmcnt(4)
  v_mfma_f32_16x16x32_bf16 v[132:135], v[20:23], v[224:227], v[132:135]
  ds_read_b64_tr_b16 v[32:33], v3 offset:4096
  s_waitcnt lgkmcnt(3)
  v_mfma_f32_16x16x32_bf16 v[136:139], v[24:27], v[224:227], v[136:139]
  ds_read_b64_tr_b16 v[34:35], v3 offset:5120
  s_waitcnt lgkmcnt(2)
  v_mfma_f32_16x16x32_bf16 v[140:143], v[28:31], v[224:227], v[140:143]
  ds_read_b64_tr_b16 v[36:37], v10 offset:4096
  s_waitcnt vmcnt(10)
  v_mfma_f32_16x16x32_bf16 v[144:147], v[16:19], v[228:231], v[144:147]
  v_mfma_f32_16x16x32_bf16 v[148:151], v[20:23], v[228:231], v[148:151]
  ds_read_b64_tr_b16 v[38:39], v10 offset:5120
  v_mfma_f32_16x16x32_bf16 v[152:155], v[24:27], v[228:231], v[152:155]
  ds_read_b64_tr_b16 v[40:41], v14 offset:4096
  v_mfma_f32_16x16x32_bf16 v[156:159], v[28:31], v[228:231], v[156:159]
  ds_read_b64_tr_b16 v[42:43], v14 offset:5120
  s_waitcnt vmcnt(9)
  v_mfma_f32_16x16x32_bf16 v[160:163], v[16:19], v[232:235], v[160:163]
  v_mfma_f32_16x16x32_bf16 v[164:167], v[20:23], v[232:235], v[164:167]
  ds_read_b64_tr_b16 v[44:45], v15 offset:4096
  v_mfma_f32_16x16x32_bf16 v[168:171], v[24:27], v[232:235], v[168:171]
  ds_read_b64_tr_b16 v[46:47], v15 offset:5120
  v_mfma_f32_16x16x32_bf16 v[172:175], v[28:31], v[232:235], v[172:175]
  s_waitcnt vmcnt(8)
  v_mfma_f32_16x16x32_bf16 v[176:179], v[16:19], v[236:239], v[176:179]
  v_mfma_f32_16x16x32_bf16 v[180:183], v[20:23], v[236:239], v[180:183]
  v_mfma_f32_16x16x32_bf16 v[184:187], v[24:27], v[236:239], v[184:187]
  v_mfma_f32_16x16x32_bf16 v[188:191], v[28:31], v[236:239], v[188:191]
  s_waitcnt vmcnt(7) lgkmcnt(6)
  v_mfma_f32_16x16x32_bf16 v[128:131], v[32:35], v[240:243], v[128:131]
  s_waitcnt lgkmcnt(4)
  v_mfma_f32_16x16x32_bf16 v[132:135], v[36:39], v[240:243], v[132:135]
  ds_read_b64_tr_b16 v[16:17], v3 offset:8192
  s_waitcnt lgkmcnt(3)
  v_mfma_f32_16x16x32_bf16 v[136:139], v[40:43], v[240:243], v[136:139]
  ds_read_b64_tr_b16 v[18:19], v3 offset:9216
  s_waitcnt lgkmcnt(2)
  v_mfma_f32_16x16x32_bf16 v[140:143], v[44:47], v[240:243], v[140:143]
  ds_read_b64_tr_b16 v[20:21], v10 offset:8192
  s_waitcnt vmcnt(6)
  v_mfma_f32_16x16x32_bf16 v[144:147], v[32:35], v[244:247], v[144:147]
  v_mfma_f32_16x16x32_bf16 v[148:151], v[36:39], v[244:247], v[148:151]
  ds_read_b64_tr_b16 v[22:23], v10 offset:9216
  v_mfma_f32_16x16x32_bf16 v[152:155], v[40:43], v[244:247], v[152:155]
  ds_read_b64_tr_b16 v[24:25], v14 offset:8192
  v_mfma_f32_16x16x32_bf16 v[156:159], v[44:47], v[244:247], v[156:159]
  ds_read_b64_tr_b16 v[26:27], v14 offset:9216
  s_waitcnt vmcnt(5)
  v_mfma_f32_16x16x32_bf16 v[160:163], v[32:35], v[248:251], v[160:163]
  v_mfma_f32_16x16x32_bf16 v[164:167], v[36:39], v[248:251], v[164:167]
  ds_read_b64_tr_b16 v[28:29], v15 offset:8192
  v_mfma_f32_16x16x32_bf16 v[168:171], v[40:43], v[248:251], v[168:171]
  ds_read_b64_tr_b16 v[30:31], v15 offset:9216
  v_mfma_f32_16x16x32_bf16 v[172:175], v[44:47], v[248:251], v[172:175]
  s_waitcnt vmcnt(4)
  v_mfma_f32_16x16x32_bf16 v[176:179], v[32:35], v[252:255], v[176:179]
  v_mfma_f32_16x16x32_bf16 v[180:183], v[36:39], v[252:255], v[180:183]
  v_mfma_f32_16x16x32_bf16 v[184:187], v[40:43], v[252:255], v[184:187]
  v_mfma_f32_16x16x32_bf16 v[188:191], v[44:47], v[252:255], v[188:191]
  s_waitcnt vmcnt(2) lgkmcnt(6)
  v_mfma_f32_16x16x32_bf16 v[144:147], v[16:19], v[100:103], v[144:147]
  v_lshlrev_b32 v11, 4, v1
  v_add_u32 v13, s66, v11
  s_waitcnt lgkmcnt(4)
  v_mfma_f32_16x16x32_bf16 v[148:151], v[20:23], v[100:103], v[148:151]
  s_waitcnt lgkmcnt(2)
  v_mfma_f32_16x16x32_bf16 v[152:155], v[24:27], v[100:103], v[152:155]
  s_waitcnt lgkmcnt(0)
  v_mfma_f32_16x16x32_bf16 v[156:159], v[28:31], v[100:103], v[156:159]
  s_waitcnt vmcnt(1)
  v_mfma_f32_16x16x32_bf16 v[160:163], v[16:19], v[104:107], v[160:163]
  v_mfma_f32_16x16x32_bf16 v[164:167], v[20:23], v[104:107], v[164:167]
  v_mfma_f32_16x16x32_bf16 v[168:171], v[24:27], v[104:107], v[168:171]
  v_mfma_f32_16x16x32_bf16 v[172:175], v[28:31], v[104:107], v[172:175]
  s_waitcnt vmcnt(0)
  v_mfma_f32_16x16x32_bf16 v[176:179], v[16:19], v[108:111], v[176:179]
  ds_write_b128 v13, v[144:147] offset:51200
  v_mfma_f32_16x16x32_bf16 v[180:183], v[20:23], v[108:111], v[180:183]
  ds_write_b128 v13, v[148:151] offset:52224
  v_mfma_f32_16x16x32_bf16 v[184:187], v[24:27], v[108:111], v[184:187]
  ds_write_b128 v13, v[152:155] offset:53248
  v_mfma_f32_16x16x32_bf16 v[188:191], v[28:31], v[108:111], v[188:191]
  ds_write_b128 v13, v[156:159] offset:54272
  v_mfma_f32_16x16x32_bf16 v[128:131], v[16:19], v[96:99], v[128:131]
  ds_write_b128 v13, v[160:163] offset:55296
  v_mfma_f32_16x16x32_bf16 v[132:135], v[20:23], v[96:99], v[132:135]
  ds_write_b128 v13, v[164:167] offset:56320
  v_mfma_f32_16x16x32_bf16 v[136:139], v[24:27], v[96:99], v[136:139]
  ds_write_b128 v13, v[168:171] offset:57344
  v_mfma_f32_16x16x32_bf16 v[140:143], v[28:31], v[96:99], v[140:143]
  ds_write_b128 v13, v[172:175] offset:58368
  s_sub_u32 s60, s56, 1
  s_and_b32 s60, s60, 3
  s_mul_i32 s60, s60, 12288
  v_add_u32 v14, s60, v11
  s_sub_u32 s60, s56, 2
  s_and_b32 s60, s60, 3
  s_mul_i32 s60, s60, 12288
  v_add_u32 v12, s60, v11
  s_sub_u32 s60, s56, 3
  s_and_b32 s60, s60, 3
  s_mul_i32 s60, s60, 12288
  v_add_u32 v15, s60, v11
  ds_write_b128 v13, v[176:179] offset:59392
  ds_write_b128 v13, v[180:183] offset:60416
  ds_write_b128 v13, v[184:187] offset:61440
  ds_write_b128 v13, v[188:191] offset:62464
  v_lshlrev_b32 v16, 16, v80
  v_and_b32 v17, 0xffff0000, v80
  v_lshlrev_b32 v18, 16, v81
  v_and_b32 v19, 0xffff0000, v81
  v_lshlrev_b32 v20, 16, v82
  v_and_b32 v21, 0xffff0000, v82
  v_lshlrev_b32 v22, 16, v83
  v_and_b32 v23, 0xffff0000, v83
  v_lshlrev_b32 v24, 16, v84
  v_and_b32 v25, 0xffff0000, v84
  v_lshlrev_b32 v26, 16, v85
  v_and_b32 v27, 0xffff0000, v85
  v_lshlrev_b32 v28, 16, v86
  v_and_b32 v29, 0xffff0000, v86
  v_lshlrev_b32 v30, 16, v87
  v_and_b32 v31, 0xffff0000, v87
  v_pk_add_f32 v[128:129], v[128:129], v[16:17]
  v_pk_add_f32 v[130:131], v[130:131], v[18:19]
  v_pk_add_f32 v[132:133], v[132:133], v[20:21]
  v_pk_add_f32 v[134:135], v[134:135], v[22:23]
  v_pk_add_f32 v[136:137], v[136:137], v[24:25]
  v_pk_add_f32 v[138:139], v[138:139], v[26:27]
  v_pk_add_f32 v[140:141], v[140:141], v[28:29]
  v_pk_add_f32 v[142:143], v[142:143], v[30:31]
  s_waitcnt lgkmcnt(0)
  s_barrier
  ds_read_b128 v[144:147], v14 offset:51200
  ds_read_b128 v[160:163], v12 offset:55296
  ds_read_b128 v[176:179], v15 offset:59392
  ds_read_b128 v[148:151], v14 offset:52224
  ds_read_b128 v[164:167], v12 offset:56320
  ds_read_b128 v[180:183], v15 offset:60416
  ds_read_b128 v[152:155], v14 offset:53248
  ds_read_b128 v[168:171], v12 offset:57344
  ds_read_b128 v[184:187], v15 offset:61440
  ds_read_b128 v[156:159], v14 offset:54272
  ds_read_b128 v[172:175], v12 offset:58368
  ds_read_b128 v[188:191], v15 offset:62464
  s_waitcnt lgkmcnt(11)
  v_pk_add_f32 v[128:129], v[128:129], v[144:145]
  v_pk_add_f32 v[130:131], v[130:131], v[146:147]
  s_waitcnt lgkmcnt(9)
  v_pk_add_f32 v[160:161], v[160:161], v[176:177]
  v_pk_add_f32 v[162:163], v[162:163], v[178:179]
  s_waitcnt lgkmcnt(8)
  v_pk_add_f32 v[132:133], v[132:133], v[148:149]
  v_pk_add_f32 v[134:135], v[134:135], v[150:151]
  s_waitcnt lgkmcnt(6)
  v_pk_add_f32 v[164:165], v[164:165], v[180:181]
  v_pk_add_f32 v[166:167], v[166:167], v[182:183]
  v_pk_add_f32 v[128:129], v[128:129], v[160:161]
  v_pk_add_f32 v[130:131], v[130:131], v[162:163]
  v_pk_add_f32 v[132:133], v[132:133], v[164:165]
  v_pk_add_f32 v[134:135], v[134:135], v[166:167]
  v_cvt_pk_bf16_f32 v32, v128, v129
  v_cvt_pk_bf16_f32 v33, v130, v131
  v_cvt_pk_bf16_f32 v34, v132, v133
  v_cvt_pk_bf16_f32 v35, v134, v135
  s_nop 0
  v_permlane16_swap_b32 v32, v34
  v_permlane16_swap_b32 v33, v35
  buffer_store_dwordx4 v[32:35], v8, s[8:11], s69 offen offset:0
  s_waitcnt lgkmcnt(5)
  v_pk_add_f32 v[136:137], v[136:137], v[152:153]
  v_pk_add_f32 v[138:139], v[138:139], v[154:155]
  s_waitcnt lgkmcnt(3)
  v_pk_add_f32 v[168:169], v[168:169], v[184:185]
  v_pk_add_f32 v[170:171], v[170:171], v[186:187]
  s_waitcnt lgkmcnt(2)
  v_pk_add_f32 v[140:141], v[140:141], v[156:157]
  v_pk_add_f32 v[142:143], v[142:143], v[158:159]
  s_waitcnt lgkmcnt(0)
  v_pk_add_f32 v[172:173], v[172:173], v[188:189]
  v_pk_add_f32 v[174:175], v[174:175], v[190:191]
  v_pk_add_f32 v[136:137], v[136:137], v[168:169]
  v_pk_add_f32 v[138:139], v[138:139], v[170:171]
  v_pk_add_f32 v[140:141], v[140:141], v[172:173]
  v_pk_add_f32 v[142:143], v[142:143], v[174:175]
  v_cvt_pk_bf16_f32 v36, v136, v137
  v_cvt_pk_bf16_f32 v37, v138, v139
  v_cvt_pk_bf16_f32 v38, v140, v141
  v_cvt_pk_bf16_f32 v39, v142, v143
  s_nop 0
  v_permlane16_swap_b32 v36, v38
  v_permlane16_swap_b32 v37, v39
  buffer_store_dwordx4 v[36:39], v8, s[8:11], s69 offen offset:64
  s_branch L_fin
L_cidle:
  s_mov_b32 s71, 0x7f000000
  s_waitcnt vmcnt(0)
  s_barrier
  s_branch L_cp2
L_fin:
L_end:
  s_endpgm
L_table:
.long 0x41210010, 0x41210510, 0x41210a00, 0x41210f00, 0x21410016, 0x21410616, 0x21410c06, 0x21111206
.long 0x41420110, 0x41420610, 0x41420b00, 0x41421000, 0x21820116, 0x21820716, 0x21820d06, 0x21221306
.long 0x41840210, 0x41840710, 0x41840c00, 0x41841100, 0x21040216, 0x21040816, 0x21040e06, 0x21441406
.long 0x41080310, 0x41080810, 0x41080d00, 0x41081200, 0x21080316, 0x21080916, 0x21080f06, 0x21881506
.long 0x41100410, 0x41100910, 0x41100e00, 0x41101300, 0x21100416, 0x21100a16, 0x21101006, 0x42111207
.long 0x82210011, 0x82210511, 0x82210a01, 0x82210f01, 0x21200516, 0x21200b16, 0x21201106, 0x42221307
.long 0x82420111, 0x82420611, 0x82420b01, 0x82421001, 0x42410017, 0x42410617, 0x42410c07, 0x42441407
.long 0x82840211, 0x82840711, 0x82840c01, 0x82841101, 0x42820117, 0x42820717, 0x42820d07, 0x42881507
.long 0x82080311, 0x82080811, 0x82080d01, 0x82081201, 0x42040217, 0x42040817, 0x42040e07, 0x84111208
.long 0x82100411, 0x82100911, 0x82100e01, 0x82101301, 0x42080317, 0x42080917, 0x42080f07, 0x84221308
.long 0x04210012, 0x04210512, 0x04210a02, 0x04210f02, 0x42100417, 0x42100a17, 0x42101007, 0x84441408
.long 0x04420112, 0x04420612, 0x04420b02, 0x04421002, 0x42200517, 0x42200b17, 0x42201107, 0x84881508
.long 0x04840212, 0x04840712, 0x04840c02, 0x04841102, 0x84410018, 0x84410618, 0x84410c08, 0x08111209
.long 0x04080312, 0x04080812, 0x04080d02, 0x04081202, 0x84820118, 0x84820718, 0x84820d08, 0x08221309
.long 0x04100412, 0x04100912, 0x04100e02, 0x04101302, 0x84040218, 0x84040818, 0x84040e08, 0x08441409
.long 0x08210013, 0x08210513, 0x08210a03, 0x08210f03, 0x84080318, 0x84080918, 0x84080f08, 0x08881509
.long 0x08420113, 0x08420613, 0x08420b03, 0x08421003, 0x84100418, 0x84100a18, 0x84101008, 0x1011120a
.long 0x08840213, 0x08840713, 0x08840c03, 0x08841103, 0x84200518, 0x84200b18, 0x84201108, 0x1022130a
.long 0x08080313, 0x08080813, 0x08080d03, 0x08081203, 0x08410019, 0x08410619, 0x08410c09, 0x1044140a
.long 0x08100413, 0x08100913, 0x08100e03, 0x08101303, 0x08820119, 0x08820719, 0x08820d09, 0x1088150a
.long 0x10210014, 0x10210514, 0x10210a04, 0x10210f04, 0x08040219, 0x08040819, 0x08040e09, 0x00551400
.long 0x10420114, 0x10420614, 0x10420b04, 0x10421004, 0x08080319, 0x08080919, 0x08080f09, 0x00aa1500
.long 0x10840214, 0x10840714, 0x10840c04, 0x10841104, 0x08100419, 0x08100a19, 0x08101009, 0x00551401
.long 0x10080314, 0x10080814, 0x10080d04, 0x10081204, 0x08200519, 0x08200b19, 0x08201109, 0x00aa1501
.long 0x10100414, 0x10100914, 0x10100e04, 0x10101304, 0x1041001a, 0x1041061a, 0x10410c0a, 0x00551402
.long 0x20210015, 0x20210515, 0x20210a05, 0x20210f05, 0x1082011a, 0x1082071a, 0x10820d0a, 0x00aa1502
.long 0x20420115, 0x20420615, 0x20420b05, 0x20421005, 0x1004021a, 0x1004081a, 0x10040e0a, 0x00551403
.long 0x20840215, 0x20840715, 0x20840c05, 0x20841105, 0x1008031a, 0x1008091a, 0x10080f0a, 0x00aa1503
.long 0x20080315, 0x20080815, 0x20080d05, 0x20081205, 0x1010041a, 0x10100a1a, 0x1010100a, 0x00551404
.long 0x20100415, 0x20100915, 0x20100e05, 0x20101305, 0x1020051a, 0x10200b1a, 0x1020110a, 0x00aa1504
.long 0x00001612, 0x00001613, 0x55001600, 0x55001601, 0x55001616, 0x55001617, 0x00001608, 0x00551405
.long 0x000000c0, 0x00000080, 0xaa001604, 0xaa001605, 0xaa001619, 0xaa00161a, 0x00000080, 0x00aa1505
L_code_end:
.section .rodata,"a"
.p2align 6
.amdhsa_kernel parallel_sum__sliding_local_dilated__geglu_ffn__prompt_kernel
  .amdhsa_next_free_vgpr 256
  .amdhsa_next_free_sgpr 102
  .amdhsa_accum_offset 256
  .amdhsa_group_segment_fixed_size 0
  .amdhsa_kernarg_size 80
  .amdhsa_user_sgpr_count 2
  .amdhsa_user_sgpr_kernarg_segment_ptr 1
  .amdhsa_system_sgpr_workgroup_id_x 1
  .amdhsa_float_denorm_mode_32 3
.end_amdhsa_kernel
.text
```
